```python
import torch

def _softmax(x, axis=-1):
    return torch.softmax(x, dim=axis)
def _gelu(x):
    return torch.nn.functional.gelu(x, approximate="tanh")
def _silu(x):
    return torch.nn.functional.silu(x)
def _sigmoid(x):
    return torch.sigmoid(x)
def _layernorm(x, axis=-1, eps=1e-5):
    m = x.mean(dim=axis, keepdim=True)
    v = x.var(dim=axis, keepdim=True, unbiased=False)
    return (x - m) / torch.sqrt(v + eps)
def _scatter_add(tgt, idx, src, axis=0):
    return tgt.clone().index_add_(axis, idx, src)
def _segment_sum(src, seg, n):
    out = torch.zeros((n,) + src.shape[1:], dtype=src.dtype)
    return out.index_add_(0, seg, src)
def _pad(x, pw):
    flat = tuple(v for pair in reversed(pw) for v in pair)
    return torch.nn.functional.pad(x, flat)

kernel_name = 'interleave_layers__spectral_gfnet__softmax_full_mha__prompt'

def setup_inputs():

    _w = (lambda a: (lambda t: t.to(torch.bfloat16) if t.is_floating_point() else t)(torch.as_tensor(a)))
    def _A_setup():
        B, S, D = 1, 2048, 576
        Df = D // 2 + 1
        return {
            "x": _w((lambda *s: torch.randn(*s, dtype=torch.bfloat16) * 0.05)(B, S, D)),
            "w_r": _w((lambda *s: torch.randn(*s, dtype=torch.bfloat16) * 1.6)(S, Df) * 0.02),
            "w_i": _w((lambda *s: torch.randn(*s, dtype=torch.bfloat16) * 1.6)(S, Df) * 0.02),
        }
    _A_in = _A_setup()

    def _B_setup():
        B, S, D = 1, 2048, 576
        return {
            "x": _w((lambda *s: torch.randn(*s, dtype=torch.bfloat16) * 0.05)(B, S, D)),
            "wqkv": _w((lambda *s: torch.randn(*s, dtype=torch.bfloat16) * 0.05)(D, 3 * D)),
            "wo": _w((lambda *s: torch.randn(*s, dtype=torch.bfloat16) * 0.05)(D, D)),
        }
    _B_in = _B_setup()

    return {
        "A_x": _A_in["x"],
        "A_w_r": _A_in["w_r"],
        "A_w_i": _A_in["w_i"],
        "B_x": _B_in["x"],
        "B_wqkv": _B_in["wqkv"],
        "B_wo": _B_in["wo"],
    }

def reference(A_x, A_w_r, A_w_i, B_x, B_wqkv, B_wo):
    def _A_ref(x, w_r, w_i):
        B, S, D = x.shape
        X = (lambda x, axes=(-2,-1): torch.fft.rfft2(x.float(), dim=axes))(x, axes=(-2, -1))
        W = w_r + 1j * w_i
        X = X * W
        y = (lambda x, s, axes=(-2,-1): torch.fft.irfft2(x, s=s, dim=axes).to(torch.bfloat16))(X, (S, D), axes=(-2, -1))
        return y

    def _B_ref(x, wqkv, wo):
        B, S, D = x.shape
        H = 32; Dh = D // H
        qkv = (lambda x, *d: x.permute(*d))((x @ wqkv).reshape(B, S, 3, H, Dh), 2, 0, 3, 1, 4)
        q, k, v = qkv[0], qkv[1], qkv[2]
        scale = Dh ** -0.5
        scores = torch.einsum("bhqd,bhkd->bhqk", q, k) * scale
        p = _softmax(scores, axis=-1)
        o = torch.einsum("bhqk,bhkd->bhqd", p, v)
        return (lambda x, *d: x.permute(*d))(o, 0, 2, 1, 3).reshape(B, S, D) @ wo

    x = A_x
    x = x + _A_ref(_layernorm(x, axis=-1), A_w_r, A_w_i)
    x = x + _B_ref(_layernorm(x, axis=-1), B_wqkv, B_wo)
    x = x + _A_ref(_layernorm(x, axis=-1), A_w_r, A_w_i)
    x = x + _B_ref(_layernorm(x, axis=-1), B_wqkv, B_wo)
    return x
```

```asm
; @launch grid=(256,1,1) block=(512,1,1) lds=163840
.amdgcn_target "amdgcn-amd-amdhsa--gfx950"
.text
.globl interleave_layers__spectral_gfnet__softmax_full_mha__prompt_kernel
.p2align 8
.type interleave_layers__spectral_gfnet__softmax_full_mha__prompt_kernel,@function
interleave_layers__spectral_gfnet__softmax_full_mha__prompt_kernel:
k_top:
  s_cmp_ge_u32 s2, 256
  s_cbranch_scc1 k_exit
  s_load_dwordx16 s[4:19], s[0:1], 0
  s_load_dwordx2 s[20:21], s[0:1], 64
  v_lshrrev_b32 v4, 6, v0
  v_and_b32 v1, 63, v0
  v_readfirstlane_b32 s22, v4
  v_and_b32 v2, 31, v0
  v_bfe_u32 v3, v0, 5, 1
  s_mov_b32 s23, 0
  s_mov_b32 s65, 0
  v_mov_b32 v109, 0
  s_mov_b32 s88, s2
  s_lshr_b32 s41, s2, 2
  s_xor_b32 s41, s41, s2
  s_bfe_u32 s41, s41, 65538
  s_mul_i32 s41, s41, 20
  s_xor_b32 s88, s88, s41
  s_mov_b32 s40, s22
  s_mov_b64 exec, -1
  s_setprio 0
  s_cmp_ge_u32 s2, 96
  s_cbranch_scc1 p0_r1
  s_and_b32 s46, s2, 7
  s_lshl_b32 s46, s46, 2
  s_bfe_u32 s41, s2, 0x20003
  s_add_u32 s46, s46, s41
  s_lshr_b32 s47, s2, 5
  s_lshr_b32 s41, s46, 3
  s_lshl_b32 s41, s41, 9
  s_and_b32 s42, s46, 1
  s_lshl_b32 s42, s42, 8
  s_add_u32 s41, s41, s42
  s_bfe_u32 s42, s46, 0x10001
  s_lshl_b32 s42, s42, 6
  s_add_u32 s41, s41, s42
  s_bfe_u32 s42, s46, 0x10002
  s_lshl_b32 s42, s42, 4
  s_add_u32 s41, s41, s42
  s_mul_i32 s48, s47, 3
  s_lshl_b32 s49, s40, 10
  s_bfe_u32 s42, s40, 0x10001
  s_lshl_b32 s42, s42, 7
  s_add_u32 s41, s41, s42
  s_lshr_b32 s43, s40, 2
  s_lshl_b32 s42, s43, 5
  s_add_u32 s41, s41, s42
  s_and_b32 s42, s40, 1
  s_lshl_b32 s42, s42, 3
  s_add_u32 s41, s41, s42
  v_lshrrev_b32 v9, 3, v1
  v_add_u32 v9, s41, v9
  v_mul_u32_u24 v9, 1152, v9
  s_lshr_b32 s42, s42, 1
  v_lshrrev_b32 v4, 4, v1
  v_and_b32 v10, 7, v1
  v_xor_b32 v4, v4, v10
  v_xor_b32 v4, s42, v4
  v_lshl_add_u32 v9, v4, 4, v9
  s_lshl_b32 s47, s47, 1
  s_add_u32 s47, s47, s43
  s_xor_b32 s43, s43, 1
  s_mul_i32 s53, s43, 73728
  s_and_b32 s40, s40, 3
  s_waitcnt lgkmcnt(0)
  s_mov_b32 s28, s4
  s_mov_b32 s29, s5
  s_mov_b32 s30, 2359296
  s_mov_b32 s31, 0x20000
  s_mul_i32 s42, s48, 128
  s_mov_b32 m0, s49
  s_nop 0
  buffer_load_dwordx4 v9, s[28:31], s42 offen offset:0 lds
  s_add_u32 s42, s42, 128
  s_add_u32 m0, m0, 8192
  s_cmp_eq_u32 s42, 1152
  s_cselect_b32 s42, 0, s42
  buffer_load_dwordx4 v9, s[28:31], s42 offen offset:0 lds
  s_add_u32 s42, s42, 128
  s_add_u32 m0, m0, 8192
  s_cmp_eq_u32 s42, 1152
  s_cselect_b32 s42, 0, s42
  buffer_load_dwordx4 v9, s[28:31], s42 offen offset:0 lds
  s_add_u32 s42, s42, 128
  s_add_u32 m0, m0, 8192
  s_cmp_eq_u32 s42, 1152
  s_cselect_b32 s42, 0, s42
  buffer_load_dwordx4 v9, s[28:31], s42 offen offset:0 lds
  s_add_u32 s42, s42, 128
  s_add_u32 m0, m0, 8192
  s_cmp_eq_u32 s42, 1152
  s_cselect_b32 s42, 0, s42
  buffer_load_dwordx4 v9, s[28:31], s42 offen offset:0 lds
  s_add_u32 s42, s42, 128
  s_add_u32 m0, m0, 8192
  s_cmp_eq_u32 s42, 1152
  s_cselect_b32 s42, 0, s42
  buffer_load_dwordx4 v9, s[28:31], s42 offen offset:0 lds
  s_add_u32 s42, s42, 128
  s_add_u32 m0, m0, 8192
  s_cmp_eq_u32 s42, 1152
  s_cselect_b32 s42, 0, s42
  buffer_load_dwordx4 v9, s[28:31], s42 offen offset:0 lds
  s_add_u32 s42, s42, 128
  s_add_u32 m0, m0, 8192
  s_cmp_eq_u32 s42, 1152
  s_cselect_b32 s42, 0, s42
  buffer_load_dwordx4 v9, s[28:31], s42 offen offset:0 lds
  s_add_u32 s42, s42, 128
  s_add_u32 m0, m0, 8192
  s_cmp_eq_u32 s42, 1152
  s_cselect_b32 s42, 0, s42
  buffer_load_dwordx4 v9, s[28:31], s42 offen offset:0 lds
  s_lshl_b32 s41, s40, 3
  v_xor_b32 v4, s41, v2
  s_mul_i32 s41, s47, 96
  v_add_u32 v4, s41, v4
  s_lshl_b32 s41, s48, 6
  s_lshl_b32 s42, s40, 4
  s_add_u32 s41, s41, s42
  v_lshl_add_u32 v199, v3, 3, s41
  v_cvt_f32_u32 v199, v199
  v_lshrrev_b32 v196, 1, v4
  v_cvt_f32_u32 v196, v196
  v_and_b32 v198, 1, v4
  v_cvt_f32_u32 v198, v198
  v_mul_f32 v198, 0x3e800000, v198
  v_mov_b32 v192, 0x43900000
  v_mov_b32 v193, 0x3e000000
  v_cmp_eq_u32 vcc, 0, v4
  s_nop 1
  v_cndmask_b32 v195, v196, v192, vcc
  v_cmp_gt_u32 vcc, 2, v4
  s_nop 1
  v_cndmask_b32 v197, v198, v193, vcc
  v_mul_f32 v192, v195, v199
  v_mul_f32 v194, 0x3de38e39, v195
  v_mul_f32 v193, 0x3ae38e39, v192
  v_rndne_f32 v194, v194
  v_rndne_f32 v193, v193
  v_fmamk_f32 v194, v194, 0xc1100000, v195
  v_fmamk_f32 v192, v193, 0xc4100000, v192
  v_mul_f32 v194, 0x3de38e39, v194
  v_fmamk_f32 v128, v192, 0x3ae38e39, v197
  v_mul_f32 v193, 0x3ae38e39, v195
  v_cos_f32 v188, v194
  v_add_f32 v136, v128, v194
  v_fmamk_f32 v129, v193, 0x3f800000, v128
  v_fmamk_f32 v130, v193, 0x40000000, v128
  v_fmamk_f32 v131, v193, 0x40400000, v128
  v_fmamk_f32 v132, v193, 0x40800000, v128
  v_fmamk_f32 v133, v193, 0x40a00000, v128
  v_fmamk_f32 v134, v193, 0x40c00000, v128
  v_fmamk_f32 v135, v193, 0x40e00000, v128
  v_fmamk_f32 v137, v193, 0x3f800000, v136
  v_fmamk_f32 v138, v193, 0x40000000, v136
  v_fmamk_f32 v139, v193, 0x40400000, v136
  v_fmamk_f32 v140, v193, 0x40800000, v136
  v_fmamk_f32 v141, v193, 0x40a00000, v136
  v_fmamk_f32 v142, v193, 0x40c00000, v136
  v_fmamk_f32 v143, v193, 0x40e00000, v136
  v_add_f32 v188, v188, v188
  v_cos_f32 v128, v128
  v_cos_f32 v129, v129
  v_cos_f32 v130, v130
  v_cos_f32 v131, v131
  v_cos_f32 v132, v132
  v_cos_f32 v133, v133
  v_cos_f32 v134, v134
  v_cos_f32 v135, v135
  v_cos_f32 v136, v136
  v_cos_f32 v137, v137
  v_cos_f32 v138, v138
  v_cos_f32 v139, v139
  v_cos_f32 v140, v140
  v_cos_f32 v141, v141
  v_cos_f32 v142, v142
  v_cos_f32 v143, v143
  v_cvt_pk_bf16_f32 v176, v128, v129
  v_cvt_pk_bf16_f32 v177, v130, v131
  v_cvt_pk_bf16_f32 v178, v132, v133
  v_cvt_pk_bf16_f32 v179, v134, v135
  v_add_f32 v196, 0x41800000, v196
  v_mul_f32 v192, v196, v199
  v_mul_f32 v194, 0x3de38e39, v196
  v_mul_f32 v193, 0x3ae38e39, v192
  v_rndne_f32 v194, v194
  v_rndne_f32 v193, v193
  v_fmamk_f32 v194, v194, 0xc1100000, v196
  v_fmamk_f32 v192, v193, 0xc4100000, v192
  v_mul_f32 v194, 0x3de38e39, v194
  v_fmamk_f32 v144, v192, 0x3ae38e39, v198
  v_mul_f32 v193, 0x3ae38e39, v196
  v_cos_f32 v189, v194
  v_add_f32 v152, v144, v194
  v_fmamk_f32 v145, v193, 0x3f800000, v144
  v_fmamk_f32 v146, v193, 0x40000000, v144
  v_fmamk_f32 v147, v193, 0x40400000, v144
  v_fmamk_f32 v148, v193, 0x40800000, v144
  v_fmamk_f32 v149, v193, 0x40a00000, v144
  v_fmamk_f32 v150, v193, 0x40c00000, v144
  v_fmamk_f32 v151, v193, 0x40e00000, v144
  v_fmamk_f32 v153, v193, 0x3f800000, v152
  v_fmamk_f32 v154, v193, 0x40000000, v152
  v_fmamk_f32 v155, v193, 0x40400000, v152
  v_fmamk_f32 v156, v193, 0x40800000, v152
  v_fmamk_f32 v157, v193, 0x40a00000, v152
  v_fmamk_f32 v158, v193, 0x40c00000, v152
  v_fmamk_f32 v159, v193, 0x40e00000, v152
  v_add_f32 v189, v189, v189
  v_cos_f32 v144, v144
  v_cos_f32 v145, v145
  v_cos_f32 v146, v146
  v_cos_f32 v147, v147
  v_cos_f32 v148, v148
  v_cos_f32 v149, v149
  v_cos_f32 v150, v150
  v_cos_f32 v151, v151
  v_cos_f32 v152, v152
  v_cos_f32 v153, v153
  v_cos_f32 v154, v154
  v_cos_f32 v155, v155
  v_cos_f32 v156, v156
  v_cos_f32 v157, v157
  v_cos_f32 v158, v158
  v_cos_f32 v159, v159
  v_cvt_pk_bf16_f32 v180, v144, v145
  v_cvt_pk_bf16_f32 v181, v146, v147
  v_cvt_pk_bf16_f32 v182, v148, v149
  v_cvt_pk_bf16_f32 v183, v150, v151
  v_add_f32 v196, 0x41800000, v196
  v_mul_f32 v192, v196, v199
  v_mul_f32 v194, 0x3de38e39, v196
  v_mul_f32 v193, 0x3ae38e39, v192
  v_rndne_f32 v194, v194
  v_rndne_f32 v193, v193
  v_fmamk_f32 v194, v194, 0xc1100000, v196
  v_fmamk_f32 v192, v193, 0xc4100000, v192
  v_mul_f32 v194, 0x3de38e39, v194
  v_fmamk_f32 v160, v192, 0x3ae38e39, v198
  v_mul_f32 v193, 0x3ae38e39, v196
  v_cos_f32 v190, v194
  v_add_f32 v168, v160, v194
  v_fmamk_f32 v161, v193, 0x3f800000, v160
  v_fmamk_f32 v162, v193, 0x40000000, v160
  v_fmamk_f32 v163, v193, 0x40400000, v160
  v_fmamk_f32 v164, v193, 0x40800000, v160
  v_fmamk_f32 v165, v193, 0x40a00000, v160
  v_fmamk_f32 v166, v193, 0x40c00000, v160
  v_fmamk_f32 v167, v193, 0x40e00000, v160
  v_fmamk_f32 v169, v193, 0x3f800000, v168
  v_fmamk_f32 v170, v193, 0x40000000, v168
  v_fmamk_f32 v171, v193, 0x40400000, v168
  v_fmamk_f32 v172, v193, 0x40800000, v168
  v_fmamk_f32 v173, v193, 0x40a00000, v168
  v_fmamk_f32 v174, v193, 0x40c00000, v168
  v_fmamk_f32 v175, v193, 0x40e00000, v168
  v_add_f32 v190, v190, v190
  v_cos_f32 v160, v160
  v_cos_f32 v161, v161
  v_cos_f32 v162, v162
  v_cos_f32 v163, v163
  v_cos_f32 v164, v164
  v_cos_f32 v165, v165
  v_cos_f32 v166, v166
  v_cos_f32 v167, v167
  v_cos_f32 v168, v168
  v_cos_f32 v169, v169
  v_cos_f32 v170, v170
  v_cos_f32 v171, v171
  v_cos_f32 v172, v172
  v_cos_f32 v173, v173
  v_cos_f32 v174, v174
  v_cos_f32 v175, v175
  v_cvt_pk_bf16_f32 v184, v160, v161
  v_cvt_pk_bf16_f32 v185, v162, v163
  v_cvt_pk_bf16_f32 v186, v164, v165
  v_cvt_pk_bf16_f32 v187, v166, v167
  s_mov_b32 s10, s20
  s_mov_b32 s11, s21
  s_add_u32 s20, s20, 14680064
  s_addc_u32 s21, s21, 0
  s_add_u32 s68, s10, 6291456
  s_addc_u32 s69, s11, 0
  s_mov_b32 s70, 8388608
  s_mov_b32 s71, 0x20000
  s_add_u32 s32, s20, 65536
  s_addc_u32 s33, s21, 0
  s_mov_b32 s34, 2359296
  s_mov_b32 s35, 0x20000
  s_mov_b32 s36, s20
  s_mov_b32 s37, s21
  s_mov_b32 s38, 49152
  s_mov_b32 s39, 0x20000
  v_mov_b32 v11, v2
  s_lshl_b32 s41, s40, 1
  v_bfe_u32 v4, v11, 1, 3
  v_xor_b32 v4, s41, v4
  v_xor_b32 v4, v3, v4
  v_lshlrev_b32 v11, 7, v11
  v_lshl_add_u32 v11, v4, 4, v11
  v_lshlrev_b32 v8, 4, v1
  v_add_u32 v8, s53, v8
  s_xor_b32 s41, s40, 1
  s_mul_i32 s41, s41, 18432
  s_add_u32 s41, s41, 0
  v_add_u32 v5, s41, v8
  s_xor_b32 s41, s40, 2
  s_mul_i32 s41, s41, 18432
  s_add_u32 s41, s41, 6144
  v_add_u32 v6, s41, v8
  s_xor_b32 s41, s40, 3
  s_mul_i32 s41, s41, 18432
  s_add_u32 s41, s41, 12288
  v_add_u32 v7, s41, v8
  s_mul_i32 s41, s40, 18432
  v_add_u32 v8, s41, v8
  s_mul_i32 s41, s47, 393216
  s_lshl_b32 s42, s40, 15
  s_add_u32 s41, s41, s42
  s_lshl_b32 s42, s46, 9
  s_add_u32 s41, s41, s42
  v_lshlrev_b32 v12, 14, v3
  v_lshl_add_u32 v12, v2, 4, v12
  v_add_u32 v12, s41, v12
  s_mov_b32 s54, 0x3d715bef
  s_mov_b32 s55, s54
  s_lshl_b32 s56, s47, 13
  s_lshl_b32 s42, s46, 8
  s_add_u32 s56, s56, s42
  s_lshl_b32 s43, s40, 5
  s_add_u32 s43, s43, s46
  s_mul_i32 s43, s43, 6
  s_add_u32 s43, s43, s47
  s_waitcnt vmcnt(7)
  s_barrier
  ds_read_b128 v[112:115], v11 offset:0
  ds_read_b128 v[116:119], v11 offset:4096
  ds_read_b128 v[120:123], v11 offset:8192
  ds_read_b128 v[124:127], v11 offset:12288
  s_waitcnt lgkmcnt(2)
  v_mfma_f32_32x32x16_bf16 v[16:31], v[176:179], v[112:115], 0
  v_mfma_f32_32x32x16_bf16 v[32:47], v[176:179], v[116:119], 0
  v_mfma_f32_32x32x16_bf16 v[48:63], v[180:183], v[112:115], 0
  v_cvt_pk_bf16_f32 v176, v136, v137
  v_cvt_pk_bf16_f32 v177, v138, v139
  v_cvt_pk_bf16_f32 v178, v140, v141
  v_cvt_pk_bf16_f32 v179, v142, v143
  v_mfma_f32_32x32x16_bf16 v[64:79], v[180:183], v[116:119], 0
  v_mfma_f32_32x32x16_bf16 v[80:95], v[184:187], v[112:115], 0
  v_cvt_pk_bf16_f32 v180, v152, v153
  v_cvt_pk_bf16_f32 v181, v154, v155
  v_cvt_pk_bf16_f32 v182, v156, v157
  v_cvt_pk_bf16_f32 v183, v158, v159
  v_mfma_f32_32x32x16_bf16 v[96:111], v[184:187], v[116:119], 0
  s_waitcnt vmcnt(4)
  s_barrier
  ds_read_b128 v[112:115], v11 offset:16384
  ds_read_b128 v[116:119], v11 offset:20480
  s_waitcnt lgkmcnt(2)
  v_mfma_f32_32x32x16_bf16 v[16:31], v[176:179], v[120:123], v[16:31]
  v_cvt_pk_bf16_f32 v184, v168, v169
  v_cvt_pk_bf16_f32 v185, v170, v171
  v_cvt_pk_bf16_f32 v186, v172, v173
  v_cvt_pk_bf16_f32 v187, v174, v175
  v_fma_f32 v128, v188, v136, -v128
  v_fma_f32 v129, v188, v137, -v129
  v_mfma_f32_32x32x16_bf16 v[32:47], v[176:179], v[124:127], v[32:47]
  v_fma_f32 v130, v188, v138, -v130
  v_fma_f32 v131, v188, v139, -v131
  v_fma_f32 v132, v188, v140, -v132
  v_fma_f32 v133, v188, v141, -v133
  v_fma_f32 v134, v188, v142, -v134
  v_fma_f32 v135, v188, v143, -v135
  v_mfma_f32_32x32x16_bf16 v[48:63], v[180:183], v[120:123], v[48:63]
  v_cvt_pk_bf16_f32 v176, v128, v129
  v_cvt_pk_bf16_f32 v177, v130, v131
  v_cvt_pk_bf16_f32 v178, v132, v133
  v_cvt_pk_bf16_f32 v179, v134, v135
  v_fma_f32 v144, v189, v152, -v144
  v_fma_f32 v145, v189, v153, -v145
  v_mfma_f32_32x32x16_bf16 v[64:79], v[180:183], v[124:127], v[64:79]
  v_fma_f32 v146, v189, v154, -v146
  v_fma_f32 v147, v189, v155, -v147
  v_fma_f32 v148, v189, v156, -v148
  v_fma_f32 v149, v189, v157, -v149
  v_fma_f32 v150, v189, v158, -v150
  v_fma_f32 v151, v189, v159, -v151
  v_mfma_f32_32x32x16_bf16 v[80:95], v[184:187], v[120:123], v[80:95]
  v_cvt_pk_bf16_f32 v180, v144, v145
  v_cvt_pk_bf16_f32 v181, v146, v147
  v_cvt_pk_bf16_f32 v182, v148, v149
  v_cvt_pk_bf16_f32 v183, v150, v151
  v_fma_f32 v160, v190, v168, -v160
  v_fma_f32 v161, v190, v169, -v161
  v_mfma_f32_32x32x16_bf16 v[96:111], v[184:187], v[124:127], v[96:111]
  v_fma_f32 v162, v190, v170, -v162
  v_fma_f32 v163, v190, v171, -v163
  v_fma_f32 v164, v190, v172, -v164
  v_fma_f32 v165, v190, v173, -v165
  v_fma_f32 v166, v190, v174, -v166
  v_fma_f32 v167, v190, v175, -v167
  v_mov_b32 v216, -1
  v_mov_b32 v217, -1
  v_mov_b32 v218, -1
  v_mov_b32 v219, -1
  s_mov_b32 s41, 131072
  s_mov_b32 s42, 262144
  v_lshlrev_b32 v4, 2, v1
  buffer_store_dwordx4 v[216:219], v12, s[32:35], 0 offen sc1
  buffer_store_dwordx4 v[216:219], v12, s[32:35], s41 offen sc1
  buffer_store_dwordx4 v[216:219], v12, s[32:35], s42 offen sc1
  buffer_store_dword v216, v4, s[36:39], s56 offen sc1
  ds_read_b128 v[120:123], v11 offset:24576
  ds_read_b128 v[124:127], v11 offset:28672
  s_waitcnt lgkmcnt(2)
  v_mfma_f32_32x32x16_bf16 v[16:31], v[176:179], v[112:115], v[16:31]
  v_cvt_pk_bf16_f32 v184, v160, v161
  v_cvt_pk_bf16_f32 v185, v162, v163
  v_cvt_pk_bf16_f32 v186, v164, v165
  v_cvt_pk_bf16_f32 v187, v166, v167
  v_fma_f32 v136, v188, v128, -v136
  v_fma_f32 v137, v188, v129, -v137
  v_mfma_f32_32x32x16_bf16 v[32:47], v[176:179], v[116:119], v[32:47]
  v_fma_f32 v138, v188, v130, -v138
  v_fma_f32 v139, v188, v131, -v139
  v_fma_f32 v140, v188, v132, -v140
  v_fma_f32 v141, v188, v133, -v141
  v_fma_f32 v142, v188, v134, -v142
  v_fma_f32 v143, v188, v135, -v143
  v_mfma_f32_32x32x16_bf16 v[48:63], v[180:183], v[112:115], v[48:63]
  v_cvt_pk_bf16_f32 v176, v136, v137
  v_cvt_pk_bf16_f32 v177, v138, v139
  v_cvt_pk_bf16_f32 v178, v140, v141
  v_cvt_pk_bf16_f32 v179, v142, v143
  v_fma_f32 v152, v189, v144, -v152
  v_fma_f32 v153, v189, v145, -v153
  v_mfma_f32_32x32x16_bf16 v[64:79], v[180:183], v[116:119], v[64:79]
  v_fma_f32 v154, v189, v146, -v154
  v_fma_f32 v155, v189, v147, -v155
  v_fma_f32 v156, v189, v148, -v156
  v_fma_f32 v157, v189, v149, -v157
  v_fma_f32 v158, v189, v150, -v158
  v_fma_f32 v159, v189, v151, -v159
  v_mfma_f32_32x32x16_bf16 v[80:95], v[184:187], v[112:115], v[80:95]
  v_cvt_pk_bf16_f32 v180, v152, v153
  v_cvt_pk_bf16_f32 v181, v154, v155
  v_cvt_pk_bf16_f32 v182, v156, v157
  v_cvt_pk_bf16_f32 v183, v158, v159
  v_fma_f32 v168, v190, v160, -v168
  v_fma_f32 v169, v190, v161, -v169
  v_mfma_f32_32x32x16_bf16 v[96:111], v[184:187], v[116:119], v[96:111]
  v_fma_f32 v170, v190, v162, -v170
  v_fma_f32 v171, v190, v163, -v171
  v_fma_f32 v172, v190, v164, -v172
  v_fma_f32 v173, v190, v165, -v173
  v_fma_f32 v174, v190, v166, -v174
  v_fma_f32 v175, v190, v167, -v175
  ds_read_b128 v[112:115], v11 offset:32768
  ds_read_b128 v[116:119], v11 offset:36864
  s_waitcnt lgkmcnt(2)
  v_mfma_f32_32x32x16_bf16 v[16:31], v[176:179], v[120:123], v[16:31]
  v_cvt_pk_bf16_f32 v184, v168, v169
  v_cvt_pk_bf16_f32 v185, v170, v171
  v_cvt_pk_bf16_f32 v186, v172, v173
  v_cvt_pk_bf16_f32 v187, v174, v175
  v_fma_f32 v128, v188, v136, -v128
  v_fma_f32 v129, v188, v137, -v129
  v_mfma_f32_32x32x16_bf16 v[32:47], v[176:179], v[124:127], v[32:47]
  v_fma_f32 v130, v188, v138, -v130
  v_fma_f32 v131, v188, v139, -v131
  v_fma_f32 v132, v188, v140, -v132
  v_fma_f32 v133, v188, v141, -v133
  v_fma_f32 v134, v188, v142, -v134
  v_fma_f32 v135, v188, v143, -v135
  v_mfma_f32_32x32x16_bf16 v[48:63], v[180:183], v[120:123], v[48:63]
  v_cvt_pk_bf16_f32 v176, v128, v129
  v_cvt_pk_bf16_f32 v177, v130, v131
  v_cvt_pk_bf16_f32 v178, v132, v133
  v_cvt_pk_bf16_f32 v179, v134, v135
  v_fma_f32 v144, v189, v152, -v144
  v_fma_f32 v145, v189, v153, -v145
  v_mfma_f32_32x32x16_bf16 v[64:79], v[180:183], v[124:127], v[64:79]
  v_fma_f32 v146, v189, v154, -v146
  v_fma_f32 v147, v189, v155, -v147
  v_fma_f32 v148, v189, v156, -v148
  v_fma_f32 v149, v189, v157, -v149
  v_fma_f32 v150, v189, v158, -v150
  v_fma_f32 v151, v189, v159, -v151
  v_mfma_f32_32x32x16_bf16 v[80:95], v[184:187], v[120:123], v[80:95]
  v_cvt_pk_bf16_f32 v180, v144, v145
  v_cvt_pk_bf16_f32 v181, v146, v147
  v_cvt_pk_bf16_f32 v182, v148, v149
  v_cvt_pk_bf16_f32 v183, v150, v151
  v_fma_f32 v160, v190, v168, -v160
  v_fma_f32 v161, v190, v169, -v161
  v_mfma_f32_32x32x16_bf16 v[96:111], v[184:187], v[124:127], v[96:111]
  v_fma_f32 v162, v190, v170, -v162
  v_fma_f32 v163, v190, v171, -v163
  v_fma_f32 v164, v190, v172, -v164
  v_fma_f32 v165, v190, v173, -v165
  v_fma_f32 v166, v190, v174, -v166
  v_fma_f32 v167, v190, v175, -v167
  s_waitcnt vmcnt(4)
  s_barrier
  ds_read_b128 v[120:123], v11 offset:40960
  ds_read_b128 v[124:127], v11 offset:45056
  s_waitcnt lgkmcnt(2)
  v_mfma_f32_32x32x16_bf16 v[16:31], v[176:179], v[112:115], v[16:31]
  v_cvt_pk_bf16_f32 v184, v160, v161
  v_cvt_pk_bf16_f32 v185, v162, v163
  v_cvt_pk_bf16_f32 v186, v164, v165
  v_cvt_pk_bf16_f32 v187, v166, v167
  v_fma_f32 v136, v188, v128, -v136
  v_fma_f32 v137, v188, v129, -v137
  v_mfma_f32_32x32x16_bf16 v[32:47], v[176:179], v[116:119], v[32:47]
  v_fma_f32 v138, v188, v130, -v138
  v_fma_f32 v139, v188, v131, -v139
  v_fma_f32 v140, v188, v132, -v140
  v_fma_f32 v141, v188, v133, -v141
  v_fma_f32 v142, v188, v134, -v142
  v_fma_f32 v143, v188, v135, -v143
  v_mfma_f32_32x32x16_bf16 v[48:63], v[180:183], v[112:115], v[48:63]
  v_cvt_pk_bf16_f32 v176, v136, v137
  v_cvt_pk_bf16_f32 v177, v138, v139
  v_cvt_pk_bf16_f32 v178, v140, v141
  v_cvt_pk_bf16_f32 v179, v142, v143
  v_fma_f32 v152, v189, v144, -v152
  v_fma_f32 v153, v189, v145, -v153
  v_mfma_f32_32x32x16_bf16 v[64:79], v[180:183], v[116:119], v[64:79]
  v_fma_f32 v154, v189, v146, -v154
  v_fma_f32 v155, v189, v147, -v155
  v_fma_f32 v156, v189, v148, -v156
  v_fma_f32 v157, v189, v149, -v157
  v_fma_f32 v158, v189, v150, -v158
  v_fma_f32 v159, v189, v151, -v159
  v_mfma_f32_32x32x16_bf16 v[80:95], v[184:187], v[112:115], v[80:95]
  v_cvt_pk_bf16_f32 v180, v152, v153
  v_cvt_pk_bf16_f32 v181, v154, v155
  v_cvt_pk_bf16_f32 v182, v156, v157
  v_cvt_pk_bf16_f32 v183, v158, v159
  v_fma_f32 v168, v190, v160, -v168
  v_fma_f32 v169, v190, v161, -v169
  v_mfma_f32_32x32x16_bf16 v[96:111], v[184:187], v[116:119], v[96:111]
  v_fma_f32 v170, v190, v162, -v170
  v_fma_f32 v171, v190, v163, -v171
  v_fma_f32 v172, v190, v164, -v172
  v_fma_f32 v173, v190, v165, -v173
  v_fma_f32 v174, v190, v166, -v174
  v_fma_f32 v175, v190, v167, -v175
  ds_read_b128 v[112:115], v11 offset:49152
  ds_read_b128 v[116:119], v11 offset:53248
  s_waitcnt lgkmcnt(2)
  v_mfma_f32_32x32x16_bf16 v[16:31], v[176:179], v[120:123], v[16:31]
  v_cvt_pk_bf16_f32 v184, v168, v169
  v_cvt_pk_bf16_f32 v185, v170, v171
  v_cvt_pk_bf16_f32 v186, v172, v173
  v_cvt_pk_bf16_f32 v187, v174, v175
  v_fma_f32 v128, v188, v136, -v128
  v_fma_f32 v129, v188, v137, -v129
  v_mfma_f32_32x32x16_bf16 v[32:47], v[176:179], v[124:127], v[32:47]
  v_fma_f32 v130, v188, v138, -v130
  v_fma_f32 v131, v188, v139, -v131
  v_fma_f32 v132, v188, v140, -v132
  v_fma_f32 v133, v188, v141, -v133
  v_fma_f32 v134, v188, v142, -v134
  v_fma_f32 v135, v188, v143, -v135
  v_mfma_f32_32x32x16_bf16 v[48:63], v[180:183], v[120:123], v[48:63]
  v_cvt_pk_bf16_f32 v176, v128, v129
  v_cvt_pk_bf16_f32 v177, v130, v131
  v_cvt_pk_bf16_f32 v178, v132, v133
  v_cvt_pk_bf16_f32 v179, v134, v135
  v_fma_f32 v144, v189, v152, -v144
  v_fma_f32 v145, v189, v153, -v145
  v_mfma_f32_32x32x16_bf16 v[64:79], v[180:183], v[124:127], v[64:79]
  v_fma_f32 v146, v189, v154, -v146
  v_fma_f32 v147, v189, v155, -v147
  v_fma_f32 v148, v189, v156, -v148
  v_fma_f32 v149, v189, v157, -v149
  v_fma_f32 v150, v189, v158, -v150
  v_fma_f32 v151, v189, v159, -v151
  v_mfma_f32_32x32x16_bf16 v[80:95], v[184:187], v[120:123], v[80:95]
  v_cvt_pk_bf16_f32 v180, v144, v145
  v_cvt_pk_bf16_f32 v181, v146, v147
  v_cvt_pk_bf16_f32 v182, v148, v149
  v_cvt_pk_bf16_f32 v183, v150, v151
  v_fma_f32 v160, v190, v168, -v160
  v_fma_f32 v161, v190, v169, -v161
  v_mfma_f32_32x32x16_bf16 v[96:111], v[184:187], v[124:127], v[96:111]
  v_fma_f32 v162, v190, v170, -v162
  v_fma_f32 v163, v190, v171, -v163
  v_fma_f32 v164, v190, v172, -v164
  v_fma_f32 v165, v190, v173, -v165
  v_fma_f32 v166, v190, v174, -v166
  v_fma_f32 v167, v190, v175, -v167
  ds_read_b128 v[120:123], v11 offset:57344
  ds_read_b128 v[124:127], v11 offset:61440
  s_waitcnt lgkmcnt(2)
  v_mfma_f32_32x32x16_bf16 v[16:31], v[176:179], v[112:115], v[16:31]
  v_cvt_pk_bf16_f32 v184, v160, v161
  v_cvt_pk_bf16_f32 v185, v162, v163
  v_cvt_pk_bf16_f32 v186, v164, v165
  v_cvt_pk_bf16_f32 v187, v166, v167
  v_fma_f32 v136, v188, v128, -v136
  v_fma_f32 v137, v188, v129, -v137
  v_mfma_f32_32x32x16_bf16 v[32:47], v[176:179], v[116:119], v[32:47]
  v_fma_f32 v138, v188, v130, -v138
  v_fma_f32 v139, v188, v131, -v139
  v_fma_f32 v140, v188, v132, -v140
  v_fma_f32 v141, v188, v133, -v141
  v_fma_f32 v142, v188, v134, -v142
  v_fma_f32 v143, v188, v135, -v143
  v_mfma_f32_32x32x16_bf16 v[48:63], v[180:183], v[112:115], v[48:63]
  v_cvt_pk_bf16_f32 v176, v136, v137
  v_cvt_pk_bf16_f32 v177, v138, v139
  v_cvt_pk_bf16_f32 v178, v140, v141
  v_cvt_pk_bf16_f32 v179, v142, v143
  v_fma_f32 v152, v189, v144, -v152
  v_fma_f32 v153, v189, v145, -v153
  v_mfma_f32_32x32x16_bf16 v[64:79], v[180:183], v[116:119], v[64:79]
  v_fma_f32 v154, v189, v146, -v154
  v_fma_f32 v155, v189, v147, -v155
  v_fma_f32 v156, v189, v148, -v156
  v_fma_f32 v157, v189, v149, -v157
  v_fma_f32 v158, v189, v150, -v158
  v_fma_f32 v159, v189, v151, -v159
  v_mfma_f32_32x32x16_bf16 v[80:95], v[184:187], v[112:115], v[80:95]
  v_cvt_pk_bf16_f32 v180, v152, v153
  v_cvt_pk_bf16_f32 v181, v154, v155
  v_cvt_pk_bf16_f32 v182, v156, v157
  v_cvt_pk_bf16_f32 v183, v158, v159
  v_fma_f32 v168, v190, v160, -v168
  v_fma_f32 v169, v190, v161, -v169
  v_mfma_f32_32x32x16_bf16 v[96:111], v[184:187], v[116:119], v[96:111]
  v_fma_f32 v170, v190, v162, -v170
  v_fma_f32 v171, v190, v163, -v171
  v_fma_f32 v172, v190, v164, -v172
  v_fma_f32 v173, v190, v165, -v173
  v_fma_f32 v174, v190, v166, -v174
  v_fma_f32 v175, v190, v167, -v175
  v_add_u32 v11, 0x10000, v11
  ds_read_b128 v[112:115], v11 offset:0
  ds_read_b128 v[116:119], v11 offset:4096
  s_waitcnt lgkmcnt(2)
  v_mfma_f32_32x32x16_bf16 v[16:31], v[176:179], v[120:123], v[16:31]
  v_cvt_pk_bf16_f32 v184, v168, v169
  v_cvt_pk_bf16_f32 v185, v170, v171
  v_cvt_pk_bf16_f32 v186, v172, v173
  v_cvt_pk_bf16_f32 v187, v174, v175
  v_fma_f32 v128, v188, v136, -v128
  v_fma_f32 v129, v188, v137, -v129
  v_mfma_f32_32x32x16_bf16 v[32:47], v[176:179], v[124:127], v[32:47]
  v_fma_f32 v130, v188, v138, -v130
  v_fma_f32 v131, v188, v139, -v131
  v_fma_f32 v132, v188, v140, -v132
  v_fma_f32 v133, v188, v141, -v133
  v_fma_f32 v134, v188, v142, -v134
  v_fma_f32 v135, v188, v143, -v135
  v_mfma_f32_32x32x16_bf16 v[48:63], v[180:183], v[120:123], v[48:63]
  v_cvt_pk_bf16_f32 v176, v128, v129
  v_cvt_pk_bf16_f32 v177, v130, v131
  v_cvt_pk_bf16_f32 v178, v132, v133
  v_cvt_pk_bf16_f32 v179, v134, v135
  v_fma_f32 v144, v189, v152, -v144
  v_fma_f32 v145, v189, v153, -v145
  v_mfma_f32_32x32x16_bf16 v[64:79], v[180:183], v[124:127], v[64:79]
  v_fma_f32 v146, v189, v154, -v146
  v_fma_f32 v147, v189, v155, -v147
  v_fma_f32 v148, v189, v156, -v148
  v_fma_f32 v149, v189, v157, -v149
  v_fma_f32 v150, v189, v158, -v150
  v_fma_f32 v151, v189, v159, -v151
  v_mfma_f32_32x32x16_bf16 v[80:95], v[184:187], v[120:123], v[80:95]
  v_cvt_pk_bf16_f32 v180, v144, v145
  v_cvt_pk_bf16_f32 v181, v146, v147
  v_cvt_pk_bf16_f32 v182, v148, v149
  v_cvt_pk_bf16_f32 v183, v150, v151
  v_fma_f32 v160, v190, v168, -v160
  v_fma_f32 v161, v190, v169, -v161
  v_mfma_f32_32x32x16_bf16 v[96:111], v[184:187], v[124:127], v[96:111]
  v_fma_f32 v162, v190, v170, -v162
  v_fma_f32 v163, v190, v171, -v163
  v_fma_f32 v164, v190, v172, -v164
  v_fma_f32 v165, v190, v173, -v165
  v_fma_f32 v166, v190, v174, -v166
  v_fma_f32 v167, v190, v175, -v167
  s_waitcnt lgkmcnt(0)
  v_mfma_f32_32x32x16_bf16 v[16:31], v[176:179], v[112:115], v[16:31]
  v_cvt_pk_bf16_f32 v184, v160, v161
  v_cvt_pk_bf16_f32 v185, v162, v163
  v_cvt_pk_bf16_f32 v186, v164, v165
  v_cvt_pk_bf16_f32 v187, v166, v167
  v_mfma_f32_32x32x16_bf16 v[32:47], v[176:179], v[116:119], v[32:47]
  v_mfma_f32_32x32x16_bf16 v[48:63], v[180:183], v[112:115], v[48:63]
  v_mfma_f32_32x32x16_bf16 v[64:79], v[180:183], v[116:119], v[64:79]
  v_mfma_f32_32x32x16_bf16 v[80:95], v[184:187], v[112:115], v[80:95]
  v_mfma_f32_32x32x16_bf16 v[96:111], v[184:187], v[116:119], v[96:111]
  v_mov_b32 v214, 0
  global_load_dwordx2 v[212:213], v214, s[18:19] sc1
  s_barrier
  ds_write_b128 v5, v[20:23] offset:0
  ds_write_b128 v6, v[24:27] offset:0
  ds_write_b128 v7, v[28:31] offset:0
  s_nop 1
  ds_write_b128 v5, v[36:39] offset:1024
  ds_write_b128 v6, v[40:43] offset:1024
  ds_write_b128 v7, v[44:47] offset:1024
  ds_write_b128 v5, v[52:55] offset:2048
  ds_write_b128 v6, v[56:59] offset:2048
  ds_write_b128 v7, v[60:63] offset:2048
  ds_write_b128 v5, v[68:71] offset:3072
  ds_write_b128 v6, v[72:75] offset:3072
  ds_write_b128 v7, v[76:79] offset:3072
  ds_write_b128 v5, v[84:87] offset:4096
  ds_write_b128 v6, v[88:91] offset:4096
  ds_write_b128 v7, v[92:95] offset:4096
  ds_write_b128 v5, v[100:103] offset:5120
  ds_write_b128 v6, v[104:107] offset:5120
  ds_write_b128 v7, v[108:111] offset:5120
  s_mov_b32 s3, 65536
  s_waitcnt vmcnt(0)
non1:
  v_readfirstlane_b32 s101, v213
  v_readfirstlane_b32 s100, v212
  s_cmp_lg_u32 s101, 0
  s_cbranch_scc1 non1_x
  global_load_dwordx2 v[212:213], v214, s[18:19] sc1
  s_sub_u32 s3, s3, 1
  s_waitcnt vmcnt(0)
  s_cbranch_scc0 non1
non1_x:
  v_mov_b32 v216, s100
  v_mov_b32 v217, s101
  s_lshl_b32 s43, s43, 7
  s_add_u32 s43, s43, 0
  s_mov_b64 exec, 1
  s_waitcnt vmcnt(63)
  buffer_store_dwordx2 v[216:217], off, s[68:71], s43 sc1
  s_mov_b64 exec, -1
  s_waitcnt lgkmcnt(0)
  s_barrier
  ds_read_b128 v[112:115], v8 offset:0
  ds_read_b128 v[116:119], v8 offset:6144
  ds_read_b128 v[120:123], v8 offset:12288
  ds_read_b128 v[124:127], v8 offset:1024
  ds_read_b128 v[128:131], v8 offset:7168
  ds_read_b128 v[132:135], v8 offset:13312
  ds_read_b128 v[136:139], v8 offset:2048
  ds_read_b128 v[140:143], v8 offset:8192
  ds_read_b128 v[144:147], v8 offset:14336
  ds_read_b128 v[148:151], v8 offset:3072
  ds_read_b128 v[152:155], v8 offset:9216
  ds_read_b128 v[156:159], v8 offset:15360
  ds_read_b128 v[160:163], v8 offset:4096
  ds_read_b128 v[164:167], v8 offset:10240
  ds_read_b128 v[168:171], v8 offset:16384
  ds_read_b128 v[172:175], v8 offset:5120
  ds_read_b128 v[176:179], v8 offset:11264
  ds_read_b128 v[180:183], v8 offset:17408
  s_waitcnt lgkmcnt(15)
  v_pk_add_f32 v[112:113], v[112:113], v[116:117]
  v_pk_add_f32 v[16:17], v[16:17], v[120:121]
  v_pk_add_f32 v[114:115], v[114:115], v[118:119]
  v_pk_add_f32 v[18:19], v[18:19], v[122:123]
  v_pk_add_f32 v[16:17], v[16:17], v[112:113]
  v_pk_add_f32 v[18:19], v[18:19], v[114:115]
  s_waitcnt lgkmcnt(12)
  v_pk_add_f32 v[124:125], v[124:125], v[128:129]
  v_pk_add_f32 v[32:33], v[32:33], v[132:133]
  v_pk_add_f32 v[126:127], v[126:127], v[130:131]
  v_pk_add_f32 v[34:35], v[34:35], v[134:135]
  v_pk_add_f32 v[32:33], v[32:33], v[124:125]
  v_pk_add_f32 v[34:35], v[34:35], v[126:127]
  s_waitcnt lgkmcnt(9)
  v_pk_add_f32 v[136:137], v[136:137], v[140:141]
  v_pk_add_f32 v[48:49], v[48:49], v[144:145]
  v_pk_add_f32 v[138:139], v[138:139], v[142:143]
  v_pk_add_f32 v[50:51], v[50:51], v[146:147]
  v_pk_add_f32 v[48:49], v[48:49], v[136:137]
  v_pk_add_f32 v[50:51], v[50:51], v[138:139]
  s_waitcnt lgkmcnt(6)
  v_pk_add_f32 v[148:149], v[148:149], v[152:153]
  v_pk_add_f32 v[64:65], v[64:65], v[156:157]
  v_pk_add_f32 v[150:151], v[150:151], v[154:155]
  v_pk_add_f32 v[66:67], v[66:67], v[158:159]
  v_pk_add_f32 v[64:65], v[64:65], v[148:149]
  v_pk_add_f32 v[66:67], v[66:67], v[150:151]
  s_waitcnt lgkmcnt(3)
  v_pk_add_f32 v[160:161], v[160:161], v[164:165]
  v_pk_add_f32 v[80:81], v[80:81], v[168:169]
  v_pk_add_f32 v[162:163], v[162:163], v[166:167]
  v_pk_add_f32 v[82:83], v[82:83], v[170:171]
  v_pk_add_f32 v[80:81], v[80:81], v[160:161]
  v_pk_add_f32 v[82:83], v[82:83], v[162:163]
  s_waitcnt lgkmcnt(0)
  v_pk_add_f32 v[172:173], v[172:173], v[176:177]
  v_pk_add_f32 v[96:97], v[96:97], v[180:181]
  v_pk_add_f32 v[174:175], v[174:175], v[178:179]
  v_pk_add_f32 v[98:99], v[98:99], v[182:183]
  v_pk_add_f32 v[96:97], v[96:97], v[172:173]
  v_pk_add_f32 v[98:99], v[98:99], v[174:175]
  s_or_b32 s41, s47, s40
  v_or_b32 v4, s41, v3
  v_cmp_eq_u32 vcc, 0, v4
  v_mov_b32 v4, -1
  v_mov_b32 v204, 0xffff
  v_cndmask_b32 v4, v4, v204, vcc
  v_mov_b32 v206, 0
  v_mov_b32 v207, 0
  v_pk_mul_f32 v[16:17], v[16:17], s[54:55]
  v_pk_mul_f32 v[18:19], v[18:19], s[54:55]
  v_cvt_pk_bf16_f32 v192, v16, v17
  v_cvt_pk_bf16_f32 v193, v18, v19
  v_and_b32 v205, v4, v192
  v_dot2_f32_bf16 v206, v205, v205, v206
  v_dot2_f32_bf16 v206, v193, v193, v206
  v_pk_mul_f32 v[32:33], v[32:33], s[54:55]
  v_pk_mul_f32 v[34:35], v[34:35], s[54:55]
  v_cvt_pk_bf16_f32 v194, v32, v33
  v_cvt_pk_bf16_f32 v195, v34, v35
  s_mov_b32 s42, 0
  buffer_store_dwordx4 v[192:195], v12, s[32:35], s42 offen sc1
  v_and_b32 v205, v4, v194
  v_dot2_f32_bf16 v207, v205, v205, v207
  v_dot2_f32_bf16 v207, v195, v195, v207
  v_pk_mul_f32 v[48:49], v[48:49], s[54:55]
  v_pk_mul_f32 v[50:51], v[50:51], s[54:55]
  v_cvt_pk_bf16_f32 v196, v48, v49
  v_cvt_pk_bf16_f32 v197, v50, v51
  v_dot2_f32_bf16 v206, v196, v196, v206
  v_dot2_f32_bf16 v206, v197, v197, v206
  v_pk_mul_f32 v[64:65], v[64:65], s[54:55]
  v_pk_mul_f32 v[66:67], v[66:67], s[54:55]
  v_cvt_pk_bf16_f32 v198, v64, v65
  v_cvt_pk_bf16_f32 v199, v66, v67
  s_mov_b32 s42, 131072
  buffer_store_dwordx4 v[196:199], v12, s[32:35], s42 offen sc1
  v_dot2_f32_bf16 v207, v198, v198, v207
  v_dot2_f32_bf16 v207, v199, v199, v207
  v_pk_mul_f32 v[80:81], v[80:81], s[54:55]
  v_pk_mul_f32 v[82:83], v[82:83], s[54:55]
  v_cvt_pk_bf16_f32 v200, v80, v81
  v_cvt_pk_bf16_f32 v201, v82, v83
  v_dot2_f32_bf16 v206, v200, v200, v206
  v_dot2_f32_bf16 v206, v201, v201, v206
  v_pk_mul_f32 v[96:97], v[96:97], s[54:55]
  v_pk_mul_f32 v[98:99], v[98:99], s[54:55]
  v_cvt_pk_bf16_f32 v202, v96, v97
  v_cvt_pk_bf16_f32 v203, v98, v99
  s_mov_b32 s42, 262144
  buffer_store_dwordx4 v[200:203], v12, s[32:35], s42 offen sc1
  v_dot2_f32_bf16 v207, v202, v202, v207
  v_dot2_f32_bf16 v207, v203, v203, v207
  s_nop 2
  v_permlane32_swap_b32 v206, v207
  v_lshlrev_b32 v5, 2, v0
  v_add_u32 v5, 147456, v5
  v_add_f32 v206, v206, v207
  ds_write_b32 v5, v206
  v_lshl_add_u32 v4, v2, 1, v3
  v_lshlrev_b32 v4, 2, v4
  s_cmp_lg_u32 s40, 0
  s_waitcnt lgkmcnt(0)
  s_barrier
  s_cbranch_scc1 p0a_done
  ds_read_b32 v208, v5 offset:256
  ds_read_b32 v209, v5 offset:512
  ds_read_b32 v210, v5 offset:768
  s_waitcnt lgkmcnt(0)
  v_add_f32 v206, v206, v208
  v_add_f32 v209, v209, v210
  v_add_f32 v206, v206, v209
  buffer_store_dword v206, v4, s[36:39], s56 offen sc1
p0a_done:
  s_branch p0_end
p0_r1:
  s_cmp_ge_u32 s2, 128
  s_cbranch_scc1 p0_r2
  s_sub_u32 s46, s2, 96
  s_and_b32 s43, s46, 3
  s_lshl_b32 s43, s43, 4
  s_lshr_b32 s41, s46, 2
  s_add_u32 s43, s43, s41
  s_add_u32 s43, s43, 768
  s_lshl_b32 s46, s46, 1
  s_lshr_b32 s41, s40, 2
  s_add_u32 s46, s46, s41
  s_mul_i32 s51, s41, 40960
  s_mul_i32 s50, s40, 10240
  s_and_b32 s40, s40, 3
  s_lshr_b32 s41, s46, 3
  s_lshl_b32 s41, s41, 2
  s_add_u32 s41, s41, s40
  s_lshl_b32 s41, s41, 6
  s_and_b32 s42, s46, 7
  s_lshl_b32 s42, s42, 3
  s_add_u32 s41, s41, s42
  s_mul_i32 s48, s41, 578
  s_add_u32 s49, s48, 4096
  v_lshlrev_b32 v5, 4, v1
  v_and_b32 v6, 7, v1
  v_lshrrev_b32 v7, 3, v1
  s_mul_i32 s41, s40, 72
  v_lshl_add_u32 v8, v7, 3, s41
  s_add_u32 s41, s41, 64
  v_add_u32 v9, s41, v7
  v_mul_u32_u24 v10, 578, v6
  v_add_u32 v10, s51, v10
  v_lshl_add_u32 v11, v8, 1, v10
  v_lshl_add_u32 v12, v9, 1, v10
  v_add_u32 v10, 576, v10
  v_cmp_eq_u32 vcc, 0, v8
  s_nop 1
  v_cndmask_b32 v10, v11, v10, vcc
  s_lshr_b32 s41, s46, 5
  s_lshl_b32 s41, s41, 12
  s_bfe_u32 s42, s46, 0x20001
  s_lshl_b32 s42, s42, 10
  s_add_u32 s41, s41, s42
  s_bfe_u32 s42, s46, 0x20003
  s_lshl_b32 s42, s42, 8
  s_add_u32 s41, s41, s42
  s_and_b32 s42, s46, 1
  s_lshl_b32 s42, s42, 7
  s_add_u32 s41, s41, s42
  v_lshl_add_u32 v6, v6, 4, s41
  v_lshl_add_u32 v8, v8, 13, v6
  v_lshl_add_u32 v9, v9, 13, v6
  s_waitcnt lgkmcnt(0)
  s_mov_b32 s24, s6
  s_mov_b32 s25, s7
  s_mov_b32 s26, 1183744
  s_mov_b32 s27, 0x20000
  s_mov_b32 s28, s8
  s_mov_b32 s29, s9
  s_mov_b32 s30, 1183744
  s_mov_b32 s31, 0x20000
  s_add_u32 m0, s50, 0
  s_nop 0
  buffer_load_dwordx4 v5, s[24:27], s48 offen offset:0 lds
  buffer_load_dwordx4 v5, s[24:27], s48 offen offset:1024 lds
  buffer_load_dwordx4 v5, s[24:27], s48 offen offset:2048 lds
  buffer_load_dwordx4 v5, s[24:27], s48 offen offset:3072 lds
  s_add_u32 m0, s50, 4096
  s_nop 0
  buffer_load_dwordx4 v5, s[24:27], s49 offen lds
  s_add_u32 m0, s50, 5120
  s_nop 0
  buffer_load_dwordx4 v5, s[28:31], s48 offen offset:0 lds
  buffer_load_dwordx4 v5, s[28:31], s48 offen offset:1024 lds
  buffer_load_dwordx4 v5, s[28:31], s48 offen offset:2048 lds
  buffer_load_dwordx4 v5, s[28:31], s48 offen offset:3072 lds
  s_add_u32 m0, s50, 9216
  s_nop 0
  buffer_load_dwordx4 v5, s[28:31], s49 offen lds
  s_mov_b32 s10, s20
  s_mov_b32 s11, s21
  s_add_u32 s20, s20, 14680064
  s_addc_u32 s21, s21, 0
  s_add_u32 s68, s10, 6291456
  s_addc_u32 s69, s11, 0
  s_mov_b32 s70, 8388608
  s_mov_b32 s71, 0x20000
  s_mov_b32 s32, s10
  s_mov_b32 s33, s11
  s_mov_b32 s34, 2359296
  s_mov_b32 s35, 0x20000
  s_waitcnt vmcnt(0)
  s_barrier
  ds_read_u16 v16, v10 offset:0
  ds_read_u16 v20, v10 offset:5120
  ds_read_u16 v17, v10 offset:10240
  ds_read_u16 v21, v10 offset:15360
  ds_read_u16 v18, v10 offset:20480
  ds_read_u16 v22, v10 offset:25600
  ds_read_u16 v19, v10 offset:30720
  ds_read_u16 v23, v10 offset:35840
  ds_read_u16 v24, v11 offset:2
  ds_read_u16 v28, v11 offset:5122
  ds_read_u16 v25, v11 offset:10242
  ds_read_u16 v29, v11 offset:15362
  ds_read_u16 v26, v11 offset:20482
  ds_read_u16 v30, v11 offset:25602
  ds_read_u16 v27, v11 offset:30722
  ds_read_u16 v31, v11 offset:35842
  s_waitcnt lgkmcnt(8)
  v_lshl_or_b32 v16, v20, 16, v16
  v_lshl_or_b32 v17, v21, 16, v17
  v_lshl_or_b32 v18, v22, 16, v18
  v_lshl_or_b32 v19, v23, 16, v19
  s_mov_b32 s42, 0
  buffer_store_dwordx4 v[16:19], v8, s[32:35], s42 offen sc1
  ds_read_u16 v32, v11 offset:4
  ds_read_u16 v36, v11 offset:5124
  ds_read_u16 v33, v11 offset:10244
  ds_read_u16 v37, v11 offset:15364
  ds_read_u16 v34, v11 offset:20484
  ds_read_u16 v38, v11 offset:25604
  ds_read_u16 v35, v11 offset:30724
  ds_read_u16 v39, v11 offset:35844
  s_waitcnt lgkmcnt(8)
  v_lshl_or_b32 v24, v28, 16, v24
  v_lshl_or_b32 v25, v29, 16, v25
  v_lshl_or_b32 v26, v30, 16, v26
  v_lshl_or_b32 v27, v31, 16, v27
  s_mov_b32 s42, 8192
  buffer_store_dwordx4 v[24:27], v8, s[32:35], s42 offen sc1
  ds_read_u16 v40, v11 offset:6
  ds_read_u16 v44, v11 offset:5126
  ds_read_u16 v41, v11 offset:10246
  ds_read_u16 v45, v11 offset:15366
  ds_read_u16 v42, v11 offset:20486
  ds_read_u16 v46, v11 offset:25606
  ds_read_u16 v43, v11 offset:30726
  ds_read_u16 v47, v11 offset:35846
  s_waitcnt lgkmcnt(8)
  v_lshl_or_b32 v32, v36, 16, v32
  v_lshl_or_b32 v33, v37, 16, v33
  v_lshl_or_b32 v34, v38, 16, v34
  v_lshl_or_b32 v35, v39, 16, v35
  s_mov_b32 s42, 16384
  buffer_store_dwordx4 v[32:35], v8, s[32:35], s42 offen sc1
  ds_read_u16 v48, v11 offset:8
  ds_read_u16 v52, v11 offset:5128
  ds_read_u16 v49, v11 offset:10248
  ds_read_u16 v53, v11 offset:15368
  ds_read_u16 v50, v11 offset:20488
  ds_read_u16 v54, v11 offset:25608
  ds_read_u16 v51, v11 offset:30728
  ds_read_u16 v55, v11 offset:35848
  s_waitcnt lgkmcnt(8)
  v_lshl_or_b32 v40, v44, 16, v40
  v_lshl_or_b32 v41, v45, 16, v41
  v_lshl_or_b32 v42, v46, 16, v42
  v_lshl_or_b32 v43, v47, 16, v43
  s_mov_b32 s42, 24576
  buffer_store_dwordx4 v[40:43], v8, s[32:35], s42 offen sc1
  ds_read_u16 v56, v11 offset:10
  ds_read_u16 v60, v11 offset:5130
  ds_read_u16 v57, v11 offset:10250
  ds_read_u16 v61, v11 offset:15370
  ds_read_u16 v58, v11 offset:20490
  ds_read_u16 v62, v11 offset:25610
  ds_read_u16 v59, v11 offset:30730
  ds_read_u16 v63, v11 offset:35850
  s_waitcnt lgkmcnt(8)
  v_lshl_or_b32 v48, v52, 16, v48
  v_lshl_or_b32 v49, v53, 16, v49
  v_lshl_or_b32 v50, v54, 16, v50
  v_lshl_or_b32 v51, v55, 16, v51
  s_mov_b32 s42, 32768
  buffer_store_dwordx4 v[48:51], v8, s[32:35], s42 offen sc1
  ds_read_u16 v64, v11 offset:12
  ds_read_u16 v68, v11 offset:5132
  ds_read_u16 v65, v11 offset:10252
  ds_read_u16 v69, v11 offset:15372
  ds_read_u16 v66, v11 offset:20492
  ds_read_u16 v70, v11 offset:25612
  ds_read_u16 v67, v11 offset:30732
  ds_read_u16 v71, v11 offset:35852
  s_waitcnt lgkmcnt(8)
  v_lshl_or_b32 v56, v60, 16, v56
  v_lshl_or_b32 v57, v61, 16, v57
  v_lshl_or_b32 v58, v62, 16, v58
  v_lshl_or_b32 v59, v63, 16, v59
  s_mov_b32 s42, 40960
  buffer_store_dwordx4 v[56:59], v8, s[32:35], s42 offen sc1
  ds_read_u16 v72, v11 offset:14
  ds_read_u16 v76, v11 offset:5134
  ds_read_u16 v73, v11 offset:10254
  ds_read_u16 v77, v11 offset:15374
  ds_read_u16 v74, v11 offset:20494
  ds_read_u16 v78, v11 offset:25614
  ds_read_u16 v75, v11 offset:30734
  ds_read_u16 v79, v11 offset:35854
  s_waitcnt lgkmcnt(8)
  v_lshl_or_b32 v64, v68, 16, v64
  v_lshl_or_b32 v65, v69, 16, v65
  v_lshl_or_b32 v66, v70, 16, v66
  v_lshl_or_b32 v67, v71, 16, v67
  s_mov_b32 s42, 49152
  buffer_store_dwordx4 v[64:67], v8, s[32:35], s42 offen sc1
  ds_read_u16 v80, v12 offset:0
  ds_read_u16 v84, v12 offset:5120
  ds_read_u16 v81, v12 offset:10240
  ds_read_u16 v85, v12 offset:15360
  ds_read_u16 v82, v12 offset:20480
  ds_read_u16 v86, v12 offset:25600
  ds_read_u16 v83, v12 offset:30720
  ds_read_u16 v87, v12 offset:35840
  s_waitcnt lgkmcnt(8)
  v_lshl_or_b32 v72, v76, 16, v72
  v_lshl_or_b32 v73, v77, 16, v73
  v_lshl_or_b32 v74, v78, 16, v74
  v_lshl_or_b32 v75, v79, 16, v75
  s_mov_b32 s42, 57344
  buffer_store_dwordx4 v[72:75], v8, s[32:35], s42 offen sc1
  s_waitcnt lgkmcnt(0)
  v_lshl_or_b32 v80, v84, 16, v80
  v_lshl_or_b32 v81, v85, 16, v81
  v_lshl_or_b32 v82, v86, 16, v82
  v_lshl_or_b32 v83, v87, 16, v83
  buffer_store_dwordx4 v[80:83], v9, s[32:35], 0 offen sc1
  v_mov_b32 v214, 0
  global_load_dwordx2 v[212:213], v214, s[18:19] sc1
  s_mov_b32 s3, 65536
  s_waitcnt vmcnt(0)
non2:
  v_readfirstlane_b32 s101, v213
  v_readfirstlane_b32 s100, v212
  s_cmp_lg_u32 s101, 0
  s_cbranch_scc1 non2_x
  global_load_dwordx2 v[212:213], v214, s[18:19] sc1
  s_sub_u32 s3, s3, 1
  s_waitcnt vmcnt(0)
  s_cbranch_scc0 non2
non2_x:
  s_barrier
  s_cmp_lg_u32 s22, 0
  s_cbranch_scc1 p0d_done
  v_mov_b32 v4, s100
  v_mov_b32 v5, s101
  s_lshl_b32 s43, s43, 7
  s_add_u32 s43, s43, s65
  s_mov_b64 exec, 1
  s_waitcnt vmcnt(0)
  buffer_store_dwordx2 v[4:5], off, s[68:71], s43 sc1
  s_mov_b64 exec, -1
p0d_done:
  s_branch p0_end
p0_r2:
  s_sub_u32 s46, s2, 144
  s_cmp_ge_u32 s46, 108
  s_cbranch_scc1 p0_r3
p0_wp:
  s_lshr_b32 s41, s46, 3
  s_mul_i32 s42, s41, 11
  s_lshr_b32 s42, s42, 5
  s_mul_i32 s43, s42, 3
  s_sub_u32 s47, s41, s43
  s_lshl_b32 s42, s42, 3
  s_and_b32 s43, s46, 7
  s_add_u32 s42, s42, s43
  s_sub_u32 s41, s46, 96
  s_and_b32 s43, s41, 3
  s_add_u32 s43, s43, 32
  s_lshr_b32 s41, s41, 2
  s_cmp_ge_u32 s46, 96
  s_cselect_b32 s46, s43, s42
  s_cselect_b32 s47, s41, s47
  s_mul_i32 s48, s47, 3
  s_mul_i32 s56, s46, 3
  s_add_u32 s56, s56, s47
  s_add_u32 s56, s56, 1024
  s_lshl_b32 s57, s47, 4
  s_lshl_b32 s49, s40, 10
  s_mov_b32 s50, s40
  s_lshr_b32 s41, s40, 2
  s_and_b32 s40, s40, 3
  s_lshl_b32 s47, s47, 1
  s_add_u32 s47, s47, s41
  s_xor_b32 s41, s41, 1
  s_mul_i32 s53, s41, 73728
  s_lshl_b32 s41, s50, 3
  v_lshrrev_b32 v9, 3, v1
  v_add_u32 v9, s41, v9
  v_and_b32 v10, 7, v1
  s_cmp_ge_u32 s46, 27
  s_cbranch_scc1 wop_role
  v_mul_u32_u24 v9, 3456, v9
  v_bfe_u32 v4, v1, 4, 1
  v_lshlrev_b32 v4, 2, v4
  v_xor_b32 v4, v4, v10
  v_lshl_add_u32 v9, v4, 4, v9
  s_lshl_b32 s41, s46, 7
  v_add_u32 v9, s41, v9
  s_waitcnt lgkmcnt(0)
  s_mov_b32 s28, s12
  s_mov_b32 s29, s13
  s_mov_b32 s30, 1990656
  s_mov_b32 s31, 0x20000
  s_mul_i32 s42, s48, 221184
  s_mov_b32 m0, s49
  s_nop 0
  buffer_load_dwordx4 v9, s[28:31], s42 offen offset:0 lds
  s_add_u32 s42, s42, 221184
  s_add_u32 m0, m0, 8192
  s_cmp_eq_u32 s42, 1990656
  s_cselect_b32 s42, 0, s42
  buffer_load_dwordx4 v9, s[28:31], s42 offen offset:0 lds
  s_add_u32 s42, s42, 221184
  s_add_u32 m0, m0, 8192
  s_cmp_eq_u32 s42, 1990656
  s_cselect_b32 s42, 0, s42
  buffer_load_dwordx4 v9, s[28:31], s42 offen offset:0 lds
  s_add_u32 s42, s42, 221184
  s_add_u32 m0, m0, 8192
  s_cmp_eq_u32 s42, 1990656
  s_cselect_b32 s42, 0, s42
  buffer_load_dwordx4 v9, s[28:31], s42 offen offset:0 lds
  s_add_u32 s42, s42, 221184
  s_add_u32 m0, m0, 8192
  s_cmp_eq_u32 s42, 1990656
  s_cselect_b32 s42, 0, s42
  buffer_load_dwordx4 v9, s[28:31], s42 offen offset:0 lds
  s_add_u32 s42, s42, 221184
  s_add_u32 m0, m0, 8192
  s_cmp_eq_u32 s42, 1990656
  s_cselect_b32 s42, 0, s42
  buffer_load_dwordx4 v9, s[28:31], s42 offen offset:0 lds
  s_add_u32 s42, s42, 221184
  s_add_u32 m0, m0, 8192
  s_cmp_eq_u32 s42, 1990656
  s_cselect_b32 s42, 0, s42
  buffer_load_dwordx4 v9, s[28:31], s42 offen offset:0 lds
  s_add_u32 s42, s42, 221184
  s_add_u32 m0, m0, 8192
  s_cmp_eq_u32 s42, 1990656
  s_cselect_b32 s42, 0, s42
  buffer_load_dwordx4 v9, s[28:31], s42 offen offset:0 lds
  s_add_u32 s42, s42, 221184
  s_add_u32 m0, m0, 8192
  s_cmp_eq_u32 s42, 1990656
  s_cselect_b32 s42, 0, s42
  buffer_load_dwordx4 v9, s[28:31], s42 offen offset:0 lds
  s_lshl_b32 s41, s40, 3
  v_xor_b32 v4, s41, v2
  s_mul_i32 s41, s47, 96
  v_add_u32 v4, s41, v4
  s_lshl_b32 s41, s48, 6
  s_lshl_b32 s42, s40, 4
  s_add_u32 s41, s41, s42
  v_lshl_add_u32 v199, v3, 3, s41
  v_cvt_f32_u32 v199, v199
  v_lshrrev_b32 v196, 1, v4
  v_cvt_f32_u32 v196, v196
  v_and_b32 v198, 1, v4
  v_cvt_f32_u32 v198, v198
  v_mul_f32 v198, 0x3e800000, v198
  v_mov_b32 v192, 0x43900000
  v_mov_b32 v193, 0x3e000000
  v_cmp_eq_u32 vcc, 0, v4
  s_nop 1
  v_cndmask_b32 v195, v196, v192, vcc
  v_cmp_gt_u32 vcc, 2, v4
  s_nop 1
  v_cndmask_b32 v197, v198, v193, vcc
  v_mul_f32 v192, v195, v199
  v_mul_f32 v194, 0x3de38e39, v195
  v_mul_f32 v193, 0x3ae38e39, v192
  v_rndne_f32 v194, v194
  v_rndne_f32 v193, v193
  v_fmamk_f32 v194, v194, 0xc1100000, v195
  v_fmamk_f32 v192, v193, 0xc4100000, v192
  v_mul_f32 v194, 0x3de38e39, v194
  v_fmamk_f32 v128, v192, 0x3ae38e39, v197
  v_mul_f32 v193, 0x3ae38e39, v195
  v_cos_f32 v188, v194
  v_add_f32 v136, v128, v194
  v_fmamk_f32 v129, v193, 0x3f800000, v128
  v_fmamk_f32 v130, v193, 0x40000000, v128
  v_fmamk_f32 v131, v193, 0x40400000, v128
  v_fmamk_f32 v132, v193, 0x40800000, v128
  v_fmamk_f32 v133, v193, 0x40a00000, v128
  v_fmamk_f32 v134, v193, 0x40c00000, v128
  v_fmamk_f32 v135, v193, 0x40e00000, v128
  v_fmamk_f32 v137, v193, 0x3f800000, v136
  v_fmamk_f32 v138, v193, 0x40000000, v136
  v_fmamk_f32 v139, v193, 0x40400000, v136
  v_fmamk_f32 v140, v193, 0x40800000, v136
  v_fmamk_f32 v141, v193, 0x40a00000, v136
  v_fmamk_f32 v142, v193, 0x40c00000, v136
  v_fmamk_f32 v143, v193, 0x40e00000, v136
  v_add_f32 v188, v188, v188
  v_cos_f32 v128, v128
  v_cos_f32 v129, v129
  v_cos_f32 v130, v130
  v_cos_f32 v131, v131
  v_cos_f32 v132, v132
  v_cos_f32 v133, v133
  v_cos_f32 v134, v134
  v_cos_f32 v135, v135
  v_cos_f32 v136, v136
  v_cos_f32 v137, v137
  v_cos_f32 v138, v138
  v_cos_f32 v139, v139
  v_cos_f32 v140, v140
  v_cos_f32 v141, v141
  v_cos_f32 v142, v142
  v_cos_f32 v143, v143
  v_cvt_pk_bf16_f32 v176, v128, v129
  v_cvt_pk_bf16_f32 v177, v130, v131
  v_cvt_pk_bf16_f32 v178, v132, v133
  v_cvt_pk_bf16_f32 v179, v134, v135
  v_add_f32 v196, 0x41800000, v196
  v_mul_f32 v192, v196, v199
  v_mul_f32 v194, 0x3de38e39, v196
  v_mul_f32 v193, 0x3ae38e39, v192
  v_rndne_f32 v194, v194
  v_rndne_f32 v193, v193
  v_fmamk_f32 v194, v194, 0xc1100000, v196
  v_fmamk_f32 v192, v193, 0xc4100000, v192
  v_mul_f32 v194, 0x3de38e39, v194
  v_fmamk_f32 v144, v192, 0x3ae38e39, v198
  v_mul_f32 v193, 0x3ae38e39, v196
  v_cos_f32 v189, v194
  v_add_f32 v152, v144, v194
  v_fmamk_f32 v145, v193, 0x3f800000, v144
  v_fmamk_f32 v146, v193, 0x40000000, v144
  v_fmamk_f32 v147, v193, 0x40400000, v144
  v_fmamk_f32 v148, v193, 0x40800000, v144
  v_fmamk_f32 v149, v193, 0x40a00000, v144
  v_fmamk_f32 v150, v193, 0x40c00000, v144
  v_fmamk_f32 v151, v193, 0x40e00000, v144
  v_fmamk_f32 v153, v193, 0x3f800000, v152
  v_fmamk_f32 v154, v193, 0x40000000, v152
  v_fmamk_f32 v155, v193, 0x40400000, v152
  v_fmamk_f32 v156, v193, 0x40800000, v152
  v_fmamk_f32 v157, v193, 0x40a00000, v152
  v_fmamk_f32 v158, v193, 0x40c00000, v152
  v_fmamk_f32 v159, v193, 0x40e00000, v152
  v_add_f32 v189, v189, v189
  v_cos_f32 v144, v144
  v_cos_f32 v145, v145
  v_cos_f32 v146, v146
  v_cos_f32 v147, v147
  v_cos_f32 v148, v148
  v_cos_f32 v149, v149
  v_cos_f32 v150, v150
  v_cos_f32 v151, v151
  v_cos_f32 v152, v152
  v_cos_f32 v153, v153
  v_cos_f32 v154, v154
  v_cos_f32 v155, v155
  v_cos_f32 v156, v156
  v_cos_f32 v157, v157
  v_cos_f32 v158, v158
  v_cos_f32 v159, v159
  v_cvt_pk_bf16_f32 v180, v144, v145
  v_cvt_pk_bf16_f32 v181, v146, v147
  v_cvt_pk_bf16_f32 v182, v148, v149
  v_cvt_pk_bf16_f32 v183, v150, v151
  v_add_f32 v196, 0x41800000, v196
  v_mul_f32 v192, v196, v199
  v_mul_f32 v194, 0x3de38e39, v196
  v_mul_f32 v193, 0x3ae38e39, v192
  v_rndne_f32 v194, v194
  v_rndne_f32 v193, v193
  v_fmamk_f32 v194, v194, 0xc1100000, v196
  v_fmamk_f32 v192, v193, 0xc4100000, v192
  v_mul_f32 v194, 0x3de38e39, v194
  v_fmamk_f32 v160, v192, 0x3ae38e39, v198
  v_mul_f32 v193, 0x3ae38e39, v196
  v_cos_f32 v190, v194
  v_add_f32 v168, v160, v194
  v_fmamk_f32 v161, v193, 0x3f800000, v160
  v_fmamk_f32 v162, v193, 0x40000000, v160
  v_fmamk_f32 v163, v193, 0x40400000, v160
  v_fmamk_f32 v164, v193, 0x40800000, v160
  v_fmamk_f32 v165, v193, 0x40a00000, v160
  v_fmamk_f32 v166, v193, 0x40c00000, v160
  v_fmamk_f32 v167, v193, 0x40e00000, v160
  v_fmamk_f32 v169, v193, 0x3f800000, v168
  v_fmamk_f32 v170, v193, 0x40000000, v168
  v_fmamk_f32 v171, v193, 0x40400000, v168
  v_fmamk_f32 v172, v193, 0x40800000, v168
  v_fmamk_f32 v173, v193, 0x40a00000, v168
  v_fmamk_f32 v174, v193, 0x40c00000, v168
  v_fmamk_f32 v175, v193, 0x40e00000, v168
  v_add_f32 v190, v190, v190
  v_cos_f32 v160, v160
  v_cos_f32 v161, v161
  v_cos_f32 v162, v162
  v_cos_f32 v163, v163
  v_cos_f32 v164, v164
  v_cos_f32 v165, v165
  v_cos_f32 v166, v166
  v_cos_f32 v167, v167
  v_cos_f32 v168, v168
  v_cos_f32 v169, v169
  v_cos_f32 v170, v170
  v_cos_f32 v171, v171
  v_cos_f32 v172, v172
  v_cos_f32 v173, v173
  v_cos_f32 v174, v174
  v_cos_f32 v175, v175
  v_cvt_pk_bf16_f32 v184, v160, v161
  v_cvt_pk_bf16_f32 v185, v162, v163
  v_cvt_pk_bf16_f32 v186, v164, v165
  v_cvt_pk_bf16_f32 v187, v166, v167
  s_mov_b32 s10, s20
  s_mov_b32 s11, s21
  s_add_u32 s20, s20, 14680064
  s_addc_u32 s21, s21, 0
  s_add_u32 s68, s10, 6291456
  s_addc_u32 s69, s11, 0
  s_mov_b32 s70, 8388608
  s_mov_b32 s71, 0x20000
  s_add_u32 s32, s10, 2359296
  s_addc_u32 s33, s11, 0
  s_mov_b32 s34, 1990656
  s_mov_b32 s35, 0x20000
  s_lshl_b32 s41, s40, 4
  v_bfe_u32 v11, v1, 2, 2
  v_lshl_add_u32 v11, v3, 3, v11
  v_add_u32 v11, s41, v11
  v_lshlrev_b32 v11, 7, v11
  v_bfe_u32 v4, v1, 4, 1
  v_lshl_add_u32 v11, v4, 5, v11
  v_and_b32 v4, 3, v1
  v_lshl_add_u32 v11, v4, 3, v11
  v_bfe_u32 v4, v1, 3, 1
  v_lshl_add_u32 v11, v4, 6, v11
  v_xor_b32 v12, 64, v11
  v_lshlrev_b32 v8, 4, v1
  v_add_u32 v8, s53, v8
  s_xor_b32 s41, s40, 1
  s_mul_i32 s41, s41, 18432
  s_add_u32 s41, s41, 0
  v_add_u32 v5, s41, v8
  s_xor_b32 s41, s40, 2
  s_mul_i32 s41, s41, 18432
  s_add_u32 s41, s41, 6144
  v_add_u32 v6, s41, v8
  s_xor_b32 s41, s40, 3
  s_mul_i32 s41, s41, 18432
  s_add_u32 s41, s41, 12288
  v_add_u32 v7, s41, v8
  s_mul_i32 s41, s40, 18432
  v_add_u32 v8, s41, v8
  s_mov_b32 s54, 0x3d715bef
  s_cmp_lt_u32 s46, 9
  s_cselect_b32 s54, 0x3ca4258a, s54
  s_mov_b32 s55, s54
  s_mul_i32 s41, s47, 12
  s_add_u32 s41, s41, s40
  s_mul_i32 s41, s41, 1728
  s_lshl_b32 s42, s46, 6
  s_add_u32 s41, s41, s42
  v_add_u32 v13, s41, v1
  v_lshlrev_b32 v13, 4, v13
  s_or_b32 s41, s47, s40
  v_or_b32 v4, s41, v3
  v_cmp_eq_u32 vcc, 0, v4
  v_mov_b32 v14, -1
  v_mov_b32 v4, 0xffff
  v_cndmask_b32 v14, v14, v4, vcc
  s_waitcnt vmcnt(7)
  s_barrier
  ds_read_b64_tr_b16 v[112:113], v11 offset:0
  ds_read_b64_tr_b16 v[114:115], v11 offset:512
  ds_read_b64_tr_b16 v[116:117], v12 offset:0
  ds_read_b64_tr_b16 v[118:119], v12 offset:512
  ds_read_b64_tr_b16 v[120:121], v11 offset:8192
  ds_read_b64_tr_b16 v[122:123], v11 offset:8704
  ds_read_b64_tr_b16 v[124:125], v12 offset:8192
  ds_read_b64_tr_b16 v[126:127], v12 offset:8704
  s_waitcnt lgkmcnt(4)
  v_mfma_f32_32x32x16_bf16 v[16:31], v[176:179], v[112:115], 0
  v_mfma_f32_32x32x16_bf16 v[32:47], v[176:179], v[116:119], 0
  v_mfma_f32_32x32x16_bf16 v[48:63], v[180:183], v[112:115], 0
  v_cvt_pk_bf16_f32 v176, v136, v137
  v_cvt_pk_bf16_f32 v177, v138, v139
  v_cvt_pk_bf16_f32 v178, v140, v141
  v_cvt_pk_bf16_f32 v179, v142, v143
  v_mfma_f32_32x32x16_bf16 v[64:79], v[180:183], v[116:119], 0
  v_mfma_f32_32x32x16_bf16 v[80:95], v[184:187], v[112:115], 0
  v_cvt_pk_bf16_f32 v180, v152, v153
  v_cvt_pk_bf16_f32 v181, v154, v155
  v_cvt_pk_bf16_f32 v182, v156, v157
  v_cvt_pk_bf16_f32 v183, v158, v159
  v_mfma_f32_32x32x16_bf16 v[96:111], v[184:187], v[116:119], 0
  s_waitcnt vmcnt(4)
  s_barrier
  ds_read_b64_tr_b16 v[112:113], v11 offset:16384
  ds_read_b64_tr_b16 v[114:115], v11 offset:16896
  ds_read_b64_tr_b16 v[116:117], v12 offset:16384
  ds_read_b64_tr_b16 v[118:119], v12 offset:16896
  s_waitcnt lgkmcnt(4)
  v_mfma_f32_32x32x16_bf16 v[16:31], v[176:179], v[120:123], v[16:31]
  v_cvt_pk_bf16_f32 v184, v168, v169
  v_cvt_pk_bf16_f32 v185, v170, v171
  v_cvt_pk_bf16_f32 v186, v172, v173
  v_cvt_pk_bf16_f32 v187, v174, v175
  v_fma_f32 v128, v188, v136, -v128
  v_fma_f32 v129, v188, v137, -v129
  v_mfma_f32_32x32x16_bf16 v[32:47], v[176:179], v[124:127], v[32:47]
  v_fma_f32 v130, v188, v138, -v130
  v_fma_f32 v131, v188, v139, -v131
  v_fma_f32 v132, v188, v140, -v132
  v_fma_f32 v133, v188, v141, -v133
  v_fma_f32 v134, v188, v142, -v134
  v_fma_f32 v135, v188, v143, -v135
  v_mfma_f32_32x32x16_bf16 v[48:63], v[180:183], v[120:123], v[48:63]
  v_cvt_pk_bf16_f32 v176, v128, v129
  v_cvt_pk_bf16_f32 v177, v130, v131
  v_cvt_pk_bf16_f32 v178, v132, v133
  v_cvt_pk_bf16_f32 v179, v134, v135
  v_fma_f32 v144, v189, v152, -v144
  v_fma_f32 v145, v189, v153, -v145
  v_mfma_f32_32x32x16_bf16 v[64:79], v[180:183], v[124:127], v[64:79]
  v_fma_f32 v146, v189, v154, -v146
  v_fma_f32 v147, v189, v155, -v147
  v_fma_f32 v148, v189, v156, -v148
  v_fma_f32 v149, v189, v157, -v149
  v_fma_f32 v150, v189, v158, -v150
  v_fma_f32 v151, v189, v159, -v151
  v_mfma_f32_32x32x16_bf16 v[80:95], v[184:187], v[120:123], v[80:95]
  v_cvt_pk_bf16_f32 v180, v144, v145
  v_cvt_pk_bf16_f32 v181, v146, v147
  v_cvt_pk_bf16_f32 v182, v148, v149
  v_cvt_pk_bf16_f32 v183, v150, v151
  v_fma_f32 v160, v190, v168, -v160
  v_fma_f32 v161, v190, v169, -v161
  v_mfma_f32_32x32x16_bf16 v[96:111], v[184:187], v[124:127], v[96:111]
  v_fma_f32 v162, v190, v170, -v162
  v_fma_f32 v163, v190, v171, -v163
  v_fma_f32 v164, v190, v172, -v164
  v_fma_f32 v165, v190, v173, -v165
  v_fma_f32 v166, v190, v174, -v166
  v_fma_f32 v167, v190, v175, -v167
  ds_read_b64_tr_b16 v[120:121], v11 offset:24576
  ds_read_b64_tr_b16 v[122:123], v11 offset:25088
  ds_read_b64_tr_b16 v[124:125], v12 offset:24576
  ds_read_b64_tr_b16 v[126:127], v12 offset:25088
  s_waitcnt lgkmcnt(4)
  v_mfma_f32_32x32x16_bf16 v[16:31], v[176:179], v[112:115], v[16:31]
  v_cvt_pk_bf16_f32 v184, v160, v161
  v_cvt_pk_bf16_f32 v185, v162, v163
  v_cvt_pk_bf16_f32 v186, v164, v165
  v_cvt_pk_bf16_f32 v187, v166, v167
  v_fma_f32 v136, v188, v128, -v136
  v_fma_f32 v137, v188, v129, -v137
  v_mfma_f32_32x32x16_bf16 v[32:47], v[176:179], v[116:119], v[32:47]
  v_fma_f32 v138, v188, v130, -v138
  v_fma_f32 v139, v188, v131, -v139
  v_fma_f32 v140, v188, v132, -v140
  v_fma_f32 v141, v188, v133, -v141
  v_fma_f32 v142, v188, v134, -v142
  v_fma_f32 v143, v188, v135, -v143
  v_mfma_f32_32x32x16_bf16 v[48:63], v[180:183], v[112:115], v[48:63]
  v_cvt_pk_bf16_f32 v176, v136, v137
  v_cvt_pk_bf16_f32 v177, v138, v139
  v_cvt_pk_bf16_f32 v178, v140, v141
  v_cvt_pk_bf16_f32 v179, v142, v143
  v_fma_f32 v152, v189, v144, -v152
  v_fma_f32 v153, v189, v145, -v153
  v_mfma_f32_32x32x16_bf16 v[64:79], v[180:183], v[116:119], v[64:79]
  v_fma_f32 v154, v189, v146, -v154
  v_fma_f32 v155, v189, v147, -v155
  v_fma_f32 v156, v189, v148, -v156
  v_fma_f32 v157, v189, v149, -v157
  v_fma_f32 v158, v189, v150, -v158
  v_fma_f32 v159, v189, v151, -v159
  v_mfma_f32_32x32x16_bf16 v[80:95], v[184:187], v[112:115], v[80:95]
  v_cvt_pk_bf16_f32 v180, v152, v153
  v_cvt_pk_bf16_f32 v181, v154, v155
  v_cvt_pk_bf16_f32 v182, v156, v157
  v_cvt_pk_bf16_f32 v183, v158, v159
  v_fma_f32 v168, v190, v160, -v168
  v_fma_f32 v169, v190, v161, -v169
  v_mfma_f32_32x32x16_bf16 v[96:111], v[184:187], v[116:119], v[96:111]
  v_fma_f32 v170, v190, v162, -v170
  v_fma_f32 v171, v190, v163, -v171
  v_fma_f32 v172, v190, v164, -v172
  v_fma_f32 v173, v190, v165, -v173
  v_fma_f32 v174, v190, v166, -v174
  v_fma_f32 v175, v190, v167, -v175
  ds_read_b64_tr_b16 v[112:113], v11 offset:32768
  ds_read_b64_tr_b16 v[114:115], v11 offset:33280
  ds_read_b64_tr_b16 v[116:117], v12 offset:32768
  ds_read_b64_tr_b16 v[118:119], v12 offset:33280
  s_waitcnt lgkmcnt(4)
  v_mfma_f32_32x32x16_bf16 v[16:31], v[176:179], v[120:123], v[16:31]
  v_cvt_pk_bf16_f32 v184, v168, v169
  v_cvt_pk_bf16_f32 v185, v170, v171
  v_cvt_pk_bf16_f32 v186, v172, v173
  v_cvt_pk_bf16_f32 v187, v174, v175
  v_fma_f32 v128, v188, v136, -v128
  v_fma_f32 v129, v188, v137, -v129
  v_mfma_f32_32x32x16_bf16 v[32:47], v[176:179], v[124:127], v[32:47]
  v_fma_f32 v130, v188, v138, -v130
  v_fma_f32 v131, v188, v139, -v131
  v_fma_f32 v132, v188, v140, -v132
  v_fma_f32 v133, v188, v141, -v133
  v_fma_f32 v134, v188, v142, -v134
  v_fma_f32 v135, v188, v143, -v135
  v_mfma_f32_32x32x16_bf16 v[48:63], v[180:183], v[120:123], v[48:63]
  v_cvt_pk_bf16_f32 v176, v128, v129
  v_cvt_pk_bf16_f32 v177, v130, v131
  v_cvt_pk_bf16_f32 v178, v132, v133
  v_cvt_pk_bf16_f32 v179, v134, v135
  v_fma_f32 v144, v189, v152, -v144
  v_fma_f32 v145, v189, v153, -v145
  v_mfma_f32_32x32x16_bf16 v[64:79], v[180:183], v[124:127], v[64:79]
  v_fma_f32 v146, v189, v154, -v146
  v_fma_f32 v147, v189, v155, -v147
  v_fma_f32 v148, v189, v156, -v148
  v_fma_f32 v149, v189, v157, -v149
  v_fma_f32 v150, v189, v158, -v150
  v_fma_f32 v151, v189, v159, -v151
  v_mfma_f32_32x32x16_bf16 v[80:95], v[184:187], v[120:123], v[80:95]
  v_cvt_pk_bf16_f32 v180, v144, v145
  v_cvt_pk_bf16_f32 v181, v146, v147
  v_cvt_pk_bf16_f32 v182, v148, v149
  v_cvt_pk_bf16_f32 v183, v150, v151
  v_fma_f32 v160, v190, v168, -v160
  v_fma_f32 v161, v190, v169, -v161
  v_mfma_f32_32x32x16_bf16 v[96:111], v[184:187], v[124:127], v[96:111]
  v_fma_f32 v162, v190, v170, -v162
  v_fma_f32 v163, v190, v171, -v163
  v_fma_f32 v164, v190, v172, -v164
  v_fma_f32 v165, v190, v173, -v165
  v_fma_f32 v166, v190, v174, -v166
  v_fma_f32 v167, v190, v175, -v167
  s_waitcnt vmcnt(0)
  s_barrier
  ds_read_b64_tr_b16 v[120:121], v11 offset:40960
  ds_read_b64_tr_b16 v[122:123], v11 offset:41472
  ds_read_b64_tr_b16 v[124:125], v12 offset:40960
  ds_read_b64_tr_b16 v[126:127], v12 offset:41472
  s_waitcnt lgkmcnt(4)
  v_mfma_f32_32x32x16_bf16 v[16:31], v[176:179], v[112:115], v[16:31]
  v_cvt_pk_bf16_f32 v184, v160, v161
  v_cvt_pk_bf16_f32 v185, v162, v163
  v_cvt_pk_bf16_f32 v186, v164, v165
  v_cvt_pk_bf16_f32 v187, v166, v167
  v_fma_f32 v136, v188, v128, -v136
  v_fma_f32 v137, v188, v129, -v137
  v_mfma_f32_32x32x16_bf16 v[32:47], v[176:179], v[116:119], v[32:47]
  v_fma_f32 v138, v188, v130, -v138
  v_fma_f32 v139, v188, v131, -v139
  v_fma_f32 v140, v188, v132, -v140
  v_fma_f32 v141, v188, v133, -v141
  v_fma_f32 v142, v188, v134, -v142
  v_fma_f32 v143, v188, v135, -v143
  v_mfma_f32_32x32x16_bf16 v[48:63], v[180:183], v[112:115], v[48:63]
  v_cvt_pk_bf16_f32 v176, v136, v137
  v_cvt_pk_bf16_f32 v177, v138, v139
  v_cvt_pk_bf16_f32 v178, v140, v141
  v_cvt_pk_bf16_f32 v179, v142, v143
  v_fma_f32 v152, v189, v144, -v152
  v_fma_f32 v153, v189, v145, -v153
  v_mfma_f32_32x32x16_bf16 v[64:79], v[180:183], v[116:119], v[64:79]
  v_fma_f32 v154, v189, v146, -v154
  v_fma_f32 v155, v189, v147, -v155
  v_fma_f32 v156, v189, v148, -v156
  v_fma_f32 v157, v189, v149, -v157
  v_fma_f32 v158, v189, v150, -v158
  v_fma_f32 v159, v189, v151, -v159
  v_mfma_f32_32x32x16_bf16 v[80:95], v[184:187], v[112:115], v[80:95]
  v_cvt_pk_bf16_f32 v180, v152, v153
  v_cvt_pk_bf16_f32 v181, v154, v155
  v_cvt_pk_bf16_f32 v182, v156, v157
  v_cvt_pk_bf16_f32 v183, v158, v159
  v_fma_f32 v168, v190, v160, -v168
  v_fma_f32 v169, v190, v161, -v169
  v_mfma_f32_32x32x16_bf16 v[96:111], v[184:187], v[116:119], v[96:111]
  v_fma_f32 v170, v190, v162, -v170
  v_fma_f32 v171, v190, v163, -v171
  v_fma_f32 v172, v190, v164, -v172
  v_fma_f32 v173, v190, v165, -v173
  v_fma_f32 v174, v190, v166, -v174
  v_fma_f32 v175, v190, v167, -v175
  ds_read_b64_tr_b16 v[112:113], v11 offset:49152
  ds_read_b64_tr_b16 v[114:115], v11 offset:49664
  ds_read_b64_tr_b16 v[116:117], v12 offset:49152
  ds_read_b64_tr_b16 v[118:119], v12 offset:49664
  s_waitcnt lgkmcnt(4)
  v_mfma_f32_32x32x16_bf16 v[16:31], v[176:179], v[120:123], v[16:31]
  v_cvt_pk_bf16_f32 v184, v168, v169
  v_cvt_pk_bf16_f32 v185, v170, v171
  v_cvt_pk_bf16_f32 v186, v172, v173
  v_cvt_pk_bf16_f32 v187, v174, v175
  v_fma_f32 v128, v188, v136, -v128
  v_fma_f32 v129, v188, v137, -v129
  v_mfma_f32_32x32x16_bf16 v[32:47], v[176:179], v[124:127], v[32:47]
  v_fma_f32 v130, v188, v138, -v130
  v_fma_f32 v131, v188, v139, -v131
  v_fma_f32 v132, v188, v140, -v132
  v_fma_f32 v133, v188, v141, -v133
  v_fma_f32 v134, v188, v142, -v134
  v_fma_f32 v135, v188, v143, -v135
  v_mfma_f32_32x32x16_bf16 v[48:63], v[180:183], v[120:123], v[48:63]
  v_cvt_pk_bf16_f32 v176, v128, v129
  v_cvt_pk_bf16_f32 v177, v130, v131
  v_cvt_pk_bf16_f32 v178, v132, v133
  v_cvt_pk_bf16_f32 v179, v134, v135
  v_fma_f32 v144, v189, v152, -v144
  v_fma_f32 v145, v189, v153, -v145
  v_mfma_f32_32x32x16_bf16 v[64:79], v[180:183], v[124:127], v[64:79]
  v_fma_f32 v146, v189, v154, -v146
  v_fma_f32 v147, v189, v155, -v147
  v_fma_f32 v148, v189, v156, -v148
  v_fma_f32 v149, v189, v157, -v149
  v_fma_f32 v150, v189, v158, -v150
  v_fma_f32 v151, v189, v159, -v151
  v_mfma_f32_32x32x16_bf16 v[80:95], v[184:187], v[120:123], v[80:95]
  v_cvt_pk_bf16_f32 v180, v144, v145
  v_cvt_pk_bf16_f32 v181, v146, v147
  v_cvt_pk_bf16_f32 v182, v148, v149
  v_cvt_pk_bf16_f32 v183, v150, v151
  v_fma_f32 v160, v190, v168, -v160
  v_fma_f32 v161, v190, v169, -v161
  v_mfma_f32_32x32x16_bf16 v[96:111], v[184:187], v[124:127], v[96:111]
  v_fma_f32 v162, v190, v170, -v162
  v_fma_f32 v163, v190, v171, -v163
  v_fma_f32 v164, v190, v172, -v164
  v_fma_f32 v165, v190, v173, -v165
  v_fma_f32 v166, v190, v174, -v166
  v_fma_f32 v167, v190, v175, -v167
  ds_read_b64_tr_b16 v[120:121], v11 offset:57344
  ds_read_b64_tr_b16 v[122:123], v11 offset:57856
  ds_read_b64_tr_b16 v[124:125], v12 offset:57344
  ds_read_b64_tr_b16 v[126:127], v12 offset:57856
  s_waitcnt lgkmcnt(4)
  v_mfma_f32_32x32x16_bf16 v[16:31], v[176:179], v[112:115], v[16:31]
  v_cvt_pk_bf16_f32 v184, v160, v161
  v_cvt_pk_bf16_f32 v185, v162, v163
  v_cvt_pk_bf16_f32 v186, v164, v165
  v_cvt_pk_bf16_f32 v187, v166, v167
  v_fma_f32 v136, v188, v128, -v136
  v_fma_f32 v137, v188, v129, -v137
  v_mfma_f32_32x32x16_bf16 v[32:47], v[176:179], v[116:119], v[32:47]
  v_fma_f32 v138, v188, v130, -v138
  v_fma_f32 v139, v188, v131, -v139
  v_fma_f32 v140, v188, v132, -v140
  v_fma_f32 v141, v188, v133, -v141
  v_fma_f32 v142, v188, v134, -v142
  v_fma_f32 v143, v188, v135, -v143
  v_mfma_f32_32x32x16_bf16 v[48:63], v[180:183], v[112:115], v[48:63]
  v_cvt_pk_bf16_f32 v176, v136, v137
  v_cvt_pk_bf16_f32 v177, v138, v139
  v_cvt_pk_bf16_f32 v178, v140, v141
  v_cvt_pk_bf16_f32 v179, v142, v143
  v_fma_f32 v152, v189, v144, -v152
  v_fma_f32 v153, v189, v145, -v153
  v_mfma_f32_32x32x16_bf16 v[64:79], v[180:183], v[116:119], v[64:79]
  v_fma_f32 v154, v189, v146, -v154
  v_fma_f32 v155, v189, v147, -v155
  v_fma_f32 v156, v189, v148, -v156
  v_fma_f32 v157, v189, v149, -v157
  v_fma_f32 v158, v189, v150, -v158
  v_fma_f32 v159, v189, v151, -v159
  v_mfma_f32_32x32x16_bf16 v[80:95], v[184:187], v[112:115], v[80:95]
  v_cvt_pk_bf16_f32 v180, v152, v153
  v_cvt_pk_bf16_f32 v181, v154, v155
  v_cvt_pk_bf16_f32 v182, v156, v157
  v_cvt_pk_bf16_f32 v183, v158, v159
  v_fma_f32 v168, v190, v160, -v168
  v_fma_f32 v169, v190, v161, -v169
  v_mfma_f32_32x32x16_bf16 v[96:111], v[184:187], v[116:119], v[96:111]
  v_fma_f32 v170, v190, v162, -v170
  v_fma_f32 v171, v190, v163, -v171
  v_fma_f32 v172, v190, v164, -v172
  v_fma_f32 v173, v190, v165, -v173
  v_fma_f32 v174, v190, v166, -v174
  v_fma_f32 v175, v190, v167, -v175
  v_add_u32 v11, 0x10000, v11
  v_add_u32 v12, 0x10000, v12
  ds_read_b64_tr_b16 v[112:113], v11 offset:0
  ds_read_b64_tr_b16 v[114:115], v11 offset:512
  ds_read_b64_tr_b16 v[116:117], v12 offset:0
  ds_read_b64_tr_b16 v[118:119], v12 offset:512
  s_waitcnt lgkmcnt(4)
  v_mfma_f32_32x32x16_bf16 v[16:31], v[176:179], v[120:123], v[16:31]
  v_cvt_pk_bf16_f32 v184, v168, v169
  v_cvt_pk_bf16_f32 v185, v170, v171
  v_cvt_pk_bf16_f32 v186, v172, v173
  v_cvt_pk_bf16_f32 v187, v174, v175
  v_fma_f32 v128, v188, v136, -v128
  v_fma_f32 v129, v188, v137, -v129
  v_mfma_f32_32x32x16_bf16 v[32:47], v[176:179], v[124:127], v[32:47]
  v_fma_f32 v130, v188, v138, -v130
  v_fma_f32 v131, v188, v139, -v131
  v_fma_f32 v132, v188, v140, -v132
  v_fma_f32 v133, v188, v141, -v133
  v_fma_f32 v134, v188, v142, -v134
  v_fma_f32 v135, v188, v143, -v135
  v_mfma_f32_32x32x16_bf16 v[48:63], v[180:183], v[120:123], v[48:63]
  v_cvt_pk_bf16_f32 v176, v128, v129
  v_cvt_pk_bf16_f32 v177, v130, v131
  v_cvt_pk_bf16_f32 v178, v132, v133
  v_cvt_pk_bf16_f32 v179, v134, v135
  v_fma_f32 v144, v189, v152, -v144
  v_fma_f32 v145, v189, v153, -v145
  v_mfma_f32_32x32x16_bf16 v[64:79], v[180:183], v[124:127], v[64:79]
  v_fma_f32 v146, v189, v154, -v146
  v_fma_f32 v147, v189, v155, -v147
  v_fma_f32 v148, v189, v156, -v148
  v_fma_f32 v149, v189, v157, -v149
  v_fma_f32 v150, v189, v158, -v150
  v_fma_f32 v151, v189, v159, -v151
  v_mfma_f32_32x32x16_bf16 v[80:95], v[184:187], v[120:123], v[80:95]
  v_cvt_pk_bf16_f32 v180, v144, v145
  v_cvt_pk_bf16_f32 v181, v146, v147
  v_cvt_pk_bf16_f32 v182, v148, v149
  v_cvt_pk_bf16_f32 v183, v150, v151
  v_fma_f32 v160, v190, v168, -v160
  v_fma_f32 v161, v190, v169, -v161
  v_mfma_f32_32x32x16_bf16 v[96:111], v[184:187], v[124:127], v[96:111]
  v_fma_f32 v162, v190, v170, -v162
  v_fma_f32 v163, v190, v171, -v163
  v_fma_f32 v164, v190, v172, -v164
  v_fma_f32 v165, v190, v173, -v165
  v_fma_f32 v166, v190, v174, -v166
  v_fma_f32 v167, v190, v175, -v167
  s_waitcnt lgkmcnt(0)
  v_mfma_f32_32x32x16_bf16 v[16:31], v[176:179], v[112:115], v[16:31]
  v_cvt_pk_bf16_f32 v184, v160, v161
  v_cvt_pk_bf16_f32 v185, v162, v163
  v_cvt_pk_bf16_f32 v186, v164, v165
  v_cvt_pk_bf16_f32 v187, v166, v167
  v_mfma_f32_32x32x16_bf16 v[32:47], v[176:179], v[116:119], v[32:47]
  v_mfma_f32_32x32x16_bf16 v[48:63], v[180:183], v[112:115], v[48:63]
  v_mfma_f32_32x32x16_bf16 v[64:79], v[180:183], v[116:119], v[64:79]
  v_mfma_f32_32x32x16_bf16 v[80:95], v[184:187], v[112:115], v[80:95]
  v_mfma_f32_32x32x16_bf16 v[96:111], v[184:187], v[116:119], v[96:111]
  v_mov_b32 v214, 0
  global_load_dwordx2 v[212:213], v214, s[18:19] sc1
  s_barrier
  ds_write_b128 v5, v[20:23] offset:0
  ds_write_b128 v6, v[24:27] offset:0
  ds_write_b128 v7, v[28:31] offset:0
  s_nop 1
  ds_write_b128 v5, v[36:39] offset:1024
  ds_write_b128 v6, v[40:43] offset:1024
  ds_write_b128 v7, v[44:47] offset:1024
  ds_write_b128 v5, v[52:55] offset:2048
  ds_write_b128 v6, v[56:59] offset:2048
  ds_write_b128 v7, v[60:63] offset:2048
  ds_write_b128 v5, v[68:71] offset:3072
  ds_write_b128 v6, v[72:75] offset:3072
  ds_write_b128 v7, v[76:79] offset:3072
  ds_write_b128 v5, v[84:87] offset:4096
  ds_write_b128 v6, v[88:91] offset:4096
  ds_write_b128 v7, v[92:95] offset:4096
  ds_write_b128 v5, v[100:103] offset:5120
  ds_write_b128 v6, v[104:107] offset:5120
  ds_write_b128 v7, v[108:111] offset:5120
  s_waitcnt lgkmcnt(0)
  s_barrier
  ds_read_b128 v[112:115], v8 offset:0
  ds_read_b128 v[116:119], v8 offset:6144
  ds_read_b128 v[120:123], v8 offset:12288
  ds_read_b128 v[124:127], v8 offset:1024
  ds_read_b128 v[128:131], v8 offset:7168
  ds_read_b128 v[132:135], v8 offset:13312
  ds_read_b128 v[136:139], v8 offset:2048
  ds_read_b128 v[140:143], v8 offset:8192
  ds_read_b128 v[144:147], v8 offset:14336
  ds_read_b128 v[148:151], v8 offset:3072
  ds_read_b128 v[152:155], v8 offset:9216
  ds_read_b128 v[156:159], v8 offset:15360
  ds_read_b128 v[160:163], v8 offset:4096
  ds_read_b128 v[164:167], v8 offset:10240
  ds_read_b128 v[168:171], v8 offset:16384
  ds_read_b128 v[172:175], v8 offset:5120
  ds_read_b128 v[176:179], v8 offset:11264
  ds_read_b128 v[180:183], v8 offset:17408
  s_waitcnt lgkmcnt(15)
  v_pk_add_f32 v[112:113], v[112:113], v[116:117]
  v_pk_add_f32 v[16:17], v[16:17], v[120:121]
  v_pk_add_f32 v[114:115], v[114:115], v[118:119]
  v_pk_add_f32 v[18:19], v[18:19], v[122:123]
  v_pk_add_f32 v[16:17], v[16:17], v[112:113]
  v_pk_add_f32 v[18:19], v[18:19], v[114:115]
  s_waitcnt lgkmcnt(12)
  v_pk_add_f32 v[124:125], v[124:125], v[128:129]
  v_pk_add_f32 v[32:33], v[32:33], v[132:133]
  v_pk_add_f32 v[126:127], v[126:127], v[130:131]
  v_pk_add_f32 v[34:35], v[34:35], v[134:135]
  v_pk_add_f32 v[32:33], v[32:33], v[124:125]
  v_pk_add_f32 v[34:35], v[34:35], v[126:127]
  s_waitcnt lgkmcnt(9)
  v_pk_add_f32 v[136:137], v[136:137], v[140:141]
  v_pk_add_f32 v[48:49], v[48:49], v[144:145]
  v_pk_add_f32 v[138:139], v[138:139], v[142:143]
  v_pk_add_f32 v[50:51], v[50:51], v[146:147]
  v_pk_add_f32 v[48:49], v[48:49], v[136:137]
  v_pk_add_f32 v[50:51], v[50:51], v[138:139]
  s_waitcnt lgkmcnt(6)
  v_pk_add_f32 v[148:149], v[148:149], v[152:153]
  v_pk_add_f32 v[64:65], v[64:65], v[156:157]
  v_pk_add_f32 v[150:151], v[150:151], v[154:155]
  v_pk_add_f32 v[66:67], v[66:67], v[158:159]
  v_pk_add_f32 v[64:65], v[64:65], v[148:149]
  v_pk_add_f32 v[66:67], v[66:67], v[150:151]
  s_waitcnt lgkmcnt(3)
  v_pk_add_f32 v[160:161], v[160:161], v[164:165]
  v_pk_add_f32 v[80:81], v[80:81], v[168:169]
  v_pk_add_f32 v[162:163], v[162:163], v[166:167]
  v_pk_add_f32 v[82:83], v[82:83], v[170:171]
  v_pk_add_f32 v[80:81], v[80:81], v[160:161]
  v_pk_add_f32 v[82:83], v[82:83], v[162:163]
  s_waitcnt lgkmcnt(0)
  v_pk_add_f32 v[172:173], v[172:173], v[176:177]
  v_pk_add_f32 v[96:97], v[96:97], v[180:181]
  v_pk_add_f32 v[174:175], v[174:175], v[178:179]
  v_pk_add_f32 v[98:99], v[98:99], v[182:183]
  v_pk_add_f32 v[96:97], v[96:97], v[172:173]
  v_pk_add_f32 v[98:99], v[98:99], v[174:175]
  v_pk_mul_f32 v[16:17], v[16:17], s[54:55]
  v_pk_mul_f32 v[18:19], v[18:19], s[54:55]
  v_cvt_pk_bf16_f32 v192, v16, v17
  v_cvt_pk_bf16_f32 v193, v18, v19
  v_and_b32 v192, v14, v192
  v_pk_mul_f32 v[32:33], v[32:33], s[54:55]
  v_pk_mul_f32 v[34:35], v[34:35], s[54:55]
  v_cvt_pk_bf16_f32 v194, v32, v33
  v_cvt_pk_bf16_f32 v195, v34, v35
  v_and_b32 v194, v14, v194
  s_nop 1
  v_permlane32_swap_b32 v192, v194
  v_permlane32_swap_b32 v193, v195
  s_mov_b32 s42, 0
  buffer_store_dwordx4 v[192:195], v13, s[32:35], s42 offen sc1
  v_pk_mul_f32 v[48:49], v[48:49], s[54:55]
  v_pk_mul_f32 v[50:51], v[50:51], s[54:55]
  v_cvt_pk_bf16_f32 v196, v48, v49
  v_cvt_pk_bf16_f32 v197, v50, v51
  v_pk_mul_f32 v[64:65], v[64:65], s[54:55]
  v_pk_mul_f32 v[66:67], v[66:67], s[54:55]
  v_cvt_pk_bf16_f32 v198, v64, v65
  v_cvt_pk_bf16_f32 v199, v66, v67
  s_nop 0
  v_permlane32_swap_b32 v196, v198
  v_permlane32_swap_b32 v197, v199
  s_mov_b32 s42, 110592
  buffer_store_dwordx4 v[196:199], v13, s[32:35], s42 offen sc1
  v_pk_mul_f32 v[80:81], v[80:81], s[54:55]
  v_pk_mul_f32 v[82:83], v[82:83], s[54:55]
  v_cvt_pk_bf16_f32 v200, v80, v81
  v_cvt_pk_bf16_f32 v201, v82, v83
  v_pk_mul_f32 v[96:97], v[96:97], s[54:55]
  v_pk_mul_f32 v[98:99], v[98:99], s[54:55]
  v_cvt_pk_bf16_f32 v202, v96, v97
  v_cvt_pk_bf16_f32 v203, v98, v99
  s_nop 0
  v_permlane32_swap_b32 v200, v202
  v_permlane32_swap_b32 v201, v203
  s_mov_b32 s42, 221184
  buffer_store_dwordx4 v[200:203], v13, s[32:35], s42 offen sc1
  s_branch wp_pub
wop_role:
  s_sub_u32 s46, s46, 27
  s_lshl_b32 s41, s46, 6
  v_add_u32 v9, s41, v9
  s_add_u32 s56, s46, s57
  s_add_u32 s56, s56, 1152
  v_lshrrev_b32 v4, 4, v9
  v_lshl_add_u32 v4, v4, 1, v9
  v_subrev_u32 v13, 512, v9
  v_cmp_gt_u32 vcc, 512, v9
  v_and_b32 v9, 1, v13
  v_lshrrev_b32 v13, 1, v13
  v_mul_u32_u24 v13, 18, v13
  v_add3_u32 v9, v9, v13, 16
  v_cndmask_b32 v9, v9, v4, vcc
  v_mul_u32_u24 v9, 1152, v9
  s_and_b32 s41, s50, 1
  s_lshl_b32 s41, s41, 2
  v_lshrrev_b32 v4, 4, v1
  v_xor_b32 v4, v4, v10
  v_xor_b32 v4, s41, v4
  v_lshl_add_u32 v9, v4, 4, v9
  s_waitcnt lgkmcnt(0)
  s_mov_b32 s28, s14
  s_mov_b32 s29, s15
  s_mov_b32 s30, 663552
  s_mov_b32 s31, 0x20000
  s_mul_i32 s42, s48, 128
  s_mov_b32 m0, s49
  s_nop 0
  buffer_load_dwordx4 v9, s[28:31], s42 offen offset:0 lds
  s_add_u32 s42, s42, 128
  s_add_u32 m0, m0, 8192
  s_cmp_eq_u32 s42, 1152
  s_cselect_b32 s42, 0, s42
  buffer_load_dwordx4 v9, s[28:31], s42 offen offset:0 lds
  s_add_u32 s42, s42, 128
  s_add_u32 m0, m0, 8192
  s_cmp_eq_u32 s42, 1152
  s_cselect_b32 s42, 0, s42
  buffer_load_dwordx4 v9, s[28:31], s42 offen offset:0 lds
  s_add_u32 s42, s42, 128
  s_add_u32 m0, m0, 8192
  s_cmp_eq_u32 s42, 1152
  s_cselect_b32 s42, 0, s42
  buffer_load_dwordx4 v9, s[28:31], s42 offen offset:0 lds
  s_add_u32 s42, s42, 128
  s_add_u32 m0, m0, 8192
  s_cmp_eq_u32 s42, 1152
  s_cselect_b32 s42, 0, s42
  buffer_load_dwordx4 v9, s[28:31], s42 offen offset:0 lds
  s_add_u32 s42, s42, 128
  s_add_u32 m0, m0, 8192
  s_cmp_eq_u32 s42, 1152
  s_cselect_b32 s42, 0, s42
  buffer_load_dwordx4 v9, s[28:31], s42 offen offset:0 lds
  s_add_u32 s42, s42, 128
  s_add_u32 m0, m0, 8192
  s_cmp_eq_u32 s42, 1152
  s_cselect_b32 s42, 0, s42
  buffer_load_dwordx4 v9, s[28:31], s42 offen offset:0 lds
  s_add_u32 s42, s42, 128
  s_add_u32 m0, m0, 8192
  s_cmp_eq_u32 s42, 1152
  s_cselect_b32 s42, 0, s42
  buffer_load_dwordx4 v9, s[28:31], s42 offen offset:0 lds
  s_add_u32 s42, s42, 128
  s_add_u32 m0, m0, 8192
  s_cmp_eq_u32 s42, 1152
  s_cselect_b32 s42, 0, s42
  buffer_load_dwordx4 v9, s[28:31], s42 offen offset:0 lds
  v_mov_b32 v4, v2
  s_mul_i32 s41, s47, 96
  v_add_u32 v4, s41, v4
  s_lshl_b32 s41, s48, 6
  s_lshl_b32 s42, s40, 4
  s_add_u32 s41, s41, s42
  v_lshl_add_u32 v199, v3, 3, s41
  v_cvt_f32_u32 v199, v199
  v_lshrrev_b32 v196, 1, v4
  v_cvt_f32_u32 v196, v196
  v_and_b32 v198, 1, v4
  v_cvt_f32_u32 v198, v198
  v_mul_f32 v198, 0x3e800000, v198
  v_mov_b32 v192, 0x43900000
  v_mov_b32 v193, 0x3e000000
  v_cmp_eq_u32 vcc, 0, v4
  s_nop 1
  v_cndmask_b32 v195, v196, v192, vcc
  v_cmp_gt_u32 vcc, 2, v4
  s_nop 1
  v_cndmask_b32 v197, v198, v193, vcc
  v_mul_f32 v192, v195, v199
  v_mul_f32 v194, 0x3de38e39, v195
  v_mul_f32 v193, 0x3ae38e39, v192
  v_rndne_f32 v194, v194
  v_rndne_f32 v193, v193
  v_fmamk_f32 v194, v194, 0xc1100000, v195
  v_fmamk_f32 v192, v193, 0xc4100000, v192
  v_mul_f32 v194, 0x3de38e39, v194
  v_fmamk_f32 v128, v192, 0x3ae38e39, v197
  v_mul_f32 v193, 0x3ae38e39, v195
  v_cos_f32 v188, v194
  v_add_f32 v136, v128, v194
  v_fmamk_f32 v129, v193, 0x3f800000, v128
  v_fmamk_f32 v130, v193, 0x40000000, v128
  v_fmamk_f32 v131, v193, 0x40400000, v128
  v_fmamk_f32 v132, v193, 0x40800000, v128
  v_fmamk_f32 v133, v193, 0x40a00000, v128
  v_fmamk_f32 v134, v193, 0x40c00000, v128
  v_fmamk_f32 v135, v193, 0x40e00000, v128
  v_fmamk_f32 v137, v193, 0x3f800000, v136
  v_fmamk_f32 v138, v193, 0x40000000, v136
  v_fmamk_f32 v139, v193, 0x40400000, v136
  v_fmamk_f32 v140, v193, 0x40800000, v136
  v_fmamk_f32 v141, v193, 0x40a00000, v136
  v_fmamk_f32 v142, v193, 0x40c00000, v136
  v_fmamk_f32 v143, v193, 0x40e00000, v136
  v_add_f32 v188, v188, v188
  v_cos_f32 v128, v128
  v_cos_f32 v129, v129
  v_cos_f32 v130, v130
  v_cos_f32 v131, v131
  v_cos_f32 v132, v132
  v_cos_f32 v133, v133
  v_cos_f32 v134, v134
  v_cos_f32 v135, v135
  v_cos_f32 v136, v136
  v_cos_f32 v137, v137
  v_cos_f32 v138, v138
  v_cos_f32 v139, v139
  v_cos_f32 v140, v140
  v_cos_f32 v141, v141
  v_cos_f32 v142, v142
  v_cos_f32 v143, v143
  v_cvt_pk_bf16_f32 v176, v128, v129
  v_cvt_pk_bf16_f32 v177, v130, v131
  v_cvt_pk_bf16_f32 v178, v132, v133
  v_cvt_pk_bf16_f32 v179, v134, v135
  v_add_f32 v196, 0x41800000, v196
  v_mul_f32 v192, v196, v199
  v_mul_f32 v194, 0x3de38e39, v196
  v_mul_f32 v193, 0x3ae38e39, v192
  v_rndne_f32 v194, v194
  v_rndne_f32 v193, v193
  v_fmamk_f32 v194, v194, 0xc1100000, v196
  v_fmamk_f32 v192, v193, 0xc4100000, v192
  v_mul_f32 v194, 0x3de38e39, v194
  v_fmamk_f32 v144, v192, 0x3ae38e39, v198
  v_mul_f32 v193, 0x3ae38e39, v196
  v_cos_f32 v189, v194
  v_add_f32 v152, v144, v194
  v_fmamk_f32 v145, v193, 0x3f800000, v144
  v_fmamk_f32 v146, v193, 0x40000000, v144
  v_fmamk_f32 v147, v193, 0x40400000, v144
  v_fmamk_f32 v148, v193, 0x40800000, v144
  v_fmamk_f32 v149, v193, 0x40a00000, v144
  v_fmamk_f32 v150, v193, 0x40c00000, v144
  v_fmamk_f32 v151, v193, 0x40e00000, v144
  v_fmamk_f32 v153, v193, 0x3f800000, v152
  v_fmamk_f32 v154, v193, 0x40000000, v152
  v_fmamk_f32 v155, v193, 0x40400000, v152
  v_fmamk_f32 v156, v193, 0x40800000, v152
  v_fmamk_f32 v157, v193, 0x40a00000, v152
  v_fmamk_f32 v158, v193, 0x40c00000, v152
  v_fmamk_f32 v159, v193, 0x40e00000, v152
  v_add_f32 v189, v189, v189
  v_cos_f32 v144, v144
  v_cos_f32 v145, v145
  v_cos_f32 v146, v146
  v_cos_f32 v147, v147
  v_cos_f32 v148, v148
  v_cos_f32 v149, v149
  v_cos_f32 v150, v150
  v_cos_f32 v151, v151
  v_cos_f32 v152, v152
  v_cos_f32 v153, v153
  v_cos_f32 v154, v154
  v_cos_f32 v155, v155
  v_cos_f32 v156, v156
  v_cos_f32 v157, v157
  v_cos_f32 v158, v158
  v_cos_f32 v159, v159
  v_cvt_pk_bf16_f32 v180, v144, v145
  v_cvt_pk_bf16_f32 v181, v146, v147
  v_cvt_pk_bf16_f32 v182, v148, v149
  v_cvt_pk_bf16_f32 v183, v150, v151
  v_add_f32 v196, 0x41800000, v196
  v_mul_f32 v192, v196, v199
  v_mul_f32 v194, 0x3de38e39, v196
  v_mul_f32 v193, 0x3ae38e39, v192
  v_rndne_f32 v194, v194
  v_rndne_f32 v193, v193
  v_fmamk_f32 v194, v194, 0xc1100000, v196
  v_fmamk_f32 v192, v193, 0xc4100000, v192
  v_mul_f32 v194, 0x3de38e39, v194
  v_fmamk_f32 v160, v192, 0x3ae38e39, v198
  v_mul_f32 v193, 0x3ae38e39, v196
  v_cos_f32 v190, v194
  v_add_f32 v168, v160, v194
  v_fmamk_f32 v161, v193, 0x3f800000, v160
  v_fmamk_f32 v162, v193, 0x40000000, v160
  v_fmamk_f32 v163, v193, 0x40400000, v160
  v_fmamk_f32 v164, v193, 0x40800000, v160
  v_fmamk_f32 v165, v193, 0x40a00000, v160
  v_fmamk_f32 v166, v193, 0x40c00000, v160
  v_fmamk_f32 v167, v193, 0x40e00000, v160
  v_fmamk_f32 v169, v193, 0x3f800000, v168
  v_fmamk_f32 v170, v193, 0x40000000, v168
  v_fmamk_f32 v171, v193, 0x40400000, v168
  v_fmamk_f32 v172, v193, 0x40800000, v168
  v_fmamk_f32 v173, v193, 0x40a00000, v168
  v_fmamk_f32 v174, v193, 0x40c00000, v168
  v_fmamk_f32 v175, v193, 0x40e00000, v168
  v_add_f32 v190, v190, v190
  v_cos_f32 v160, v160
  v_cos_f32 v161, v161
  v_cos_f32 v162, v162
  v_cos_f32 v163, v163
  v_cos_f32 v164, v164
  v_cos_f32 v165, v165
  v_cos_f32 v166, v166
  v_cos_f32 v167, v167
  v_cos_f32 v168, v168
  v_cos_f32 v169, v169
  v_cos_f32 v170, v170
  v_cos_f32 v171, v171
  v_cos_f32 v172, v172
  v_cos_f32 v173, v173
  v_cos_f32 v174, v174
  v_cos_f32 v175, v175
  v_cvt_pk_bf16_f32 v184, v160, v161
  v_cvt_pk_bf16_f32 v185, v162, v163
  v_cvt_pk_bf16_f32 v186, v164, v165
  v_cvt_pk_bf16_f32 v187, v166, v167
  s_mov_b32 s10, s20
  s_mov_b32 s11, s21
  s_add_u32 s20, s20, 14680064
  s_addc_u32 s21, s21, 0
  s_add_u32 s68, s10, 6291456
  s_addc_u32 s69, s11, 0
  s_mov_b32 s70, 8388608
  s_mov_b32 s71, 0x20000
  s_add_u32 s32, s10, 4718592
  s_addc_u32 s33, s11, 0
  s_mov_b32 s34, 663552
  s_mov_b32 s35, 0x20000
  s_lshl_b32 s41, s40, 3
  v_xor_b32 v11, s41, v2
  s_lshl_b32 s41, s40, 1
  v_bfe_u32 v4, v11, 1, 3
  v_xor_b32 v4, s41, v4
  v_xor_b32 v4, v3, v4
  v_lshlrev_b32 v11, 7, v11
  v_lshl_add_u32 v11, v4, 4, v11
  v_lshlrev_b32 v8, 4, v1
  v_add_u32 v8, s53, v8
  s_xor_b32 s41, s40, 1
  s_mul_i32 s41, s41, 18432
  s_add_u32 s41, s41, 0
  v_add_u32 v5, s41, v8
  s_xor_b32 s41, s40, 2
  s_mul_i32 s41, s41, 18432
  s_add_u32 s41, s41, 6144
  v_add_u32 v6, s41, v8
  s_xor_b32 s41, s40, 3
  s_mul_i32 s41, s41, 18432
  s_add_u32 s41, s41, 12288
  v_add_u32 v7, s41, v8
  s_mul_i32 s41, s40, 18432
  v_add_u32 v8, s41, v8
  s_lshl_b32 s41, s46, 3
  s_add_u32 s41, s41, s40
  s_mul_i32 s41, s41, 576
  s_mul_i32 s42, s47, 96
  s_add_u32 s41, s41, s42
  v_mul_u32_u24 v13, 2304, v3
  v_add3_u32 v13, v13, v2, s41
  v_lshlrev_b32 v13, 4, v13
  s_mov_b32 s54, 0x3d715bef
  s_mov_b32 s55, s54
  s_waitcnt vmcnt(7)
  s_barrier
  ds_read_b128 v[112:115], v11 offset:0
  ds_read_b128 v[116:119], v11 offset:4096
  ds_read_b128 v[120:123], v11 offset:8192
  ds_read_b128 v[124:127], v11 offset:12288
  s_waitcnt lgkmcnt(2)
  v_mfma_f32_32x32x16_bf16 v[16:31], v[112:115], v[176:179], 0
  v_mfma_f32_32x32x16_bf16 v[32:47], v[116:119], v[176:179], 0
  v_mfma_f32_32x32x16_bf16 v[48:63], v[112:115], v[180:183], 0
  v_cvt_pk_bf16_f32 v176, v136, v137
  v_cvt_pk_bf16_f32 v177, v138, v139
  v_cvt_pk_bf16_f32 v178, v140, v141
  v_cvt_pk_bf16_f32 v179, v142, v143
  v_mfma_f32_32x32x16_bf16 v[64:79], v[116:119], v[180:183], 0
  v_mfma_f32_32x32x16_bf16 v[80:95], v[112:115], v[184:187], 0
  v_cvt_pk_bf16_f32 v180, v152, v153
  v_cvt_pk_bf16_f32 v181, v154, v155
  v_cvt_pk_bf16_f32 v182, v156, v157
  v_cvt_pk_bf16_f32 v183, v158, v159
  v_mfma_f32_32x32x16_bf16 v[96:111], v[116:119], v[184:187], 0
  s_waitcnt vmcnt(4)
  s_barrier
  ds_read_b128 v[112:115], v11 offset:16384
  ds_read_b128 v[116:119], v11 offset:20480
  s_waitcnt lgkmcnt(2)
  v_mfma_f32_32x32x16_bf16 v[16:31], v[120:123], v[176:179], v[16:31]
  v_cvt_pk_bf16_f32 v184, v168, v169
  v_cvt_pk_bf16_f32 v185, v170, v171
  v_cvt_pk_bf16_f32 v186, v172, v173
  v_cvt_pk_bf16_f32 v187, v174, v175
  v_fma_f32 v128, v188, v136, -v128
  v_fma_f32 v129, v188, v137, -v129
  v_mfma_f32_32x32x16_bf16 v[32:47], v[124:127], v[176:179], v[32:47]
  v_fma_f32 v130, v188, v138, -v130
  v_fma_f32 v131, v188, v139, -v131
  v_fma_f32 v132, v188, v140, -v132
  v_fma_f32 v133, v188, v141, -v133
  v_fma_f32 v134, v188, v142, -v134
  v_fma_f32 v135, v188, v143, -v135
  v_mfma_f32_32x32x16_bf16 v[48:63], v[120:123], v[180:183], v[48:63]
  v_cvt_pk_bf16_f32 v176, v128, v129
  v_cvt_pk_bf16_f32 v177, v130, v131
  v_cvt_pk_bf16_f32 v178, v132, v133
  v_cvt_pk_bf16_f32 v179, v134, v135
  v_fma_f32 v144, v189, v152, -v144
  v_fma_f32 v145, v189, v153, -v145
  v_mfma_f32_32x32x16_bf16 v[64:79], v[124:127], v[180:183], v[64:79]
  v_fma_f32 v146, v189, v154, -v146
  v_fma_f32 v147, v189, v155, -v147
  v_fma_f32 v148, v189, v156, -v148
  v_fma_f32 v149, v189, v157, -v149
  v_fma_f32 v150, v189, v158, -v150
  v_fma_f32 v151, v189, v159, -v151
  v_mfma_f32_32x32x16_bf16 v[80:95], v[120:123], v[184:187], v[80:95]
  v_cvt_pk_bf16_f32 v180, v144, v145
  v_cvt_pk_bf16_f32 v181, v146, v147
  v_cvt_pk_bf16_f32 v182, v148, v149
  v_cvt_pk_bf16_f32 v183, v150, v151
  v_fma_f32 v160, v190, v168, -v160
  v_fma_f32 v161, v190, v169, -v161
  v_mfma_f32_32x32x16_bf16 v[96:111], v[124:127], v[184:187], v[96:111]
  v_fma_f32 v162, v190, v170, -v162
  v_fma_f32 v163, v190, v171, -v163
  v_fma_f32 v164, v190, v172, -v164
  v_fma_f32 v165, v190, v173, -v165
  v_fma_f32 v166, v190, v174, -v166
  v_fma_f32 v167, v190, v175, -v167
  ds_read_b128 v[120:123], v11 offset:24576
  ds_read_b128 v[124:127], v11 offset:28672
  s_waitcnt lgkmcnt(2)
  v_mfma_f32_32x32x16_bf16 v[16:31], v[112:115], v[176:179], v[16:31]
  v_cvt_pk_bf16_f32 v184, v160, v161
  v_cvt_pk_bf16_f32 v185, v162, v163
  v_cvt_pk_bf16_f32 v186, v164, v165
  v_cvt_pk_bf16_f32 v187, v166, v167
  v_fma_f32 v136, v188, v128, -v136
  v_fma_f32 v137, v188, v129, -v137
  v_mfma_f32_32x32x16_bf16 v[32:47], v[116:119], v[176:179], v[32:47]
  v_fma_f32 v138, v188, v130, -v138
  v_fma_f32 v139, v188, v131, -v139
  v_fma_f32 v140, v188, v132, -v140
  v_fma_f32 v141, v188, v133, -v141
  v_fma_f32 v142, v188, v134, -v142
  v_fma_f32 v143, v188, v135, -v143
  v_mfma_f32_32x32x16_bf16 v[48:63], v[112:115], v[180:183], v[48:63]
  v_cvt_pk_bf16_f32 v176, v136, v137
  v_cvt_pk_bf16_f32 v177, v138, v139
  v_cvt_pk_bf16_f32 v178, v140, v141
  v_cvt_pk_bf16_f32 v179, v142, v143
  v_fma_f32 v152, v189, v144, -v152
  v_fma_f32 v153, v189, v145, -v153
  v_mfma_f32_32x32x16_bf16 v[64:79], v[116:119], v[180:183], v[64:79]
  v_fma_f32 v154, v189, v146, -v154
  v_fma_f32 v155, v189, v147, -v155
  v_fma_f32 v156, v189, v148, -v156
  v_fma_f32 v157, v189, v149, -v157
  v_fma_f32 v158, v189, v150, -v158
  v_fma_f32 v159, v189, v151, -v159
  v_mfma_f32_32x32x16_bf16 v[80:95], v[112:115], v[184:187], v[80:95]
  v_cvt_pk_bf16_f32 v180, v152, v153
  v_cvt_pk_bf16_f32 v181, v154, v155
  v_cvt_pk_bf16_f32 v182, v156, v157
  v_cvt_pk_bf16_f32 v183, v158, v159
  v_fma_f32 v168, v190, v160, -v168
  v_fma_f32 v169, v190, v161, -v169
  v_mfma_f32_32x32x16_bf16 v[96:111], v[116:119], v[184:187], v[96:111]
  v_fma_f32 v170, v190, v162, -v170
  v_fma_f32 v171, v190, v163, -v171
  v_fma_f32 v172, v190, v164, -v172
  v_fma_f32 v173, v190, v165, -v173
  v_fma_f32 v174, v190, v166, -v174
  v_fma_f32 v175, v190, v167, -v175
  ds_read_b128 v[112:115], v11 offset:32768
  ds_read_b128 v[116:119], v11 offset:36864
  s_waitcnt lgkmcnt(2)
  v_mfma_f32_32x32x16_bf16 v[16:31], v[120:123], v[176:179], v[16:31]
  v_cvt_pk_bf16_f32 v184, v168, v169
  v_cvt_pk_bf16_f32 v185, v170, v171
  v_cvt_pk_bf16_f32 v186, v172, v173
  v_cvt_pk_bf16_f32 v187, v174, v175
  v_fma_f32 v128, v188, v136, -v128
  v_fma_f32 v129, v188, v137, -v129
  v_mfma_f32_32x32x16_bf16 v[32:47], v[124:127], v[176:179], v[32:47]
  v_fma_f32 v130, v188, v138, -v130
  v_fma_f32 v131, v188, v139, -v131
  v_fma_f32 v132, v188, v140, -v132
  v_fma_f32 v133, v188, v141, -v133
  v_fma_f32 v134, v188, v142, -v134
  v_fma_f32 v135, v188, v143, -v135
  v_mfma_f32_32x32x16_bf16 v[48:63], v[120:123], v[180:183], v[48:63]
  v_cvt_pk_bf16_f32 v176, v128, v129
  v_cvt_pk_bf16_f32 v177, v130, v131
  v_cvt_pk_bf16_f32 v178, v132, v133
  v_cvt_pk_bf16_f32 v179, v134, v135
  v_fma_f32 v144, v189, v152, -v144
  v_fma_f32 v145, v189, v153, -v145
  v_mfma_f32_32x32x16_bf16 v[64:79], v[124:127], v[180:183], v[64:79]
  v_fma_f32 v146, v189, v154, -v146
  v_fma_f32 v147, v189, v155, -v147
  v_fma_f32 v148, v189, v156, -v148
  v_fma_f32 v149, v189, v157, -v149
  v_fma_f32 v150, v189, v158, -v150
  v_fma_f32 v151, v189, v159, -v151
  v_mfma_f32_32x32x16_bf16 v[80:95], v[120:123], v[184:187], v[80:95]
  v_cvt_pk_bf16_f32 v180, v144, v145
  v_cvt_pk_bf16_f32 v181, v146, v147
  v_cvt_pk_bf16_f32 v182, v148, v149
  v_cvt_pk_bf16_f32 v183, v150, v151
  v_fma_f32 v160, v190, v168, -v160
  v_fma_f32 v161, v190, v169, -v161
  v_mfma_f32_32x32x16_bf16 v[96:111], v[124:127], v[184:187], v[96:111]
  v_fma_f32 v162, v190, v170, -v162
  v_fma_f32 v163, v190, v171, -v163
  v_fma_f32 v164, v190, v172, -v164
  v_fma_f32 v165, v190, v173, -v165
  v_fma_f32 v166, v190, v174, -v166
  v_fma_f32 v167, v190, v175, -v167
  s_waitcnt vmcnt(0)
  s_barrier
  ds_read_b128 v[120:123], v11 offset:40960
  ds_read_b128 v[124:127], v11 offset:45056
  s_waitcnt lgkmcnt(2)
  v_mfma_f32_32x32x16_bf16 v[16:31], v[112:115], v[176:179], v[16:31]
  v_cvt_pk_bf16_f32 v184, v160, v161
  v_cvt_pk_bf16_f32 v185, v162, v163
  v_cvt_pk_bf16_f32 v186, v164, v165
  v_cvt_pk_bf16_f32 v187, v166, v167
  v_fma_f32 v136, v188, v128, -v136
  v_fma_f32 v137, v188, v129, -v137
  v_mfma_f32_32x32x16_bf16 v[32:47], v[116:119], v[176:179], v[32:47]
  v_fma_f32 v138, v188, v130, -v138
  v_fma_f32 v139, v188, v131, -v139
  v_fma_f32 v140, v188, v132, -v140
  v_fma_f32 v141, v188, v133, -v141
  v_fma_f32 v142, v188, v134, -v142
  v_fma_f32 v143, v188, v135, -v143
  v_mfma_f32_32x32x16_bf16 v[48:63], v[112:115], v[180:183], v[48:63]
  v_cvt_pk_bf16_f32 v176, v136, v137
  v_cvt_pk_bf16_f32 v177, v138, v139
  v_cvt_pk_bf16_f32 v178, v140, v141
  v_cvt_pk_bf16_f32 v179, v142, v143
  v_fma_f32 v152, v189, v144, -v152
  v_fma_f32 v153, v189, v145, -v153
  v_mfma_f32_32x32x16_bf16 v[64:79], v[116:119], v[180:183], v[64:79]
  v_fma_f32 v154, v189, v146, -v154
  v_fma_f32 v155, v189, v147, -v155
  v_fma_f32 v156, v189, v148, -v156
  v_fma_f32 v157, v189, v149, -v157
  v_fma_f32 v158, v189, v150, -v158
  v_fma_f32 v159, v189, v151, -v159
  v_mfma_f32_32x32x16_bf16 v[80:95], v[112:115], v[184:187], v[80:95]
  v_cvt_pk_bf16_f32 v180, v152, v153
  v_cvt_pk_bf16_f32 v181, v154, v155
  v_cvt_pk_bf16_f32 v182, v156, v157
  v_cvt_pk_bf16_f32 v183, v158, v159
  v_fma_f32 v168, v190, v160, -v168
  v_fma_f32 v169, v190, v161, -v169
  v_mfma_f32_32x32x16_bf16 v[96:111], v[116:119], v[184:187], v[96:111]
  v_fma_f32 v170, v190, v162, -v170
  v_fma_f32 v171, v190, v163, -v171
  v_fma_f32 v172, v190, v164, -v172
  v_fma_f32 v173, v190, v165, -v173
  v_fma_f32 v174, v190, v166, -v174
  v_fma_f32 v175, v190, v167, -v175
  ds_read_b128 v[112:115], v11 offset:49152
  ds_read_b128 v[116:119], v11 offset:53248
  s_waitcnt lgkmcnt(2)
  v_mfma_f32_32x32x16_bf16 v[16:31], v[120:123], v[176:179], v[16:31]
  v_cvt_pk_bf16_f32 v184, v168, v169
  v_cvt_pk_bf16_f32 v185, v170, v171
  v_cvt_pk_bf16_f32 v186, v172, v173
  v_cvt_pk_bf16_f32 v187, v174, v175
  v_fma_f32 v128, v188, v136, -v128
  v_fma_f32 v129, v188, v137, -v129
  v_mfma_f32_32x32x16_bf16 v[32:47], v[124:127], v[176:179], v[32:47]
  v_fma_f32 v130, v188, v138, -v130
  v_fma_f32 v131, v188, v139, -v131
  v_fma_f32 v132, v188, v140, -v132
  v_fma_f32 v133, v188, v141, -v133
  v_fma_f32 v134, v188, v142, -v134
  v_fma_f32 v135, v188, v143, -v135
  v_mfma_f32_32x32x16_bf16 v[48:63], v[120:123], v[180:183], v[48:63]
  v_cvt_pk_bf16_f32 v176, v128, v129
  v_cvt_pk_bf16_f32 v177, v130, v131
  v_cvt_pk_bf16_f32 v178, v132, v133
  v_cvt_pk_bf16_f32 v179, v134, v135
  v_fma_f32 v144, v189, v152, -v144
  v_fma_f32 v145, v189, v153, -v145
  v_mfma_f32_32x32x16_bf16 v[64:79], v[124:127], v[180:183], v[64:79]
  v_fma_f32 v146, v189, v154, -v146
  v_fma_f32 v147, v189, v155, -v147
  v_fma_f32 v148, v189, v156, -v148
  v_fma_f32 v149, v189, v157, -v149
  v_fma_f32 v150, v189, v158, -v150
  v_fma_f32 v151, v189, v159, -v151
  v_mfma_f32_32x32x16_bf16 v[80:95], v[120:123], v[184:187], v[80:95]
  v_cvt_pk_bf16_f32 v180, v144, v145
  v_cvt_pk_bf16_f32 v181, v146, v147
  v_cvt_pk_bf16_f32 v182, v148, v149
  v_cvt_pk_bf16_f32 v183, v150, v151
  v_fma_f32 v160, v190, v168, -v160
  v_fma_f32 v161, v190, v169, -v161
  v_mfma_f32_32x32x16_bf16 v[96:111], v[124:127], v[184:187], v[96:111]
  v_fma_f32 v162, v190, v170, -v162
  v_fma_f32 v163, v190, v171, -v163
  v_fma_f32 v164, v190, v172, -v164
  v_fma_f32 v165, v190, v173, -v165
  v_fma_f32 v166, v190, v174, -v166
  v_fma_f32 v167, v190, v175, -v167
  ds_read_b128 v[120:123], v11 offset:57344
  ds_read_b128 v[124:127], v11 offset:61440
  s_waitcnt lgkmcnt(2)
  v_mfma_f32_32x32x16_bf16 v[16:31], v[112:115], v[176:179], v[16:31]
  v_cvt_pk_bf16_f32 v184, v160, v161
  v_cvt_pk_bf16_f32 v185, v162, v163
  v_cvt_pk_bf16_f32 v186, v164, v165
  v_cvt_pk_bf16_f32 v187, v166, v167
  v_fma_f32 v136, v188, v128, -v136
  v_fma_f32 v137, v188, v129, -v137
  v_mfma_f32_32x32x16_bf16 v[32:47], v[116:119], v[176:179], v[32:47]
  v_fma_f32 v138, v188, v130, -v138
  v_fma_f32 v139, v188, v131, -v139
  v_fma_f32 v140, v188, v132, -v140
  v_fma_f32 v141, v188, v133, -v141
  v_fma_f32 v142, v188, v134, -v142
  v_fma_f32 v143, v188, v135, -v143
  v_mfma_f32_32x32x16_bf16 v[48:63], v[112:115], v[180:183], v[48:63]
  v_cvt_pk_bf16_f32 v176, v136, v137
  v_cvt_pk_bf16_f32 v177, v138, v139
  v_cvt_pk_bf16_f32 v178, v140, v141
  v_cvt_pk_bf16_f32 v179, v142, v143
  v_fma_f32 v152, v189, v144, -v152
  v_fma_f32 v153, v189, v145, -v153
  v_mfma_f32_32x32x16_bf16 v[64:79], v[116:119], v[180:183], v[64:79]
  v_fma_f32 v154, v189, v146, -v154
  v_fma_f32 v155, v189, v147, -v155
  v_fma_f32 v156, v189, v148, -v156
  v_fma_f32 v157, v189, v149, -v157
  v_fma_f32 v158, v189, v150, -v158
  v_fma_f32 v159, v189, v151, -v159
  v_mfma_f32_32x32x16_bf16 v[80:95], v[112:115], v[184:187], v[80:95]
  v_cvt_pk_bf16_f32 v180, v152, v153
  v_cvt_pk_bf16_f32 v181, v154, v155
  v_cvt_pk_bf16_f32 v182, v156, v157
  v_cvt_pk_bf16_f32 v183, v158, v159
  v_fma_f32 v168, v190, v160, -v168
  v_fma_f32 v169, v190, v161, -v169
  v_mfma_f32_32x32x16_bf16 v[96:111], v[116:119], v[184:187], v[96:111]
  v_fma_f32 v170, v190, v162, -v170
  v_fma_f32 v171, v190, v163, -v171
  v_fma_f32 v172, v190, v164, -v172
  v_fma_f32 v173, v190, v165, -v173
  v_fma_f32 v174, v190, v166, -v174
  v_fma_f32 v175, v190, v167, -v175
  v_add_u32 v11, 0x10000, v11
  ds_read_b128 v[112:115], v11 offset:0
  ds_read_b128 v[116:119], v11 offset:4096
  s_waitcnt lgkmcnt(2)
  v_mfma_f32_32x32x16_bf16 v[16:31], v[120:123], v[176:179], v[16:31]
  v_cvt_pk_bf16_f32 v184, v168, v169
  v_cvt_pk_bf16_f32 v185, v170, v171
  v_cvt_pk_bf16_f32 v186, v172, v173
  v_cvt_pk_bf16_f32 v187, v174, v175
  v_fma_f32 v128, v188, v136, -v128
  v_fma_f32 v129, v188, v137, -v129
  v_mfma_f32_32x32x16_bf16 v[32:47], v[124:127], v[176:179], v[32:47]
  v_fma_f32 v130, v188, v138, -v130
  v_fma_f32 v131, v188, v139, -v131
  v_fma_f32 v132, v188, v140, -v132
  v_fma_f32 v133, v188, v141, -v133
  v_fma_f32 v134, v188, v142, -v134
  v_fma_f32 v135, v188, v143, -v135
  v_mfma_f32_32x32x16_bf16 v[48:63], v[120:123], v[180:183], v[48:63]
  v_cvt_pk_bf16_f32 v176, v128, v129
  v_cvt_pk_bf16_f32 v177, v130, v131
  v_cvt_pk_bf16_f32 v178, v132, v133
  v_cvt_pk_bf16_f32 v179, v134, v135
  v_fma_f32 v144, v189, v152, -v144
  v_fma_f32 v145, v189, v153, -v145
  v_mfma_f32_32x32x16_bf16 v[64:79], v[124:127], v[180:183], v[64:79]
  v_fma_f32 v146, v189, v154, -v146
  v_fma_f32 v147, v189, v155, -v147
  v_fma_f32 v148, v189, v156, -v148
  v_fma_f32 v149, v189, v157, -v149
  v_fma_f32 v150, v189, v158, -v150
  v_fma_f32 v151, v189, v159, -v151
  v_mfma_f32_32x32x16_bf16 v[80:95], v[120:123], v[184:187], v[80:95]
  v_cvt_pk_bf16_f32 v180, v144, v145
  v_cvt_pk_bf16_f32 v181, v146, v147
  v_cvt_pk_bf16_f32 v182, v148, v149
  v_cvt_pk_bf16_f32 v183, v150, v151
  v_fma_f32 v160, v190, v168, -v160
  v_fma_f32 v161, v190, v169, -v161
  v_mfma_f32_32x32x16_bf16 v[96:111], v[124:127], v[184:187], v[96:111]
  v_fma_f32 v162, v190, v170, -v162
  v_fma_f32 v163, v190, v171, -v163
  v_fma_f32 v164, v190, v172, -v164
  v_fma_f32 v165, v190, v173, -v165
  v_fma_f32 v166, v190, v174, -v166
  v_fma_f32 v167, v190, v175, -v167
  s_waitcnt lgkmcnt(0)
  v_mfma_f32_32x32x16_bf16 v[16:31], v[112:115], v[176:179], v[16:31]
  v_cvt_pk_bf16_f32 v184, v160, v161
  v_cvt_pk_bf16_f32 v185, v162, v163
  v_cvt_pk_bf16_f32 v186, v164, v165
  v_cvt_pk_bf16_f32 v187, v166, v167
  v_mfma_f32_32x32x16_bf16 v[32:47], v[116:119], v[176:179], v[32:47]
  v_mfma_f32_32x32x16_bf16 v[48:63], v[112:115], v[180:183], v[48:63]
  v_mfma_f32_32x32x16_bf16 v[64:79], v[116:119], v[180:183], v[64:79]
  v_mfma_f32_32x32x16_bf16 v[80:95], v[112:115], v[184:187], v[80:95]
  v_mfma_f32_32x32x16_bf16 v[96:111], v[116:119], v[184:187], v[96:111]
  v_mov_b32 v214, 0
  global_load_dwordx2 v[212:213], v214, s[18:19] sc1
  s_barrier
  ds_write_b128 v5, v[20:23] offset:0
  ds_write_b128 v6, v[24:27] offset:0
  ds_write_b128 v7, v[28:31] offset:0
  s_nop 1
  ds_write_b128 v5, v[36:39] offset:1024
  ds_write_b128 v6, v[40:43] offset:1024
  ds_write_b128 v7, v[44:47] offset:1024
  ds_write_b128 v5, v[52:55] offset:2048
  ds_write_b128 v6, v[56:59] offset:2048
  ds_write_b128 v7, v[60:63] offset:2048
  ds_write_b128 v5, v[68:71] offset:3072
  ds_write_b128 v6, v[72:75] offset:3072
  ds_write_b128 v7, v[76:79] offset:3072
  ds_write_b128 v5, v[84:87] offset:4096
  ds_write_b128 v6, v[88:91] offset:4096
  ds_write_b128 v7, v[92:95] offset:4096
  ds_write_b128 v5, v[100:103] offset:5120
  ds_write_b128 v6, v[104:107] offset:5120
  ds_write_b128 v7, v[108:111] offset:5120
  s_waitcnt lgkmcnt(0)
  s_barrier
  ds_read_b128 v[112:115], v8 offset:0
  ds_read_b128 v[116:119], v8 offset:6144
  ds_read_b128 v[120:123], v8 offset:12288
  ds_read_b128 v[124:127], v8 offset:1024
  ds_read_b128 v[128:131], v8 offset:7168
  ds_read_b128 v[132:135], v8 offset:13312
  ds_read_b128 v[136:139], v8 offset:2048
  ds_read_b128 v[140:143], v8 offset:8192
  ds_read_b128 v[144:147], v8 offset:14336
  ds_read_b128 v[148:151], v8 offset:3072
  ds_read_b128 v[152:155], v8 offset:9216
  ds_read_b128 v[156:159], v8 offset:15360
  ds_read_b128 v[160:163], v8 offset:4096
  ds_read_b128 v[164:167], v8 offset:10240
  ds_read_b128 v[168:171], v8 offset:16384
  ds_read_b128 v[172:175], v8 offset:5120
  ds_read_b128 v[176:179], v8 offset:11264
  ds_read_b128 v[180:183], v8 offset:17408
  s_waitcnt lgkmcnt(15)
  v_pk_add_f32 v[112:113], v[112:113], v[116:117]
  v_pk_add_f32 v[16:17], v[16:17], v[120:121]
  v_pk_add_f32 v[114:115], v[114:115], v[118:119]
  v_pk_add_f32 v[18:19], v[18:19], v[122:123]
  v_pk_add_f32 v[16:17], v[16:17], v[112:113]
  v_pk_add_f32 v[18:19], v[18:19], v[114:115]
  s_waitcnt lgkmcnt(12)
  v_pk_add_f32 v[124:125], v[124:125], v[128:129]
  v_pk_add_f32 v[32:33], v[32:33], v[132:133]
  v_pk_add_f32 v[126:127], v[126:127], v[130:131]
  v_pk_add_f32 v[34:35], v[34:35], v[134:135]
  v_pk_add_f32 v[32:33], v[32:33], v[124:125]
  v_pk_add_f32 v[34:35], v[34:35], v[126:127]
  s_waitcnt lgkmcnt(9)
  v_pk_add_f32 v[136:137], v[136:137], v[140:141]
  v_pk_add_f32 v[48:49], v[48:49], v[144:145]
  v_pk_add_f32 v[138:139], v[138:139], v[142:143]
  v_pk_add_f32 v[50:51], v[50:51], v[146:147]
  v_pk_add_f32 v[48:49], v[48:49], v[136:137]
  v_pk_add_f32 v[50:51], v[50:51], v[138:139]
  s_waitcnt lgkmcnt(6)
  v_pk_add_f32 v[148:149], v[148:149], v[152:153]
  v_pk_add_f32 v[64:65], v[64:65], v[156:157]
  v_pk_add_f32 v[150:151], v[150:151], v[154:155]
  v_pk_add_f32 v[66:67], v[66:67], v[158:159]
  v_pk_add_f32 v[64:65], v[64:65], v[148:149]
  v_pk_add_f32 v[66:67], v[66:67], v[150:151]
  s_waitcnt lgkmcnt(3)
  v_pk_add_f32 v[160:161], v[160:161], v[164:165]
  v_pk_add_f32 v[80:81], v[80:81], v[168:169]
  v_pk_add_f32 v[162:163], v[162:163], v[166:167]
  v_pk_add_f32 v[82:83], v[82:83], v[170:171]
  v_pk_add_f32 v[80:81], v[80:81], v[160:161]
  v_pk_add_f32 v[82:83], v[82:83], v[162:163]
  s_waitcnt lgkmcnt(0)
  v_pk_add_f32 v[172:173], v[172:173], v[176:177]
  v_pk_add_f32 v[96:97], v[96:97], v[180:181]
  v_pk_add_f32 v[174:175], v[174:175], v[178:179]
  v_pk_add_f32 v[98:99], v[98:99], v[182:183]
  v_pk_add_f32 v[96:97], v[96:97], v[172:173]
  v_pk_add_f32 v[98:99], v[98:99], v[174:175]
  v_pk_mul_f32 v[16:17], v[16:17], s[54:55]
  v_pk_mul_f32 v[18:19], v[18:19], s[54:55]
  v_cvt_pk_bf16_f32 v192, v16, v17
  v_cvt_pk_bf16_f32 v193, v18, v19
  v_pk_mul_f32 v[32:33], v[32:33], s[54:55]
  v_pk_mul_f32 v[34:35], v[34:35], s[54:55]
  v_cvt_pk_bf16_f32 v194, v32, v33
  v_cvt_pk_bf16_f32 v195, v34, v35
  s_nop 0
  v_permlane32_swap_b32 v192, v194
  v_permlane32_swap_b32 v193, v195
  s_mov_b32 s42, 0
  buffer_store_dwordx4 v[192:195], v13, s[32:35], s42 offen sc1
  v_pk_mul_f32 v[48:49], v[48:49], s[54:55]
  v_pk_mul_f32 v[50:51], v[50:51], s[54:55]
  v_cvt_pk_bf16_f32 v196, v48, v49
  v_cvt_pk_bf16_f32 v197, v50, v51
  v_pk_mul_f32 v[64:65], v[64:65], s[54:55]
  v_pk_mul_f32 v[66:67], v[66:67], s[54:55]
  v_cvt_pk_bf16_f32 v198, v64, v65
  v_cvt_pk_bf16_f32 v199, v66, v67
  s_nop 0
  v_permlane32_swap_b32 v196, v198
  v_permlane32_swap_b32 v197, v199
  s_mov_b32 s42, 512
  buffer_store_dwordx4 v[196:199], v13, s[32:35], s42 offen sc1
  v_pk_mul_f32 v[80:81], v[80:81], s[54:55]
  v_pk_mul_f32 v[82:83], v[82:83], s[54:55]
  v_cvt_pk_bf16_f32 v200, v80, v81
  v_cvt_pk_bf16_f32 v201, v82, v83
  v_pk_mul_f32 v[96:97], v[96:97], s[54:55]
  v_pk_mul_f32 v[98:99], v[98:99], s[54:55]
  v_cvt_pk_bf16_f32 v202, v96, v97
  v_cvt_pk_bf16_f32 v203, v98, v99
  s_nop 0
  v_permlane32_swap_b32 v200, v202
  v_permlane32_swap_b32 v201, v203
  s_mov_b32 s42, 1024
  buffer_store_dwordx4 v[200:203], v13, s[32:35], s42 offen sc1
wp_pub:
  s_mov_b32 s3, 65536
  s_waitcnt vmcnt(0)
non3:
  v_readfirstlane_b32 s101, v213
  v_readfirstlane_b32 s100, v212
  s_cmp_lg_u32 s101, 0
  s_cbranch_scc1 non3_x
  global_load_dwordx2 v[212:213], v214, s[18:19] sc1
  s_sub_u32 s3, s3, 1
  s_waitcnt vmcnt(0)
  s_cbranch_scc0 non3
non3_x:
  s_barrier
  s_cmp_lg_u32 s22, 0
  s_cbranch_scc1 wp_done
  v_mov_b32 v4, s100
  v_mov_b32 v5, s101
  s_lshl_b32 s56, s56, 7
  s_add_u32 s56, s56, s65
  s_mov_b64 exec, 1
  s_waitcnt vmcnt(0)
  buffer_store_dwordx2 v[4:5], off, s[68:71], s56 sc1
  s_mov_b64 exec, -1
wp_done:
  s_branch p0_end
p0_r3:
  s_add_u32 s41, s2, s22
  s_cmp_lg_u32 s41, 128
  s_cbranch_scc1 p0_nn
  s_memrealtime s[28:29]
  v_mov_b32 v6, 0
  s_waitcnt lgkmcnt(0)
  s_lshl_b64 s[28:29], s[28:29], 16
  s_or_b32 s29, s29, 0x40000000
  v_mov_b32 v4, s28
  v_mov_b32 v5, s29
  s_mov_b64 exec, 1
  global_store_dwordx2 v6, v[4:5], s[18:19] sc1
  s_mov_b64 exec, -1
p0_nn:
  s_getpc_b64 s[24:25]
  s_add_u32 s24, s24, k_layer@rel32@lo+4
  s_addc_u32 s25, s25, k_layer@rel32@hi+12
  s_mov_b32 s26, k_end-k_layer
  s_mov_b32 s27, 0x20000
  s_bfe_u32 s41, s2, 0x10003
  s_lshl_b32 s41, s41, 3
  s_add_u32 s41, s41, s22
  s_mul_i32 s41, s41, 3072
  v_lshlrev_b32 v4, 4, v1
  buffer_load_dwordx4 v[16:19], v4, s[24:27], s41 offen offset:0
  buffer_load_dwordx4 v[20:23], v4, s[24:27], s41 offen offset:1024
  buffer_load_dwordx4 v[24:27], v4, s[24:27], s41 offen offset:2048
  s_waitcnt lgkmcnt(0)
  s_mov_b32 s10, s20
  s_mov_b32 s11, s21
  s_add_u32 s20, s20, 14680064
  s_addc_u32 s21, s21, 0
  s_add_u32 s68, s10, 6291456
  s_addc_u32 s69, s11, 0
  s_mov_b32 s70, 8388608
  s_mov_b32 s71, 0x20000
  v_mov_b32 v214, 0
  global_load_dwordx2 v[212:213], v214, s[18:19] sc1
  s_mov_b32 s3, 65536
  s_waitcnt vmcnt(0)
non4:
  v_readfirstlane_b32 s101, v213
  v_readfirstlane_b32 s100, v212
  s_cmp_lg_u32 s101, 0
  s_cbranch_scc1 non4_x
  global_load_dwordx2 v[212:213], v214, s[18:19] sc1
  s_sub_u32 s3, s3, 1
  s_waitcnt vmcnt(0)
  s_cbranch_scc0 non4
non4_x:
p0_end:
k_layer:
  s_mov_b32 s40, s22
  s_mov_b64 exec, -1
  s_setprio 0
  s_cmp_ge_u32 s2, 144
  s_cbranch_scc1 fft_r1
  s_lshr_b32 s46, s40, 2
  s_and_b32 s47, s40, 3
  s_lshl_b32 s41, s47, 1
  s_add_u32 s48, s41, s46
  s_lshl_b32 s41, s2, 14
  s_lshl_b32 s42, s48, 11
  s_add_u32 s49, s41, s42
  v_lshlrev_b32 v5, 3, v1
  v_lshlrev_b32 v6, 4, v1
  s_lshl_b32 s50, s48, 10
  s_lshl_b32 s42, s46, 13
  s_add_u32 s41, s41, s42
  s_lshl_b32 s42, s47, 10
  s_add_u32 s51, s41, s42
  s_add_u32 s52, s51, 4096
  s_add_u32 s24, s20, 65536
  s_addc_u32 s25, s21, 0
  s_mov_b32 s26, 2359296
  s_mov_b32 s27, 0x20000
  s_mov_b32 s28, s20
  s_mov_b32 s29, s21
  s_mov_b32 s30, 49152
  s_mov_b32 s31, 0x20000
  s_mov_b32 s32, s10
  s_mov_b32 s33, s11
  s_mov_b32 s34, 2359296
  s_mov_b32 s35, 0x20000
  s_cmp_lg_u32 s23, 0
  s_cbranch_scc1 fft_nw
  v_bfe_u32 v216, v1, 3, 2
  v_mul_u32_u24 v216, 576, v216
  v_bfe_u32 v7, v1, 2, 1
  v_mul_u32_u24 v7, 35, v7
  s_lshr_b32 s41, s88, 4
  s_mul_i32 s41, s41, 36
  v_add3_u32 v216, v216, v7, s41
  v_lshrrev_b32 v216, 6, v216
  v_mul_u32_u24 v216, 3, v216
  v_and_b32 v7, 3, v1
  v_add_u32 v216, v216, v7
  v_add_u32 v216, 1024, v216
  s_lshl_b32 s41, s47, 4
  s_add_u32 s41, s41, 712
  v_add_u32 v4, s41, v1
  v_cmp_lt_u32 vcc, 55, v1
  s_nop 1
  v_cndmask_b32 v216, v216, v4, vcc
  s_bfe_u32 s42, s2, 0x20001
  s_mul_i32 s42, s42, 192
  s_mul_i32 s41, s2, 171
  s_lshr_b32 s41, s41, 12
  s_add_u32 s42, s42, s41
  s_mul_i32 s41, s48, 24
  v_add_u32 v4, s41, v1
  s_add_u32 s42, s42, s41
  v_and_b32 v7, 3, v1
  v_mul_u32_u24 v7, 6, v7
  v_add_u32 v7, s42, v7
  v_cmp_gt_u32 vcc, 24, v1
  s_nop 1
  v_cndmask_b32 v4, v7, v4, vcc
  v_cmp_gt_u32 vcc, 32, v1
  s_nop 1
  v_cndmask_b32 v216, v216, v4, vcc
  s_and_b32 s41, s2, 15
  s_cmp_lt_u32 s41, 9
  s_cselect_b32 s41, s2, 0
  s_cmp_lt_u32 s41, 48
  s_cselect_b32 s41, s41, 0
  s_add_u32 s41, s41, 1152
  v_writelane_b32 v216, s41, 28
  s_nop 1
  v_lshlrev_b32 v216, 7, v216
  s_mov_b32 exec_lo, 0xfffffff
  s_mov_b32 exec_hi, 0
  buffer_load_dwordx2 v[16:17], v216, s[68:71], 0 offen sc1
  s_mov_b64 exec, -1
  s_branch fft_w
fft_nw:
  buffer_load_dwordx4 v[48:51], v6, s[32:35], s51 offen sc1
  buffer_load_dwordx4 v[52:55], v6, s[32:35], s52 offen sc1
  s_cmp_ge_u32 s22, 4
  s_cbranch_scc1 fft_w
  buffer_load_dwordx4 v[16:19], v6, s[24:27], s49 offen sc1
  buffer_load_dwordx4 v[20:23], v6, s[24:27], s49 offen offset:1024 sc1
  s_mov_b32 s41, s50
  buffer_load_dwordx2 v[24:25], v5, s[28:31], s41 offen sc1
  buffer_load_dwordx2 v[26:27], v5, s[28:31], s41 offen offset:512 sc1
  s_add_u32 s41, s41, 8192
  buffer_load_dwordx2 v[28:29], v5, s[28:31], s41 offen sc1
  buffer_load_dwordx2 v[30:31], v5, s[28:31], s41 offen offset:512 sc1
  s_add_u32 s41, s41, 8192
  buffer_load_dwordx2 v[32:33], v5, s[28:31], s41 offen sc1
  buffer_load_dwordx2 v[34:35], v5, s[28:31], s41 offen offset:512 sc1
  s_add_u32 s41, s41, 8192
  buffer_load_dwordx2 v[36:37], v5, s[28:31], s41 offen sc1
  buffer_load_dwordx2 v[38:39], v5, s[28:31], s41 offen offset:512 sc1
  s_add_u32 s41, s41, 8192
  buffer_load_dwordx2 v[40:41], v5, s[28:31], s41 offen sc1
  buffer_load_dwordx2 v[42:43], v5, s[28:31], s41 offen offset:512 sc1
  s_add_u32 s41, s41, 8192
  buffer_load_dwordx2 v[44:45], v5, s[28:31], s41 offen sc1
  buffer_load_dwordx2 v[46:47], v5, s[28:31], s41 offen offset:512 sc1
  s_cmp_ge_u32 s22, 4
  s_cbranch_scc1 fft_w
  v_mov_b32 v220, v12
  s_lshr_b32 s64, s22, 1
  s_mul_i32 s64, s64, 27648
  s_mul_i32 s96, s22, 864
  s_cmp_eq_u32 s23, 0
  s_cselect_b64 s[98:99], s[94:95], 0
  s_branch fft_pre
fft_w:
  s_add_u32 s60, s10, 2359296
  s_addc_u32 s61, s11, 0
  s_mov_b32 s62, 1990656
  s_mov_b32 s63, 0x20000
  s_and_b32 s41, s22, 1
  s_mul_i32 s41, s41, 54
  v_add_u32 v4, s41, v1
  v_bfe_u32 v5, v4, 4, 1
  v_bfe_u32 v6, v4, 5, 1
  v_mul_u32_u24 v7, 576, v5
  v_mad_u32_u24 v7, v6, 18, v7
  v_bfe_u32 v6, v4, 2, 1
  v_lshl_add_u32 v7, v6, 3, v7
  v_bfe_u32 v6, v4, 3, 1
  v_lshl_add_u32 v7, v6, 2, v7
  v_and_b32 v6, 3, v4
  v_add_u32 v7, v7, v6
  v_lshl_add_u32 v5, v5, 1, v4
  v_add_u32 v5, 1088, v5
  v_cmp_gt_u32 vcc, 64, v4
  s_nop 1
  v_cndmask_b32 v7, v5, v7, vcc
  v_bfe_u32 v5, v4, 2, 2
  v_mul_u32_u24 v5, 576, v5
  v_lshrrev_b32 v6, 1, v6
  v_mad_u32_u24 v5, v6, 18, v5
  v_and_or_b32 v6, v4, 1, 16
  v_add_u32 v5, v5, v6
  v_cmp_gt_u32 vcc, 96, v4
  s_nop 1
  v_cndmask_b32 v7, v5, v7, vcc
  s_lshr_b32 s41, s88, 4
  s_mul_i32 s41, s41, 36
  v_add_lshl_u32 v220, v7, s41, 4
  s_bfm_b64 s[94:95], 54, 0
  s_lshr_b32 s64, s22, 1
  s_mul_i32 s64, s64, 27648
  s_mul_i32 s96, s22, 864
  s_cmp_eq_u32 s23, 0
  s_cselect_b64 s[98:99], s[94:95], 0
  s_lshl_b32 s41, s23, 2
  s_and_b32 s41, s41, s22
  s_cbranch_scc0 fft_ls
  s_waitcnt lgkmcnt(0)
  s_barrier
  s_barrier
fft_ls:
  v_lshrrev_b32 v152, 4, v1
  v_lshlrev_b32 v152, 2, v152
  v_and_b32 v153, 15, v1
  s_and_b32 s41, s22, 3
  s_lshl_b32 s41, s41, 4
  v_add_u32 v154, s41, v153
  v_cvt_f32_u32 v152, v152
  v_cvt_f32_u32 v154, v154
  v_cvt_f32_u32 v153, v153
  v_mul_f32 v154, 0x3c800000, v154
  v_mul_f32 v153, 0x3d000000, v153
  v_mul_f32 v155, v152, v154
  v_mul_f32 v156, v152, v153
  v_cos_f32 v158, v155
  v_sin_f32 v159, v155
  s_nop 0
  v_cvt_pk_bf16_f32 v80, v158, v159
  v_cvt_pk_bf16_f32 v84, -v159, v158
  v_fmamk_f32 v157, v154, 0x3f800000, v155
  v_cos_f32 v158, v157
  v_sin_f32 v159, v157
  s_nop 0
  v_cvt_pk_bf16_f32 v81, v158, v159
  v_cvt_pk_bf16_f32 v85, -v159, v158
  v_fmamk_f32 v157, v154, 0x40000000, v155
  v_cos_f32 v158, v157
  v_sin_f32 v159, v157
  s_nop 0
  v_cvt_pk_bf16_f32 v82, v158, v159
  v_cvt_pk_bf16_f32 v86, -v159, v158
  v_fmamk_f32 v157, v154, 0x40400000, v155
  v_cos_f32 v158, v157
  v_sin_f32 v159, v157
  s_nop 0
  v_cvt_pk_bf16_f32 v83, v158, v159
  v_cvt_pk_bf16_f32 v87, -v159, v158
  v_cos_f32 v158, v156
  v_sin_f32 v159, v156
  s_nop 0
  v_cvt_pk_bf16_f32 v88, v158, v159
  v_cvt_pk_bf16_f32 v92, -v159, v158
  v_fmamk_f32 v157, v153, 0x3f800000, v156
  v_cos_f32 v158, v157
  v_sin_f32 v159, v157
  s_nop 0
  v_cvt_pk_bf16_f32 v89, v158, v159
  v_cvt_pk_bf16_f32 v93, -v159, v158
  v_fmamk_f32 v157, v153, 0x40000000, v156
  v_cos_f32 v158, v157
  v_sin_f32 v159, v157
  s_nop 0
  v_cvt_pk_bf16_f32 v90, v158, v159
  v_cvt_pk_bf16_f32 v94, -v159, v158
  v_fmamk_f32 v157, v153, 0x40400000, v156
  v_cos_f32 v158, v157
  v_sin_f32 v159, v157
  s_nop 0
  v_cvt_pk_bf16_f32 v91, v158, v159
  v_cvt_pk_bf16_f32 v95, -v159, v158
  v_mul_f32 v154, 0x3d000000, v154
  v_mul_f32 v155, 0x3d000000, v155
  v_fmamk_f32 v157, v154, 0x0, v155
  v_cos_f32 v96, v157
  v_sin_f32 v104, v157
  v_fmamk_f32 v157, v154, 0x3f800000, v155
  v_cos_f32 v97, v157
  v_sin_f32 v105, v157
  v_fmamk_f32 v157, v154, 0x40000000, v155
  v_cos_f32 v98, v157
  v_sin_f32 v106, v157
  v_fmamk_f32 v157, v154, 0x40400000, v155
  v_cos_f32 v99, v157
  v_sin_f32 v107, v157
  v_fmamk_f32 v157, v154, 0x41800000, v155
  v_cos_f32 v100, v157
  v_sin_f32 v108, v157
  v_fmamk_f32 v157, v154, 0x41880000, v155
  v_cos_f32 v101, v157
  v_sin_f32 v109, v157
  v_fmamk_f32 v157, v154, 0x41900000, v155
  v_cos_f32 v102, v157
  v_sin_f32 v110, v157
  v_fmamk_f32 v157, v154, 0x41980000, v155
  v_cos_f32 v103, v157
  v_sin_f32 v111, v157
fft_pre:
  s_and_b32 s41, s22, 3
  s_cmp_eq_u32 s41, 3
  s_cbranch_scc1 wraf_x
  s_lshl_b32 s41, s41, 5
  v_mul_u32_u24 v14, 108, v3
  v_add3_u32 v14, v14, v2, s41
  s_branch wraf_e
wraf_x:
  v_bfe_u32 v14, v1, 2, 2
  v_and_b32 v4, 1, v14
  v_or_b32 v4, 4, v4
  v_and_b32 v15, 2, v1
  v_cmp_eq_u32 vcc, 0, v15
  s_nop 1
  v_cndmask_b32 v14, v4, v14, vcc
  v_and_b32 v4, 1, v1
  v_lshl_add_u32 v14, v14, 1, v4
  v_lshrrev_b32 v4, 4, v1
  v_mul_u32_u24 v4, 108, v4
  v_add_u32 v14, 96, v14
  v_add_u32 v14, v14, v4
wraf_e:
  v_lshlrev_b32 v14, 4, v14
  v_add_u32 v15, 62208, v14
  s_add_u32 s36, s20, 2424832
  s_addc_u32 s37, s21, 0
  s_mov_b32 s38, 2359296
  s_mov_b32 s39, 0x20000
  s_lshl_b32 s41, s48, 8
  s_add_u32 s43, s2, s41
  s_add_u32 s43, s43, 2048
  v_lshlrev_b32 v5, 3, v1
  v_lshlrev_b32 v6, 4, v1
  v_and_b32 v8, 15, v1
  s_lshl_b32 s41, s47, 4
  v_add_u32 v9, s41, v8
  s_mov_b32 s44, 0x80008000
  v_and_b32 v4, 1, v9
  v_cmp_eq_u32 vcc, 1, v4
  v_mul_lo_u32 v217, v4, s44
  v_bfe_u32 v4, v9, 1, 1
  v_mul_lo_u32 v218, v4, s44
  v_xor_b32 v4, v217, v218
  v_cndmask_b32 v208, v80, v84, vcc
  v_cndmask_b32 v209, v84, v80, vcc
  v_xor_b32 v112, v218, v208
  v_xor_b32 v124, v4, v209
  v_xor_b32 v116, v217, v80
  v_xor_b32 v128, v217, v84
  v_xor_b32 v120, v217, v112
  v_xor_b32 v132, v217, v124
  v_cndmask_b32 v208, v81, v85, vcc
  v_cndmask_b32 v209, v85, v81, vcc
  v_xor_b32 v113, v218, v208
  v_xor_b32 v125, v4, v209
  v_xor_b32 v117, v217, v81
  v_xor_b32 v129, v217, v85
  v_xor_b32 v121, v217, v113
  v_xor_b32 v133, v217, v125
  v_cndmask_b32 v208, v82, v86, vcc
  v_cndmask_b32 v209, v86, v82, vcc
  v_xor_b32 v114, v218, v208
  v_xor_b32 v126, v4, v209
  v_xor_b32 v118, v217, v82
  v_xor_b32 v130, v217, v86
  v_xor_b32 v122, v217, v114
  v_xor_b32 v134, v217, v126
  v_cndmask_b32 v208, v83, v87, vcc
  v_cndmask_b32 v209, v87, v83, vcc
  v_xor_b32 v115, v218, v208
  v_xor_b32 v127, v4, v209
  v_xor_b32 v119, v217, v83
  v_xor_b32 v131, v217, v87
  v_xor_b32 v123, v217, v115
  v_xor_b32 v135, v217, v127
  v_xor_b32 v136, v217, v88
  v_mov_b32 v144, v88
  v_mov_b32 v72, v136
  v_xor_b32 v137, v217, v89
  v_xor_b32 v145, s44, v89
  v_xor_b32 v73, s44, v137
  v_xor_b32 v138, v217, v90
  v_mov_b32 v146, v90
  v_mov_b32 v74, v138
  v_xor_b32 v139, v217, v91
  v_xor_b32 v147, s44, v91
  v_xor_b32 v75, s44, v139
  v_xor_b32 v140, v217, v92
  v_mov_b32 v148, v92
  v_mov_b32 v76, v140
  v_xor_b32 v141, v217, v93
  v_xor_b32 v149, s44, v93
  v_xor_b32 v77, s44, v141
  v_xor_b32 v142, v217, v94
  v_mov_b32 v150, v94
  v_mov_b32 v78, v142
  v_xor_b32 v143, v217, v95
  v_xor_b32 v151, s44, v95
  v_xor_b32 v79, s44, v143
  s_lshl_b32 s41, s48, 10
  s_add_u32 s41, s41, 124416
  v_add_u32 v10, s41, v6
  s_lshl_b32 s41, s46, 13
  s_add_u32 s41, s41, 124416
  v_add_u32 v11, s41, v6
  v_lshrrev_b32 v12, 4, v1
  v_mul_u32_u24 v13, 1088, v12
  v_lshl_add_u32 v13, v9, 2, v13
  s_mul_i32 s41, s46, 8704
  s_add_u32 s41, s41, 140800
  v_add_u32 v13, s41, v13
  v_mul_u32_u24 v7, 272, v8
  v_lshl_add_u32 v7, v12, 4, v7
  s_mul_i32 s41, s46, 4352
  s_add_u32 s41, s41, 140800
  v_add_u32 v7, s41, v7
  s_cmp_eq_u32 s2, 0
  s_cselect_b32 s45, 0xffff, -1
  s_cselect_b32 s54, 0, 0xba000000
  s_mov_b32 s55, s54
  s_mov_b32 s56, 0xba000000
  s_mov_b32 s57, s56
  s_mov_b32 s58, 0x3a000000
  s_mov_b32 s59, s58
  v_mov_b32 v4, 0x3727c5ac
  s_cmp_lg_u32 s23, 0
  s_cbranch_scc1 fft_np
  s_mov_b32 exec_lo, 268435455
  s_mov_b32 exec_hi, 0
  s_mov_b32 s3, 65536
  s_waitcnt vmcnt(0)
plw5:
  v_cmp_ne_u64 vcc, s[100:101], v[16:17]
  s_cbranch_vccz plw5_x
  s_mov_b64 exec, vcc
  buffer_load_dwordx2 v[16:17], v216, s[68:71], 0 offen sc1
  s_sub_u32 s3, s3, 1
  s_waitcnt vmcnt(0)
  s_cbranch_scc0 plw5
plw5_x:
  s_mov_b64 exec, -1
  buffer_load_dwordx4 v[16:19], v6, s[24:27], s49 offen sc1
  buffer_load_dwordx4 v[20:23], v6, s[24:27], s49 offen offset:1024 sc1
  s_mov_b32 s41, s50
  buffer_load_dwordx2 v[24:25], v5, s[28:31], s41 offen sc1
  buffer_load_dwordx2 v[26:27], v5, s[28:31], s41 offen offset:512 sc1
  s_add_u32 s41, s41, 8192
  buffer_load_dwordx2 v[28:29], v5, s[28:31], s41 offen sc1
  buffer_load_dwordx2 v[30:31], v5, s[28:31], s41 offen offset:512 sc1
  s_add_u32 s41, s41, 8192
  buffer_load_dwordx2 v[32:33], v5, s[28:31], s41 offen sc1
  buffer_load_dwordx2 v[34:35], v5, s[28:31], s41 offen offset:512 sc1
  s_add_u32 s41, s41, 8192
  buffer_load_dwordx2 v[36:37], v5, s[28:31], s41 offen sc1
  buffer_load_dwordx2 v[38:39], v5, s[28:31], s41 offen offset:512 sc1
  s_add_u32 s41, s41, 8192
  buffer_load_dwordx2 v[40:41], v5, s[28:31], s41 offen sc1
  buffer_load_dwordx2 v[42:43], v5, s[28:31], s41 offen offset:512 sc1
  s_add_u32 s41, s41, 8192
  buffer_load_dwordx2 v[44:45], v5, s[28:31], s41 offen sc1
  buffer_load_dwordx2 v[46:47], v5, s[28:31], s41 offen offset:512 sc1
  s_mov_b32 exec_lo, 0x10000000
  s_mov_b32 exec_hi, 4286019447
  buffer_load_dwordx2 v[218:219], v216, s[68:71], 0 offen sc1
  s_mov_b64 exec, -1
  s_mov_b32 s89, -2
  s_mov_b32 s3, 65536
  s_waitcnt vmcnt(1)
  s_branch fft_ck2
fft_np:
  s_mov_b32 s89, -2
  s_mov_b32 s3, 65536
  s_lshl_b32 s41, s23, 2
  s_andn2_b32 s41, s41, s22
  s_cbranch_scc1 fft_ck
fft_ld:
  buffer_load_dwordx4 v[16:19], v6, s[24:27], s49 offen sc1
  buffer_load_dwordx4 v[20:23], v6, s[24:27], s49 offen offset:1024 sc1
  s_mov_b32 s41, s50
  buffer_load_dwordx2 v[24:25], v5, s[28:31], s41 offen sc1
  buffer_load_dwordx2 v[26:27], v5, s[28:31], s41 offen offset:512 sc1
  s_add_u32 s41, s41, 8192
  buffer_load_dwordx2 v[28:29], v5, s[28:31], s41 offen sc1
  buffer_load_dwordx2 v[30:31], v5, s[28:31], s41 offen offset:512 sc1
  s_add_u32 s41, s41, 8192
  buffer_load_dwordx2 v[32:33], v5, s[28:31], s41 offen sc1
  buffer_load_dwordx2 v[34:35], v5, s[28:31], s41 offen offset:512 sc1
  s_add_u32 s41, s41, 8192
  buffer_load_dwordx2 v[36:37], v5, s[28:31], s41 offen sc1
  buffer_load_dwordx2 v[38:39], v5, s[28:31], s41 offen offset:512 sc1
  s_add_u32 s41, s41, 8192
  buffer_load_dwordx2 v[40:41], v5, s[28:31], s41 offen sc1
  buffer_load_dwordx2 v[42:43], v5, s[28:31], s41 offen offset:512 sc1
  s_add_u32 s41, s41, 8192
  buffer_load_dwordx2 v[44:45], v5, s[28:31], s41 offen sc1
  buffer_load_dwordx2 v[46:47], v5, s[28:31], s41 offen offset:512 sc1
fft_ck:
  s_waitcnt vmcnt(0)
fft_ck2:
  v_max3_u32 v208, v16, v17, v18
  v_max3_u32 v209, v19, v20, v21
  v_pk_add_f32 v[24:25], v[24:25], v[28:29]
  v_pk_add_f32 v[32:33], v[32:33], v[36:37]
  v_pk_add_f32 v[40:41], v[40:41], v[44:45]
  v_pk_add_f32 v[24:25], v[24:25], v[32:33]
  v_pk_add_f32 v[24:25], v[24:25], v[40:41]
  v_pk_add_f32 v[26:27], v[26:27], v[30:31]
  v_pk_add_f32 v[34:35], v[34:35], v[38:39]
  v_pk_add_f32 v[42:43], v[42:43], v[46:47]
  v_pk_add_f32 v[26:27], v[26:27], v[34:35]
  v_pk_add_f32 v[26:27], v[26:27], v[42:43]
  v_max3_u32 v208, v208, v22, v23
  v_pk_add_f32 v[210:211], v[24:25], v[26:27]
  v_max_u32 v208, v208, v209
  v_cmp_u_f32 vcc, v210, v211
  s_nop 1
  v_cndmask_b32 v208, v208, -1, vcc
  s_sub_u32 s3, s3, 1
  v_cmp_lt_u32 vcc, s89, v208
  s_cselect_b32 s89, -1, s89
  s_cbranch_vccnz fft_ld
  s_mov_b64 exec, -1
  s_cmp_lg_u32 s23, 0
  s_cbranch_scc1 fft_nf
  s_mov_b32 exec_lo, 0
  s_mov_b32 exec_hi, 4278190080
  s_mov_b32 s3, 65536
  s_waitcnt vmcnt(0)
plw6:
  v_cmp_ne_u64 vcc, s[100:101], v[218:219]
  s_cbranch_vccz plw6_x
  s_mov_b64 exec, vcc
  buffer_load_dwordx2 v[218:219], v216, s[68:71], 0 offen sc1
  s_sub_u32 s3, s3, 1
  s_waitcnt vmcnt(0)
  s_cbranch_scc0 plw6
plw6_x:
  s_mov_b64 exec, -1
  buffer_load_dwordx4 v[48:51], v6, s[32:35], s51 offen sc1
  buffer_load_dwordx4 v[52:55], v6, s[32:35], s52 offen sc1
fft_nf:
  v_fmamk_f32 v24, v24, 0x3ae38e39, v4
  v_rsq_f32 v24, v24
  v_fmamk_f32 v25, v25, 0x3ae38e39, v4
  v_rsq_f32 v25, v25
  v_fmamk_f32 v26, v26, 0x3ae38e39, v4
  v_rsq_f32 v26, v26
  v_fmamk_f32 v27, v27, 0x3ae38e39, v4
  v_rsq_f32 v27, v27
  v_lshlrev_b32 v28, 16, v16
  v_and_b32 v32, 0xffff0000, v16
  v_lshlrev_b32 v36, 16, v17
  v_and_b32 v40, 0xffff0000, v17
  v_lshlrev_b32 v29, 16, v18
  v_and_b32 v33, 0xffff0000, v18
  v_lshlrev_b32 v37, 16, v19
  v_and_b32 v41, 0xffff0000, v19
  v_lshlrev_b32 v30, 16, v20
  v_and_b32 v34, 0xffff0000, v20
  v_lshlrev_b32 v38, 16, v21
  v_and_b32 v42, 0xffff0000, v21
  v_lshlrev_b32 v31, 16, v22
  v_and_b32 v35, 0xffff0000, v22
  v_lshlrev_b32 v39, 16, v23
  v_and_b32 v43, 0xffff0000, v23
  v_pk_mul_f32 v[208:209], v[28:29], v[24:25]
  v_pk_mul_f32 v[212:213], v[32:33], v[24:25]
  v_pk_mul_f32 v[210:211], v[30:31], v[26:27]
  v_pk_mul_f32 v[214:215], v[34:35], v[26:27]
  v_cvt_pk_bf16_f32 v200, v208, v212
  v_and_b32 v200, s45, v200
  v_cvt_pk_bf16_f32 v201, v209, v213
  v_and_b32 v201, s45, v201
  v_cvt_pk_bf16_f32 v202, v210, v214
  v_and_b32 v202, s45, v202
  v_cvt_pk_bf16_f32 v203, v211, v215
  v_and_b32 v203, s45, v203
  ds_write_b128 v10, v[200:203] offset:0
  v_pk_mul_f32 v[208:209], v[36:37], v[24:25]
  v_pk_mul_f32 v[212:213], v[40:41], v[24:25]
  v_pk_mul_f32 v[210:211], v[38:39], v[26:27]
  v_pk_mul_f32 v[214:215], v[42:43], v[26:27]
  v_cvt_pk_bf16_f32 v204, v208, v212
  v_cvt_pk_bf16_f32 v205, v209, v213
  v_cvt_pk_bf16_f32 v206, v210, v214
  v_cvt_pk_bf16_f32 v207, v211, v215
  ds_write_b128 v10, v[204:207] offset:8192
  s_cmp_lg_u32 s23, 0
  s_cbranch_scc1 fft_nd
  s_mov_b32 exec_lo, 268435456
  s_mov_b32 exec_hi, 7829367
  s_mov_b32 s3, 65536
  s_waitcnt vmcnt(2)
plw7:
  v_cmp_ne_u64 vcc, s[100:101], v[218:219]
  s_cbranch_vccz plw7_x
  s_mov_b64 exec, vcc
  buffer_load_dwordx2 v[218:219], v216, s[68:71], 0 offen sc1
  s_sub_u32 s3, s3, 1
  s_waitcnt vmcnt(0)
  s_cbranch_scc0 plw7
plw7_x:
  s_mov_b64 exec, -1
  s_add_u32 m0, s96, 0
  s_mov_b64 exec, s[94:95]
  s_add_u32 s97, s64, 0
  buffer_load_dwordx4 v220, s[60:63], s97 offen sc1 lds
  s_mov_b64 exec, -1
  s_add_u32 m0, s96, 6912
  s_mov_b64 exec, s[94:95]
  s_add_u32 s97, s64, 110592
  buffer_load_dwordx4 v220, s[60:63], s97 offen sc1 lds
  s_mov_b64 exec, -1
  s_add_u32 m0, s96, 13824
  s_mov_b64 exec, s[94:95]
  s_add_u32 s97, s64, 221184
  buffer_load_dwordx4 v220, s[60:63], s97 offen sc1 lds
  s_mov_b64 exec, -1
  s_add_u32 m0, s96, 20736
  s_mov_b64 exec, s[94:95]
  s_add_u32 s97, s64, 331776
  buffer_load_dwordx4 v220, s[60:63], s97 offen sc1 lds
  s_mov_b64 exec, -1
  s_add_u32 m0, s96, 27648
  s_mov_b64 exec, s[94:95]
  s_add_u32 s97, s64, 442368
  buffer_load_dwordx4 v220, s[60:63], s97 offen sc1 lds
  s_mov_b64 exec, -1
  s_add_u32 m0, s96, 34560
  s_mov_b64 exec, s[94:95]
  s_add_u32 s97, s64, 552960
  buffer_load_dwordx4 v220, s[60:63], s97 offen sc1 lds
  s_mov_b64 exec, -1
fft_nd:
  s_andn2_b64 s[90:91], s[94:95], s[98:99]
  s_waitcnt lgkmcnt(0)
  s_barrier
  ds_read_b128 v[152:155], v11 offset:0
  ds_read_b128 v[156:159], v11 offset:1024
  ds_read_b128 v[160:163], v11 offset:2048
  ds_read_b128 v[164:167], v11 offset:3072
  ds_read_b128 v[168:171], v11 offset:4096
  ds_read_b128 v[172:175], v11 offset:5120
  ds_read_b128 v[176:179], v11 offset:6144
  ds_read_b128 v[180:183], v11 offset:7168
  s_waitcnt lgkmcnt(6)
  v_mfma_f32_16x16x32_bf16 v[184:187], v[152:155], v[80:83], 0
  v_mfma_f32_16x16x32_bf16 v[188:191], v[152:155], v[84:87], 0
  v_mfma_f32_16x16x32_bf16 v[192:195], v[156:159], v[80:83], 0
  v_mfma_f32_16x16x32_bf16 v[196:199], v[156:159], v[84:87], 0
  s_add_u32 m0, s96, 69120
  s_mov_b64 exec, s[94:95]
  s_add_u32 s97, s64, 1105920
  buffer_load_dwordx4 v220, s[60:63], s97 offen sc1 lds
  s_mov_b64 exec, -1
  s_waitcnt lgkmcnt(4)
  v_mfma_f32_16x16x32_bf16 v[184:187], v[160:163], v[112:115], v[184:187]
  v_mfma_f32_16x16x32_bf16 v[188:191], v[160:163], v[124:127], v[188:191]
  v_mfma_f32_16x16x32_bf16 v[192:195], v[164:167], v[112:115], v[192:195]
  v_mfma_f32_16x16x32_bf16 v[196:199], v[164:167], v[124:127], v[196:199]
  s_waitcnt lgkmcnt(2)
  v_mfma_f32_16x16x32_bf16 v[184:187], v[168:171], v[116:119], v[184:187]
  v_mfma_f32_16x16x32_bf16 v[188:191], v[168:171], v[128:131], v[188:191]
  v_mfma_f32_16x16x32_bf16 v[192:195], v[172:175], v[116:119], v[192:195]
  v_mfma_f32_16x16x32_bf16 v[196:199], v[172:175], v[128:131], v[196:199]
  s_waitcnt lgkmcnt(0)
  s_add_u32 m0, s96, 76032
  s_mov_b64 exec, s[94:95]
  s_add_u32 s97, s64, 1216512
  buffer_load_dwordx4 v220, s[60:63], s97 offen sc1 lds
  s_mov_b64 exec, -1
  v_mfma_f32_16x16x32_bf16 v[184:187], v[176:179], v[120:123], v[184:187]
  v_mfma_f32_16x16x32_bf16 v[188:191], v[176:179], v[132:135], v[188:191]
  v_mfma_f32_16x16x32_bf16 v[192:195], v[180:183], v[120:123], v[192:195]
  v_mfma_f32_16x16x32_bf16 v[196:199], v[180:183], v[132:135], v[196:199]
  s_nop 4
  v_pk_mul_f32 v[208:209], v[184:185], v[96:97]
  v_pk_mul_f32 v[212:213], v[188:189], v[96:97]
  v_pk_fma_f32 v[208:209], v[188:189], v[104:105], v[208:209]
  v_pk_fma_f32 v[212:213], v[184:185], v[104:105], v[212:213] neg_lo:[1,0,0] neg_hi:[1,0,0]
  v_pk_mul_f32 v[210:211], v[186:187], v[98:99]
  v_pk_mul_f32 v[214:215], v[190:191], v[98:99]
  v_pk_fma_f32 v[210:211], v[190:191], v[106:107], v[210:211]
  s_add_u32 m0, s96, 82944
  s_mov_b64 exec, s[94:95]
  s_add_u32 s97, s64, 1327104
  buffer_load_dwordx4 v220, s[60:63], s97 offen sc1 lds
  s_mov_b64 exec, -1
  v_pk_fma_f32 v[214:215], v[186:187], v[106:107], v[214:215] neg_lo:[1,0,0] neg_hi:[1,0,0]
  v_cvt_pk_bf16_f32 v200, v208, v212
  v_cvt_pk_bf16_f32 v201, v209, v213
  v_cvt_pk_bf16_f32 v202, v210, v214
  v_cvt_pk_bf16_f32 v203, v211, v215
  v_pk_mul_f32 v[208:209], v[192:193], v[100:101]
  v_pk_mul_f32 v[212:213], v[196:197], v[100:101]
  v_pk_fma_f32 v[208:209], v[196:197], v[108:109], v[208:209]
  v_pk_fma_f32 v[212:213], v[192:193], v[108:109], v[212:213] neg_lo:[1,0,0] neg_hi:[1,0,0]
  v_pk_mul_f32 v[210:211], v[194:195], v[102:103]
  v_pk_mul_f32 v[214:215], v[198:199], v[102:103]
  s_add_u32 m0, s96, 89856
  s_mov_b64 exec, s[94:95]
  s_add_u32 s97, s64, 1437696
  buffer_load_dwordx4 v220, s[60:63], s97 offen sc1 lds
  s_mov_b64 exec, -1
  v_pk_fma_f32 v[210:211], v[198:199], v[110:111], v[210:211]
  v_pk_fma_f32 v[214:215], v[194:195], v[110:111], v[214:215] neg_lo:[1,0,0] neg_hi:[1,0,0]
  v_cvt_pk_bf16_f32 v204, v208, v212
  v_cvt_pk_bf16_f32 v205, v209, v213
  v_cvt_pk_bf16_f32 v206, v210, v214
  v_cvt_pk_bf16_f32 v207, v211, v215
  v_mfma_f32_16x16x32_bf16 v[184:187], v[88:91], v[200:203], 0
  v_mfma_f32_16x16x32_bf16 v[188:191], v[92:95], v[200:203], 0
  v_mfma_f32_16x16x32_bf16 v[192:195], v[144:147], v[200:203], 0
  v_mfma_f32_16x16x32_bf16 v[196:199], v[148:151], v[200:203], 0
  v_mfma_f32_16x16x32_bf16 v[184:187], v[136:139], v[204:207], v[184:187]
  s_add_u32 m0, s96, 96768
  s_mov_b64 exec, s[94:95]
  s_add_u32 s97, s64, 1548288
  buffer_load_dwordx4 v220, s[60:63], s97 offen sc1 lds
  s_mov_b64 exec, -1
  v_mfma_f32_16x16x32_bf16 v[188:191], v[140:143], v[204:207], v[188:191]
  v_mfma_f32_16x16x32_bf16 v[192:195], v[72:75], v[204:207], v[192:195]
  v_mfma_f32_16x16x32_bf16 v[196:199], v[76:79], v[204:207], v[196:199]
  s_waitcnt vmcnt(11)
  v_lshlrev_b32 v56, 16, v48
  v_and_b32 v64, 0xffff0000, v48
  v_lshlrev_b32 v57, 16, v49
  v_and_b32 v65, 0xffff0000, v49
  v_lshlrev_b32 v58, 16, v50
  v_and_b32 v66, 0xffff0000, v50
  v_lshlrev_b32 v59, 16, v51
  s_add_u32 m0, s96, 103680
  s_mov_b64 exec, s[94:95]
  s_add_u32 s97, s64, 1658880
  buffer_load_dwordx4 v220, s[60:63], s97 offen sc1 lds
  s_mov_b64 exec, -1
  v_and_b32 v67, 0xffff0000, v51
  v_lshlrev_b32 v60, 16, v52
  v_and_b32 v68, 0xffff0000, v52
  v_lshlrev_b32 v61, 16, v53
  v_and_b32 v69, 0xffff0000, v53
  v_lshlrev_b32 v62, 16, v54
  v_and_b32 v70, 0xffff0000, v54
  v_lshlrev_b32 v63, 16, v55
  v_and_b32 v71, 0xffff0000, v55
  v_pk_mul_f32 v[208:209], v[184:185], v[56:57]
  v_pk_mul_f32 v[212:213], v[188:189], v[56:57] neg_lo:[1,0] neg_hi:[1,0]
  v_pk_fma_f32 v[208:209], v[188:189], v[64:65], v[208:209] neg_lo:[1,0,0] neg_hi:[1,0,0]
  s_add_u32 m0, s96, 110592
  s_mov_b64 exec, s[94:95]
  s_add_u32 s97, s64, 1769472
  buffer_load_dwordx4 v220, s[60:63], s97 offen sc1 lds
  s_mov_b64 exec, -1
  v_pk_fma_f32 v[212:213], v[184:185], v[64:65], v[212:213] neg_lo:[1,0,0] neg_hi:[1,0,0]
  v_pk_mul_f32 v[210:211], v[186:187], v[58:59]
  v_pk_mul_f32 v[214:215], v[190:191], v[58:59] neg_lo:[1,0] neg_hi:[1,0]
  v_pk_fma_f32 v[210:211], v[190:191], v[66:67], v[210:211] neg_lo:[1,0,0] neg_hi:[1,0,0]
  v_pk_fma_f32 v[214:215], v[186:187], v[66:67], v[214:215] neg_lo:[1,0,0] neg_hi:[1,0,0]
  v_cvt_pk_bf16_f32 v200, v208, v212
  v_cvt_pk_bf16_f32 v201, v209, v213
  v_cvt_pk_bf16_f32 v202, v210, v214
  v_cvt_pk_bf16_f32 v203, v211, v215
  v_pk_mul_f32 v[208:209], v[192:193], v[60:61]
  v_pk_mul_f32 v[212:213], v[196:197], v[60:61] neg_lo:[1,0] neg_hi:[1,0]
  s_add_u32 m0, s96, 117504
  s_mov_b64 exec, s[94:95]
  s_add_u32 s97, s64, 1880064
  buffer_load_dwordx4 v220, s[60:63], s97 offen sc1 lds
  s_mov_b64 exec, -1
  v_pk_fma_f32 v[208:209], v[196:197], v[68:69], v[208:209] neg_lo:[1,0,0] neg_hi:[1,0,0]
  v_pk_fma_f32 v[212:213], v[192:193], v[68:69], v[212:213] neg_lo:[1,0,0] neg_hi:[1,0,0]
  v_pk_mul_f32 v[210:211], v[194:195], v[62:63]
  v_pk_mul_f32 v[214:215], v[198:199], v[62:63] neg_lo:[1,0] neg_hi:[1,0]
  v_pk_fma_f32 v[210:211], v[198:199], v[70:71], v[210:211] neg_lo:[1,0,0] neg_hi:[1,0,0]
  v_pk_fma_f32 v[214:215], v[194:195], v[70:71], v[214:215] neg_lo:[1,0,0] neg_hi:[1,0,0]
  v_cvt_pk_bf16_f32 v204, v208, v212
  v_cvt_pk_bf16_f32 v205, v209, v213
  v_cvt_pk_bf16_f32 v206, v210, v214
  v_cvt_pk_bf16_f32 v207, v211, v215
  v_mfma_f32_16x16x32_bf16 v[184:187], v[88:91], v[200:203], 0
  s_add_u32 m0, s96, 41472
  s_mov_b64 exec, s[98:99]
  s_add_u32 s97, s64, 663552
  buffer_load_dwordx4 v220, s[60:63], s97 offen sc1 lds
  s_mov_b64 exec, -1
  v_mfma_f32_16x16x32_bf16 v[188:191], v[92:95], v[200:203], 0
  v_mfma_f32_16x16x32_bf16 v[192:195], v[144:147], v[200:203], 0
  v_mfma_f32_16x16x32_bf16 v[196:199], v[148:151], v[200:203], 0
  v_mfma_f32_16x16x32_bf16 v[184:187], v[136:139], v[204:207], v[184:187]
  v_mfma_f32_16x16x32_bf16 v[188:191], v[140:143], v[204:207], v[188:191]
  v_mfma_f32_16x16x32_bf16 v[192:195], v[72:75], v[204:207], v[192:195]
  v_mfma_f32_16x16x32_bf16 v[196:199], v[76:79], v[204:207], v[196:199]
  s_nop 4
  v_pk_mul_f32 v[208:209], v[184:185], v[96:97]
  v_pk_mul_f32 v[212:213], v[188:189], v[96:97]
  v_pk_fma_f32 v[208:209], v[188:189], v[104:105], v[208:209]
  v_pk_fma_f32 v[212:213], v[184:185], v[104:105], v[212:213] neg_lo:[1,0,0] neg_hi:[1,0,0]
  s_add_u32 m0, s96, 48384
  s_mov_b64 exec, s[98:99]
  s_add_u32 s97, s64, 774144
  buffer_load_dwordx4 v220, s[60:63], s97 offen sc1 lds
  s_mov_b64 exec, -1
  v_pk_mul_f32 v[210:211], v[186:187], v[98:99]
  v_pk_mul_f32 v[214:215], v[190:191], v[98:99]
  v_pk_fma_f32 v[210:211], v[190:191], v[106:107], v[210:211]
  v_pk_fma_f32 v[214:215], v[186:187], v[106:107], v[214:215] neg_lo:[1,0,0] neg_hi:[1,0,0]
  v_cvt_pk_bf16_f32 v200, v208, v212
  v_cvt_pk_bf16_f32 v201, v209, v213
  v_cvt_pk_bf16_f32 v202, v210, v214
  v_cvt_pk_bf16_f32 v203, v211, v215
  ds_write_b32 v13, v200 offset:0
  ds_write_b32 v13, v201 offset:272
  ds_write_b32 v13, v202 offset:544
  s_add_u32 m0, s96, 55296
  s_mov_b64 exec, s[98:99]
  s_add_u32 s97, s64, 884736
  buffer_load_dwordx4 v220, s[60:63], s97 offen sc1 lds
  s_mov_b64 exec, -1
  ds_write_b32 v13, v203 offset:816
  v_pk_mul_f32 v[208:209], v[192:193], v[100:101]
  v_pk_mul_f32 v[212:213], v[196:197], v[100:101]
  v_pk_fma_f32 v[208:209], v[196:197], v[108:109], v[208:209]
  v_pk_fma_f32 v[212:213], v[192:193], v[108:109], v[212:213] neg_lo:[1,0,0] neg_hi:[1,0,0]
  v_pk_mul_f32 v[210:211], v[194:195], v[102:103]
  v_pk_mul_f32 v[214:215], v[198:199], v[102:103]
  v_pk_fma_f32 v[210:211], v[198:199], v[110:111], v[210:211]
  v_pk_fma_f32 v[214:215], v[194:195], v[110:111], v[214:215] neg_lo:[1,0,0] neg_hi:[1,0,0]
  v_cvt_pk_bf16_f32 v204, v208, v212
  v_cvt_pk_bf16_f32 v205, v209, v213
  s_add_u32 m0, s96, 62208
  s_mov_b64 exec, s[98:99]
  s_add_u32 s97, s64, 995328
  buffer_load_dwordx4 v220, s[60:63], s97 offen sc1 lds
  s_mov_b64 exec, -1
  v_cvt_pk_bf16_f32 v206, v210, v214
  v_cvt_pk_bf16_f32 v207, v211, v215
  ds_write_b32 v13, v204 offset:4352
  ds_write_b32 v13, v205 offset:4624
  ds_write_b32 v13, v206 offset:4896
  ds_write_b32 v13, v207 offset:5168
  s_waitcnt lgkmcnt(0)
  s_barrier
  ds_read_b128 v[152:155], v7 offset:0
  ds_read_b128 v[156:159], v7 offset:8704
  ds_read_b128 v[160:163], v7 offset:64
  ds_read_b128 v[164:167], v7 offset:8768
  ds_read_b128 v[168:171], v7 offset:128
  ds_read_b128 v[172:175], v7 offset:8832
  ds_read_b128 v[176:179], v7 offset:192
  ds_read_b128 v[180:183], v7 offset:8896
  s_waitcnt lgkmcnt(6)
  v_mfma_f32_16x16x32_bf16 v[184:187], v[80:83], v[152:155], 0
  v_mfma_f32_16x16x32_bf16 v[188:191], v[84:87], v[152:155], 0
  v_mfma_f32_16x16x32_bf16 v[192:195], v[80:83], v[156:159], 0
  v_mfma_f32_16x16x32_bf16 v[196:199], v[84:87], v[156:159], 0
  s_waitcnt lgkmcnt(4)
  v_mfma_f32_16x16x32_bf16 v[184:187], v[112:115], v[160:163], v[184:187]
  v_mfma_f32_16x16x32_bf16 v[188:191], v[124:127], v[160:163], v[188:191]
  v_mfma_f32_16x16x32_bf16 v[192:195], v[112:115], v[164:167], v[192:195]
  v_mfma_f32_16x16x32_bf16 v[196:199], v[124:127], v[164:167], v[196:199]
  s_waitcnt lgkmcnt(2)
  v_mfma_f32_16x16x32_bf16 v[184:187], v[116:119], v[168:171], v[184:187]
  v_mfma_f32_16x16x32_bf16 v[188:191], v[128:131], v[168:171], v[188:191]
  v_mfma_f32_16x16x32_bf16 v[192:195], v[116:119], v[172:175], v[192:195]
  v_mfma_f32_16x16x32_bf16 v[196:199], v[128:131], v[172:175], v[196:199]
  s_waitcnt lgkmcnt(0)
  v_mfma_f32_16x16x32_bf16 v[184:187], v[120:123], v[176:179], v[184:187]
  v_mfma_f32_16x16x32_bf16 v[188:191], v[132:135], v[176:179], v[188:191]
  v_mfma_f32_16x16x32_bf16 v[192:195], v[120:123], v[180:183], v[192:195]
  v_mfma_f32_16x16x32_bf16 v[196:199], v[132:135], v[180:183], v[196:199]
  s_nop 4
  v_pk_fma_f32 v[28:29], v[184:185], s[58:59], v[28:29]
  v_pk_fma_f32 v[32:33], v[188:189], s[54:55], v[32:33]
  v_pk_fma_f32 v[30:31], v[186:187], s[58:59], v[30:31]
  v_pk_fma_f32 v[34:35], v[190:191], s[54:55], v[34:35]
  v_cvt_pk_bf16_f32 v16, v28, v32
  v_cvt_pk_bf16_f32 v18, v29, v33
  v_cvt_pk_bf16_f32 v20, v30, v34
  v_cvt_pk_bf16_f32 v22, v31, v35
  v_pk_fma_f32 v[36:37], v[192:193], s[58:59], v[36:37]
  v_pk_fma_f32 v[40:41], v[196:197], s[56:57], v[40:41]
  v_pk_fma_f32 v[38:39], v[194:195], s[58:59], v[38:39]
  v_pk_fma_f32 v[42:43], v[198:199], s[56:57], v[42:43]
  v_cvt_pk_bf16_f32 v17, v36, v40
  v_cvt_pk_bf16_f32 v19, v37, v41
  v_cvt_pk_bf16_f32 v21, v38, v42
  v_cvt_pk_bf16_f32 v23, v39, v43
  buffer_store_dwordx4 v[16:19], v6, s[36:39], s49 offen sc1
  buffer_store_dwordx4 v[20:23], v6, s[36:39], s49 offen offset:1024 sc1
  s_waitcnt vmcnt(2)
  s_barrier
  ds_read_b128 v[112:115], v14 offset:0
  ds_read_b128 v[120:123], v14 offset:6912
  ds_read_b128 v[128:131], v14 offset:13824
  ds_read_b128 v[136:139], v14 offset:20736
  ds_read_b128 v[144:147], v14 offset:27648
  ds_read_b128 v[152:155], v14 offset:34560
  ds_read_b128 v[160:163], v14 offset:41472
  ds_read_b128 v[168:171], v14 offset:48384
  ds_read_b128 v[176:179], v14 offset:55296
  ds_read_b128 v[184:187], v15 offset:0
  ds_read_b128 v[192:195], v15 offset:6912
  ds_read_b128 v[200:203], v15 offset:13824
  v_mov_b32 v4, s100
  v_mov_b32 v5, s101
  s_lshl_b32 s43, s43, 7
  s_add_u32 s43, s43, s65
  s_mov_b64 exec, 1
  s_waitcnt vmcnt(0)
  buffer_store_dwordx2 v[4:5], off, s[68:71], s43 sc1
  s_mov_b64 exec, -1
  s_branch fft_end
fft_r1:
  s_add_u32 s60, s10, 2359296
  s_addc_u32 s61, s11, 0
  s_mov_b32 s62, 1990656
  s_mov_b32 s63, 0x20000
  s_and_b32 s41, s22, 1
  s_mul_i32 s41, s41, 54
  v_add_u32 v4, s41, v1
  v_bfe_u32 v5, v4, 4, 1
  v_bfe_u32 v6, v4, 5, 1
  v_mul_u32_u24 v7, 576, v5
  v_mad_u32_u24 v7, v6, 18, v7
  v_bfe_u32 v6, v4, 2, 1
  v_lshl_add_u32 v7, v6, 3, v7
  v_bfe_u32 v6, v4, 3, 1
  v_lshl_add_u32 v7, v6, 2, v7
  v_and_b32 v6, 3, v4
  v_add_u32 v7, v7, v6
  v_lshl_add_u32 v5, v5, 1, v4
  v_add_u32 v5, 1088, v5
  v_cmp_gt_u32 vcc, 64, v4
  s_nop 1
  v_cndmask_b32 v7, v5, v7, vcc
  v_bfe_u32 v5, v4, 2, 2
  v_mul_u32_u24 v5, 576, v5
  v_lshrrev_b32 v6, 1, v6
  v_mad_u32_u24 v5, v6, 18, v5
  v_and_or_b32 v6, v4, 1, 16
  v_add_u32 v5, v5, v6
  v_cmp_gt_u32 vcc, 96, v4
  s_nop 1
  v_cndmask_b32 v7, v5, v7, vcc
  s_lshr_b32 s41, s88, 4
  s_mul_i32 s41, s41, 36
  v_add_lshl_u32 v220, v7, s41, 4
  s_bfm_b64 s[94:95], 54, 0
  s_lshr_b32 s64, s22, 1
  s_mul_i32 s64, s64, 27648
  s_mul_i32 s96, s22, 864
  s_cmp_eq_u32 s23, 0
  s_cselect_b64 s[98:99], s[94:95], 0
  s_and_b32 s41, s22, 3
  s_cmp_eq_u32 s41, 3
  s_cbranch_scc1 wra_x
  s_lshl_b32 s41, s41, 5
  v_mul_u32_u24 v14, 108, v3
  v_add3_u32 v14, v14, v2, s41
  s_branch wra_e
wra_x:
  v_bfe_u32 v14, v1, 2, 2
  v_and_b32 v4, 1, v14
  v_or_b32 v4, 4, v4
  v_and_b32 v15, 2, v1
  v_cmp_eq_u32 vcc, 0, v15
  s_nop 1
  v_cndmask_b32 v14, v4, v14, vcc
  v_and_b32 v4, 1, v1
  v_lshl_add_u32 v14, v14, 1, v4
  v_lshrrev_b32 v4, 4, v1
  v_mul_u32_u24 v4, 108, v4
  v_add_u32 v14, 96, v14
  v_add_u32 v14, v14, v4
wra_e:
  v_lshlrev_b32 v14, 4, v14
  v_add_u32 v15, 62208, v14
  s_cmp_lg_u32 s23, 0
  s_cbranch_scc1 fft_r2
  s_sub_u32 s46, s2, 144
  s_lshl_b32 s46, s46, 3
  s_add_u32 s46, s46, s22
  s_cmp_ge_u32 s46, 324
  s_cbranch_scc1 fft_r3
  s_lshl_b32 s46, s46, 1
  v_add_u32 v5, s46, v3
  v_mul_u32_u24 v6, 7282, v5
  v_lshrrev_b32 v6, 16, v6
  v_mul_u32_u24 v7, 9, v6
  v_sub_u32 v5, v5, v7
  v_lshl_add_u32 v5, v5, 5, v2
  v_lshlrev_b32 v7, 3, v6
  v_lshrrev_b32 v8, 4, v7
  v_lshl_add_u32 v8, v8, 1, v7
  v_subrev_u32 v9, 512, v7
  v_cmp_gt_u32 vcc, 512, v7
  v_and_b32 v7, 1, v9
  v_lshrrev_b32 v9, 1, v9
  v_mul_u32_u24 v9, 18, v9
  v_add3_u32 v7, v7, v9, 16
  v_cndmask_b32 v7, v7, v8, vcc
  v_mov_b32 v8, 20736
  v_mov_b32 v9, 2304
  v_cndmask_b32 v8, v8, v9, vcc
  v_mul_u32_u24 v7, 1152, v7
  v_lshl_add_u32 v10, v5, 2, v7
  v_add_u32 v11, v10, v8
  v_add_u32 v12, v11, v8
  v_add_u32 v13, v12, v8
  v_mul_u32_u24 v6, 9216, v6
  v_lshl_add_u32 v5, v5, 5, v6
  s_mov_b32 s44, 0x05040100
  s_mov_b32 s45, 0x07060302
  s_mov_b32 s24, s14
  s_mov_b32 s25, s15
  s_mov_b32 s26, 663552
  s_mov_b32 s27, 0x20000
  s_add_u32 s32, s10, 5505024
  s_addc_u32 s33, s11, 0
  s_mov_b32 s34, 663552
  s_mov_b32 s35, 0x20000
  buffer_load_dword v16, v10, s[24:27], 0 offen offset:0
  buffer_load_dword v17, v10, s[24:27], 0 offen offset:1152
  buffer_load_dword v18, v11, s[24:27], 0 offen offset:0
  buffer_load_dword v19, v11, s[24:27], 0 offen offset:1152
  buffer_load_dword v20, v12, s[24:27], 0 offen offset:0
  buffer_load_dword v21, v12, s[24:27], 0 offen offset:1152
  buffer_load_dword v22, v13, s[24:27], 0 offen offset:0
  buffer_load_dword v23, v13, s[24:27], 0 offen offset:1152
  s_waitcnt vmcnt(0)
  v_perm_b32 v24, v17, v16, s44
  v_perm_b32 v28, v17, v16, s45
  v_perm_b32 v25, v19, v18, s44
  v_perm_b32 v29, v19, v18, s45
  v_perm_b32 v26, v21, v20, s44
  v_perm_b32 v30, v21, v20, s45
  v_perm_b32 v27, v23, v22, s44
  v_perm_b32 v31, v23, v22, s45
  buffer_store_dwordx4 v[24:27], v5, s[32:35], 0 offen sc1
  buffer_store_dwordx4 v[28:31], v5, s[32:35], 0 offen offset:16 sc1
fft_r3:
  v_bfe_u32 v4, v1, 3, 2
  v_mul_u32_u24 v4, 576, v4
  v_bfe_u32 v5, v1, 2, 1
  v_mul_u32_u24 v5, 35, v5
  s_lshr_b32 s41, s88, 4
  s_mul_i32 s41, s41, 36
  v_add3_u32 v4, v4, v5, s41
  v_lshrrev_b32 v4, 6, v4
  v_mul_u32_u24 v4, 3, v4
  v_and_b32 v5, 3, v1
  v_add_u32 v4, v4, v5
  v_add_u32 v4, 1024, v4
  s_mov_b64 exec, 0x777777
  v_lshlrev_b32 v4, 7, v4
  s_mov_b32 s3, 65536
poll8:
  buffer_load_dwordx2 v[8:9], v4, s[68:71], 0 offen sc1
  s_waitcnt vmcnt(0)
  v_cmp_ne_u64 vcc, s[100:101], v[8:9]
  s_sub_u32 s3, s3, 1
  s_cbranch_scc1 poll8_x
  s_mov_b64 exec, vcc
  s_cbranch_vccnz poll8
poll8_x:
  s_mov_b64 exec, -1
  s_add_u32 m0, s96, 0
  s_mov_b64 exec, s[94:95]
  s_add_u32 s97, s64, 0
  buffer_load_dwordx4 v220, s[60:63], s97 offen sc1 lds
  s_mov_b64 exec, -1
  s_add_u32 m0, s96, 6912
  s_mov_b64 exec, s[94:95]
  s_add_u32 s97, s64, 110592
  buffer_load_dwordx4 v220, s[60:63], s97 offen sc1 lds
  s_mov_b64 exec, -1
  s_add_u32 m0, s96, 13824
  s_mov_b64 exec, s[94:95]
  s_add_u32 s97, s64, 221184
  buffer_load_dwordx4 v220, s[60:63], s97 offen sc1 lds
  s_mov_b64 exec, -1
  s_add_u32 m0, s96, 20736
  s_mov_b64 exec, s[94:95]
  s_add_u32 s97, s64, 331776
  buffer_load_dwordx4 v220, s[60:63], s97 offen sc1 lds
  s_mov_b64 exec, -1
  s_add_u32 m0, s96, 27648
  s_mov_b64 exec, s[94:95]
  s_add_u32 s97, s64, 442368
  buffer_load_dwordx4 v220, s[60:63], s97 offen sc1 lds
  s_mov_b64 exec, -1
  s_add_u32 m0, s96, 34560
  s_mov_b64 exec, s[94:95]
  s_add_u32 s97, s64, 552960
  buffer_load_dwordx4 v220, s[60:63], s97 offen sc1 lds
  s_mov_b64 exec, -1
  s_add_u32 m0, s96, 41472
  s_mov_b64 exec, s[94:95]
  s_add_u32 s97, s64, 663552
  buffer_load_dwordx4 v220, s[60:63], s97 offen sc1 lds
  s_mov_b64 exec, -1
  s_add_u32 m0, s96, 48384
  s_mov_b64 exec, s[94:95]
  s_add_u32 s97, s64, 774144
  buffer_load_dwordx4 v220, s[60:63], s97 offen sc1 lds
  s_mov_b64 exec, -1
  s_add_u32 m0, s96, 55296
  s_mov_b64 exec, s[94:95]
  s_add_u32 s97, s64, 884736
  buffer_load_dwordx4 v220, s[60:63], s97 offen sc1 lds
  s_mov_b64 exec, -1
  s_add_u32 m0, s96, 62208
  s_mov_b64 exec, s[94:95]
  s_add_u32 s97, s64, 995328
  buffer_load_dwordx4 v220, s[60:63], s97 offen sc1 lds
  s_mov_b64 exec, -1
  s_branch fft_r4
fft_r2:
  s_cmp_ge_u32 s2, 192
  s_cbranch_scc1 fft_r4
  s_lshl_b32 s41, s23, 2
  s_and_b32 s41, s41, s22
  s_cbranch_scc0 fft_r4
  s_waitcnt lgkmcnt(0)
  s_barrier
  s_barrier
fft_r4:
  s_add_u32 m0, s96, 69120
  s_mov_b64 exec, s[94:95]
  s_add_u32 s97, s64, 1105920
  buffer_load_dwordx4 v220, s[60:63], s97 offen sc1 lds
  s_mov_b64 exec, -1
  s_add_u32 m0, s96, 76032
  s_mov_b64 exec, s[94:95]
  s_add_u32 s97, s64, 1216512
  buffer_load_dwordx4 v220, s[60:63], s97 offen sc1 lds
  s_mov_b64 exec, -1
  s_add_u32 m0, s96, 82944
  s_mov_b64 exec, s[94:95]
  s_add_u32 s97, s64, 1327104
  buffer_load_dwordx4 v220, s[60:63], s97 offen sc1 lds
  s_mov_b64 exec, -1
  s_add_u32 m0, s96, 89856
  s_mov_b64 exec, s[94:95]
  s_add_u32 s97, s64, 1437696
  buffer_load_dwordx4 v220, s[60:63], s97 offen sc1 lds
  s_mov_b64 exec, -1
  s_add_u32 m0, s96, 96768
  s_mov_b64 exec, s[94:95]
  s_add_u32 s97, s64, 1548288
  buffer_load_dwordx4 v220, s[60:63], s97 offen sc1 lds
  s_mov_b64 exec, -1
  s_add_u32 m0, s96, 103680
  s_mov_b64 exec, s[94:95]
  s_add_u32 s97, s64, 1658880
  buffer_load_dwordx4 v220, s[60:63], s97 offen sc1 lds
  s_mov_b64 exec, -1
  s_add_u32 m0, s96, 110592
  s_mov_b64 exec, s[94:95]
  s_add_u32 s97, s64, 1769472
  buffer_load_dwordx4 v220, s[60:63], s97 offen sc1 lds
  s_mov_b64 exec, -1
  s_add_u32 m0, s96, 117504
  s_mov_b64 exec, s[94:95]
  s_add_u32 s97, s64, 1880064
  buffer_load_dwordx4 v220, s[60:63], s97 offen sc1 lds
  s_mov_b64 exec, -1
  s_waitcnt vmcnt(0)
  s_barrier
  ds_read_b128 v[112:115], v14 offset:0
  ds_read_b128 v[120:123], v14 offset:6912
  ds_read_b128 v[128:131], v14 offset:13824
  ds_read_b128 v[136:139], v14 offset:20736
  ds_read_b128 v[144:147], v14 offset:27648
  ds_read_b128 v[152:155], v14 offset:34560
  ds_read_b128 v[160:163], v14 offset:41472
  ds_read_b128 v[168:171], v14 offset:48384
  ds_read_b128 v[176:179], v14 offset:55296
  ds_read_b128 v[184:187], v15 offset:0
  ds_read_b128 v[192:195], v15 offset:6912
  ds_read_b128 v[200:203], v15 offset:13824
fft_end:
  ds_read_b128 v[208:211], v15 offset:20736
  ds_read_b128 v[216:219], v15 offset:27648
  ds_read_b128 v[224:227], v15 offset:34560
  ds_read_b128 v[232:235], v15 offset:41472
  ds_read_b128 v[240:243], v15 offset:48384
  ds_read_b128 v[248:251], v15 offset:55296
  s_and_b32 s41, s22, 3
  s_cmp_eq_u32 s41, 3
  s_cbranch_scc1 fft_e2
  ds_read_b128 v[116:119], v14 offset:3456
  ds_read_b128 v[124:127], v14 offset:10368
  ds_read_b128 v[132:135], v14 offset:17280
  ds_read_b128 v[140:143], v14 offset:24192
  ds_read_b128 v[148:151], v14 offset:31104
  ds_read_b128 v[156:159], v14 offset:38016
  ds_read_b128 v[164:167], v14 offset:44928
  ds_read_b128 v[172:175], v14 offset:51840
  ds_read_b128 v[180:183], v14 offset:58752
  ds_read_b128 v[188:191], v15 offset:3456
  ds_read_b128 v[196:199], v15 offset:10368
  ds_read_b128 v[204:207], v15 offset:17280
  ds_read_b128 v[212:215], v15 offset:24192
  ds_read_b128 v[220:223], v15 offset:31104
  ds_read_b128 v[228:231], v15 offset:38016
  ds_read_b128 v[236:239], v15 offset:44928
  ds_read_b128 v[244:247], v15 offset:51840
  ds_read_b128 v[252:255], v15 offset:58752
fft_e2:
  s_mov_b32 s40, s22
  s_mov_b64 exec, -1
  s_setprio 0
  s_and_b32 s45, s40, 3
  s_lshr_b32 s44, s40, 2
  s_and_b32 s41, s88, 7
  s_lshl_b32 s46, s41, 1
  s_bfe_u32 s42, s88, 0x10003
  s_add_u32 s46, s46, s42
  s_lshr_b32 s47, s88, 4
  s_lshl_b32 s41, s41, 8
  s_lshl_b32 s42, s40, 1
  s_add_u32 s41, s41, s42
  s_add_u32 s41, s41, 2048
  v_lshrrev_b32 v4, 1, v1
  v_and_b32 v5, 1, v1
  v_lshl_add_u32 v4, v4, 4, v5
  v_add_u32 v4, s41, v4
  s_and_b32 s41, s40, 1
  s_lshl_b32 s41, s41, 3
  v_xor_b32 v5, s41, v2
  v_lshlrev_b32 v5, 4, v5
  v_lshl_add_u32 v5, v3, 14, v5
  s_lshl_b32 s48, s40, 15
  s_lshl_b32 s41, s46, 10
  s_add_u32 s48, s48, s41
  s_lshl_b32 m0, s40, 10
  s_lshl_b32 s43, s47, 4
  s_add_u32 s43, s43, s46
  s_lshl_b32 s43, s43, 3
  s_add_u32 s43, s43, s40
  s_add_u32 s43, s43, 4096
  s_mul_i32 s60, s47, 294912
  s_mul_i32 s41, s46, 9216
  s_add_u32 s60, s60, s41
  s_add_u32 s60, s60, 2359296
  s_lshl_b32 s61, s44, 8
  s_lshl_b32 s63, s44, 7
  s_add_u32 s63, s63, 147456
  s_cmp_eq_u32 s45, 3
  s_cbranch_scc1 qkv_sx
  v_lshlrev_b32 v6, 4, v3
  v_xor_b32 v6, v6, v2
  v_lshlrev_b32 v6, 3, v6
  v_lshl_add_u32 v6, v3, 10, v6
  v_add_u32 v6, s61, v6
  v_add_u32 v7, 0x10000, v6
  v_add_u32 v8, 0x20000, v6
  s_cmp_eq_u32 s45, 2
  s_cbranch_scc1 qkv_sv
  v_lshl_add_u32 v9, v2, 2, s63
  v_lshlrev_b32 v13, 4, v2
  v_lshl_add_u32 v12, v3, 15, v13
  v_lshl_add_u32 v13, v3, 11, v13
  s_lshl_b32 s62, s47, 1
  s_add_u32 s62, s62, s45
  s_lshl_b32 s62, s62, 16
  s_lshl_b32 s41, s46, 11
  s_add_u32 s62, s62, s41
  s_lshl_b32 s41, s44, 9
  s_add_u32 s62, s62, s41
  s_mul_i32 s41, s45, 147456
  s_add_u32 s64, s60, s41
  s_lshl_b32 s41, s44, 10
  s_add_u32 s64, s64, s41
  s_branch qkv_se
qkv_sv:
  v_lshl_add_u32 v9, v3, 4, s63
  v_lshrrev_b32 v12, 4, v2
  v_mul_u32_u24 v12, 147456, v12
  v_and_b32 v13, 15, v2
  v_lshl_add_u32 v12, v13, 4, v12
  v_lshl_add_u32 v12, v3, 8, v12
  s_mul_i32 s41, s44, 2304
  s_add_u32 s64, s41, s60
  s_add_u32 s64, s64, 4608
  s_branch qkv_se
qkv_sx:
  v_lshrrev_b32 v10, 4, v1
  v_lshlrev_b32 v6, 3, v2
  v_lshl_add_u32 v6, v10, 10, v6
  v_add_u32 v6, s61, v6
  v_add_u32 v7, 0x10000, v6
  v_add_u32 v8, 0x20000, v6
  v_and_b32 v11, 15, v1
  v_lshl_add_u32 v12, v11, 2, s63
  v_cmp_eq_u32 vcc, 0, v10
  v_mov_b32 v111, 0xffff
  s_nop 0
  v_cndmask_b32 v111, -1, v111, vcc
  v_mov_b32 v110, 0x3727c5ac
  v_and_b32 v10, 1, v10
  s_lshl_b32 s41, s47, 14
  s_lshl_b32 s42, s46, 9
  s_add_u32 s41, s41, s42
  s_add_u32 s41, s41, s61
  s_add_u32 s41, s41, 2097152
  v_lshl_add_u32 v104, v10, 13, s41
  s_add_u32 s41, s60, s61
  s_add_u32 s41, s41, 4096
  v_mul_u32_u24 v109, 147456, v10
  v_add_u32 v105, s41, v109
  v_cmp_eq_u32 vcc, 0, v3
  s_nop 1
  v_cndmask_b32 v104, v105, v104, vcc
  v_lshl_add_u32 v108, v11, 4, v104
  s_lshl_b32 s41, s44, 9
  s_add_u32 s41, s41, 147968
  v_lshl_add_u32 v107, v2, 4, s41
  v_lshl_add_u32 v13, v10, 8, s41
  v_bfe_u32 v104, v1, 2, 1
  v_lshl_add_u32 v13, v104, 5, v13
  v_bfe_u32 v104, v1, 3, 1
  v_lshl_add_u32 v13, v104, 3, v13
  v_and_b32 v104, 3, v1
  v_lshl_add_u32 v13, v104, 1, v13
  v_lshl_add_u32 v109, v104, 4, v109
  v_bfe_u32 v104, v1, 2, 2
  v_mul_u32_u24 v104, 576, v104
  v_add_u32 v109, v109, v104
  v_xor_b32 v9, 128, v6
  v_xor_b32 v10, 128, v7
  v_xor_b32 v11, 128, v8
  s_mul_i32 s41, s44, 2304
  s_add_u32 s64, s41, s60
  s_add_u32 s64, s64, 5120
  s_mov_b32 s54, 0xaaaaaaaa
  s_mov_b32 s55, s54
  s_mov_b32 s56, 0xcccccccc
  s_mov_b32 s57, s56
  s_mov_b32 s58, 0x00f0000f
  s_mov_b32 s59, 0xf0000f00
  v_mov_b32 v14, v108
  v_mov_b32 v15, v107
qkv_se:
  s_add_u32 s24, s20, 2424832
  s_addc_u32 s25, s21, 0
  s_mov_b32 s26, 2359296
  s_mov_b32 s27, 0x20000
  s_add_u32 s32, s20, 4784128
  s_addc_u32 s33, s21, 0
  s_mov_b32 s34, 7077888
  s_mov_b32 s35, 0x20000
  s_waitcnt lgkmcnt(0)
  s_barrier
  s_cmp_lt_u32 s2, 144
  s_cbranch_scc1 qkv_pp
  v_mov_b32 v106, v4
  s_bfm_b64 exec, 1, 0
  v_lshlrev_b32 v106, 7, v106
  s_mov_b32 s3, 65536
poll9:
  buffer_load_dwordx2 v[104:105], v106, s[68:71], s65 offen sc1
  s_waitcnt vmcnt(0)
  v_cmp_ne_u64 vcc, s[100:101], v[104:105]
  s_sub_u32 s3, s3, 1
  s_cbranch_scc1 poll9_x
  s_mov_b64 exec, vcc
  s_cbranch_vccnz poll9
poll9_x:
  s_mov_b64 exec, -1
qkv_pp:
  s_bfm_b64 exec, 18, 0
  v_lshlrev_b32 v4, 7, v4
  s_mov_b32 s3, 65536
poll10:
  buffer_load_dwordx2 v[104:105], v4, s[68:71], s65 offen sc1
  s_waitcnt vmcnt(0)
  v_cmp_ne_u64 vcc, s[100:101], v[104:105]
  s_sub_u32 s3, s3, 1
  s_cbranch_scc1 poll10_x
  s_mov_b64 exec, vcc
  s_cbranch_vccnz poll10
poll10_x:
  s_mov_b64 exec, -1
  buffer_load_dwordx4 v5, s[24:27], s48 offen sc1 lds
  s_add_u32 m0, m0, 8192
  s_add_u32 s48, s48, 262144
  buffer_load_dwordx4 v5, s[24:27], s48 offen sc1 lds
  s_add_u32 m0, m0, 8192
  s_add_u32 s48, s48, 262144
  buffer_load_dwordx4 v5, s[24:27], s48 offen sc1 lds
  s_add_u32 m0, m0, 8192
  s_add_u32 s48, s48, 262144
  buffer_load_dwordx4 v5, s[24:27], s48 offen sc1 lds
  s_add_u32 m0, m0, 8192
  s_add_u32 s48, s48, 262144
  buffer_load_dwordx4 v5, s[24:27], s48 offen sc1 lds
  s_add_u32 m0, m0, 8192
  s_add_u32 s48, s48, 262144
  buffer_load_dwordx4 v5, s[24:27], s48 offen sc1 lds
  s_add_u32 m0, m0, 8192
  s_add_u32 s48, s48, 262144
  buffer_load_dwordx4 v5, s[24:27], s48 offen sc1 lds
  s_add_u32 m0, m0, 8192
  s_add_u32 s48, s48, 262144
  buffer_load_dwordx4 v5, s[24:27], s48 offen sc1 lds
  s_add_u32 m0, m0, 8192
  s_add_u32 s48, s48, 262144
  s_cmp_ge_u32 s45, 2
  s_cbranch_scc1 qkv_v
  s_waitcnt vmcnt(7)
  s_barrier
  ds_read_b64 v[48:49], v6 offset:0
  ds_read_b64 v[50:51], v6 offset:512
  ds_read_b64 v[52:53], v6 offset:2048
  ds_read_b64 v[54:55], v6 offset:2560
  ds_read_b64 v[56:57], v6 offset:4096
  ds_read_b64 v[58:59], v6 offset:4608
  ds_read_b64 v[60:61], v6 offset:6144
  ds_read_b64 v[62:63], v6 offset:6656
  s_waitcnt vmcnt(6)
  s_barrier
  ds_read_b64 v[64:65], v6 offset:8192
  ds_read_b64 v[66:67], v6 offset:8704
  s_waitcnt lgkmcnt(8)
  buffer_load_dwordx4 v5, s[24:27], s48 offen sc1 lds
  s_add_u32 m0, m0, 8192
  s_sub_u32 s48, s48, 2096640
  v_mfma_f32_32x32x16_bf16 v[16:31], v[112:115], v[48:51], 0
  ds_read_b64 v[68:69], v6 offset:10240
  ds_read_b64 v[70:71], v6 offset:10752
  s_waitcnt lgkmcnt(8)
  buffer_load_dwordx4 v5, s[24:27], s48 offen sc1 lds
  s_add_u32 m0, m0, 8192
  s_add_u32 s48, s48, 262144
  v_mfma_f32_32x32x16_bf16 v[16:31], v[116:119], v[52:55], v[16:31]
  ds_read_b64 v[72:73], v6 offset:12288
  ds_read_b64 v[74:75], v6 offset:12800
  s_waitcnt lgkmcnt(8)
  buffer_load_dwordx4 v5, s[24:27], s48 offen sc1 lds
  s_add_u32 m0, m0, 8192
  s_add_u32 s48, s48, 262144
  v_mfma_f32_32x32x16_bf16 v[16:31], v[120:123], v[56:59], v[16:31]
  ds_read_b64 v[76:77], v6 offset:14336
  ds_read_b64 v[78:79], v6 offset:14848
  s_waitcnt lgkmcnt(8)
  buffer_load_dwordx4 v5, s[24:27], s48 offen sc1 lds
  s_add_u32 m0, m0, 8192
  s_add_u32 s48, s48, 262144
  v_mfma_f32_32x32x16_bf16 v[16:31], v[124:127], v[60:63], v[16:31]
  s_waitcnt vmcnt(9)
  s_barrier
  ds_read_b64 v[48:49], v6 offset:16384
  ds_read_b64 v[50:51], v6 offset:16896
  s_waitcnt lgkmcnt(8)
  buffer_load_dwordx4 v5, s[24:27], s48 offen sc1 lds
  s_add_u32 m0, m0, 8192
  s_add_u32 s48, s48, 262144
  v_mfma_f32_32x32x16_bf16 v[16:31], v[128:131], v[64:67], v[16:31]
  ds_read_b64 v[52:53], v6 offset:18432
  ds_read_b64 v[54:55], v6 offset:18944
  s_waitcnt lgkmcnt(8)
  buffer_load_dwordx4 v5, s[24:27], s48 offen sc1 lds
  s_add_u32 m0, m0, 8192
  s_add_u32 s48, s48, 262144
  v_mfma_f32_32x32x16_bf16 v[16:31], v[132:135], v[68:71], v[16:31]
  ds_read_b64 v[56:57], v6 offset:20480
  ds_read_b64 v[58:59], v6 offset:20992
  s_waitcnt lgkmcnt(8)
  buffer_load_dwordx4 v5, s[24:27], s48 offen sc1 lds
  s_add_u32 m0, m0, 8192
  s_add_u32 s48, s48, 262144
  v_mfma_f32_32x32x16_bf16 v[16:31], v[136:139], v[72:75], v[16:31]
  ds_read_b64 v[60:61], v6 offset:22528
  ds_read_b64 v[62:63], v6 offset:23040
  s_waitcnt lgkmcnt(8)
  buffer_load_dwordx4 v5, s[24:27], s48 offen sc1 lds
  s_add_u32 m0, m0, 8192
  s_add_u32 s48, s48, 262144
  v_mfma_f32_32x32x16_bf16 v[16:31], v[140:143], v[76:79], v[16:31]
  s_waitcnt vmcnt(11)
  s_barrier
  ds_read_b64 v[64:65], v6 offset:24576
  ds_read_b64 v[66:67], v6 offset:25088
  s_waitcnt lgkmcnt(8)
  buffer_load_dwordx4 v5, s[24:27], s48 offen sc1 lds
  s_add_u32 m0, m0, 8192
  s_add_u32 s48, s48, 262144
  v_mfma_f32_32x32x16_bf16 v[16:31], v[144:147], v[48:51], v[16:31]
  ds_read_b64 v[68:69], v6 offset:26624
  ds_read_b64 v[70:71], v6 offset:27136
  s_waitcnt lgkmcnt(8)
  buffer_load_dwordx4 v5, s[24:27], s48 offen sc1 lds
  v_mfma_f32_32x32x16_bf16 v[16:31], v[148:151], v[52:55], v[16:31]
  ds_read_b64 v[72:73], v6 offset:28672
  ds_read_b64 v[74:75], v6 offset:29184
  s_waitcnt lgkmcnt(8)
  v_mfma_f32_32x32x16_bf16 v[16:31], v[152:155], v[56:59], v[16:31]
  ds_read_b64 v[76:77], v6 offset:30720
  ds_read_b64 v[78:79], v6 offset:31232
  s_waitcnt lgkmcnt(8)
  v_mfma_f32_32x32x16_bf16 v[16:31], v[156:159], v[60:63], v[16:31]
  ds_read_b64 v[48:49], v6 offset:32768
  ds_read_b64 v[50:51], v6 offset:33280
  s_waitcnt lgkmcnt(8)
  v_mfma_f32_32x32x16_bf16 v[16:31], v[160:163], v[64:67], v[16:31]
  ds_read_b64 v[52:53], v6 offset:34816
  ds_read_b64 v[54:55], v6 offset:35328
  s_waitcnt lgkmcnt(8)
  v_mfma_f32_32x32x16_bf16 v[16:31], v[164:167], v[68:71], v[16:31]
  ds_read_b64 v[56:57], v6 offset:36864
  ds_read_b64 v[58:59], v6 offset:37376
  s_waitcnt lgkmcnt(8)
  v_mfma_f32_32x32x16_bf16 v[16:31], v[168:171], v[72:75], v[16:31]
  ds_read_b64 v[60:61], v6 offset:38912
  ds_read_b64 v[62:63], v6 offset:39424
  s_waitcnt lgkmcnt(8)
  v_mfma_f32_32x32x16_bf16 v[16:31], v[172:175], v[76:79], v[16:31]
  s_waitcnt vmcnt(11)
  s_barrier
  ds_read_b64 v[64:65], v6 offset:40960
  ds_read_b64 v[66:67], v6 offset:41472
  s_waitcnt lgkmcnt(8)
  v_mfma_f32_32x32x16_bf16 v[16:31], v[176:179], v[48:51], v[16:31]
  ds_read_b64 v[68:69], v6 offset:43008
  ds_read_b64 v[70:71], v6 offset:43520
  s_waitcnt lgkmcnt(8)
  v_mfma_f32_32x32x16_bf16 v[16:31], v[180:183], v[52:55], v[16:31]
  ds_read_b64 v[72:73], v6 offset:45056
  ds_read_b64 v[74:75], v6 offset:45568
  s_waitcnt lgkmcnt(8)
  v_mfma_f32_32x32x16_bf16 v[16:31], v[184:187], v[56:59], v[16:31]
  ds_read_b64 v[76:77], v6 offset:47104
  ds_read_b64 v[78:79], v6 offset:47616
  s_waitcnt lgkmcnt(8)
  v_mfma_f32_32x32x16_bf16 v[16:31], v[188:191], v[60:63], v[16:31]
  ds_read_b64 v[48:49], v6 offset:49152
  ds_read_b64 v[50:51], v6 offset:49664
  s_waitcnt lgkmcnt(8)
  v_mfma_f32_32x32x16_bf16 v[16:31], v[192:195], v[64:67], v[16:31]
  ds_read_b64 v[52:53], v6 offset:51200
  ds_read_b64 v[54:55], v6 offset:51712
  s_waitcnt lgkmcnt(8)
  v_mfma_f32_32x32x16_bf16 v[16:31], v[196:199], v[68:71], v[16:31]
  ds_read_b64 v[56:57], v6 offset:53248
  ds_read_b64 v[58:59], v6 offset:53760
  s_waitcnt lgkmcnt(8)
  v_mfma_f32_32x32x16_bf16 v[16:31], v[200:203], v[72:75], v[16:31]
  ds_read_b64 v[60:61], v6 offset:55296
  ds_read_b64 v[62:63], v6 offset:55808
  s_waitcnt lgkmcnt(8)
  v_mfma_f32_32x32x16_bf16 v[16:31], v[204:207], v[76:79], v[16:31]
  s_waitcnt vmcnt(9)
  s_barrier
  ds_read_b64 v[64:65], v6 offset:57344
  ds_read_b64 v[66:67], v6 offset:57856
  s_waitcnt lgkmcnt(8)
  v_mfma_f32_32x32x16_bf16 v[16:31], v[208:211], v[48:51], v[16:31]
  ds_read_b64 v[68:69], v6 offset:59392
  ds_read_b64 v[70:71], v6 offset:59904
  s_waitcnt lgkmcnt(8)
  v_mfma_f32_32x32x16_bf16 v[16:31], v[212:215], v[52:55], v[16:31]
  ds_read_b64 v[72:73], v6 offset:61440
  ds_read_b64 v[74:75], v6 offset:61952
  s_waitcnt lgkmcnt(8)
  v_mfma_f32_32x32x16_bf16 v[16:31], v[216:219], v[56:59], v[16:31]
  ds_read_b64 v[76:77], v6 offset:63488
  ds_read_b64 v[78:79], v6 offset:64000
  s_waitcnt lgkmcnt(8)
  v_mfma_f32_32x32x16_bf16 v[16:31], v[220:223], v[60:63], v[16:31]
  ds_read_b64 v[48:49], v7 offset:0
  ds_read_b64 v[50:51], v7 offset:512
  s_waitcnt lgkmcnt(8)
  v_mfma_f32_32x32x16_bf16 v[16:31], v[224:227], v[64:67], v[16:31]
  ds_read_b64 v[52:53], v7 offset:2048
  ds_read_b64 v[54:55], v7 offset:2560
  s_waitcnt lgkmcnt(8)
  v_mfma_f32_32x32x16_bf16 v[16:31], v[228:231], v[68:71], v[16:31]
  ds_read_b64 v[56:57], v7 offset:4096
  ds_read_b64 v[58:59], v7 offset:4608
  s_waitcnt lgkmcnt(8)
  v_mfma_f32_32x32x16_bf16 v[16:31], v[232:235], v[72:75], v[16:31]
  ds_read_b64 v[60:61], v7 offset:6144
  ds_read_b64 v[62:63], v7 offset:6656
  s_waitcnt lgkmcnt(8)
  v_mfma_f32_32x32x16_bf16 v[16:31], v[236:239], v[76:79], v[16:31]
  s_waitcnt vmcnt(7)
  s_barrier
  ds_read_b64 v[64:65], v7 offset:8192
  ds_read_b64 v[66:67], v7 offset:8704
  s_waitcnt lgkmcnt(8)
  v_mfma_f32_32x32x16_bf16 v[16:31], v[240:243], v[48:51], v[16:31]
  ds_read_b64 v[68:69], v7 offset:10240
  ds_read_b64 v[70:71], v7 offset:10752
  s_waitcnt lgkmcnt(8)
  v_mfma_f32_32x32x16_bf16 v[16:31], v[244:247], v[52:55], v[16:31]
  ds_read_b64 v[72:73], v7 offset:12288
  ds_read_b64 v[74:75], v7 offset:12800
  s_waitcnt lgkmcnt(8)
  v_mfma_f32_32x32x16_bf16 v[16:31], v[248:251], v[56:59], v[16:31]
  ds_read_b64 v[76:77], v7 offset:14336
  ds_read_b64 v[78:79], v7 offset:14848
  s_waitcnt lgkmcnt(8)
  v_mfma_f32_32x32x16_bf16 v[16:31], v[252:255], v[60:63], v[16:31]
  ds_read_b64 v[48:49], v7 offset:16384
  ds_read_b64 v[50:51], v7 offset:16896
  s_waitcnt lgkmcnt(8)
  v_mfma_f32_32x32x16_bf16 v[32:47], v[112:115], v[64:67], 0
  ds_read_b64 v[52:53], v7 offset:18432
  ds_read_b64 v[54:55], v7 offset:18944
  s_waitcnt lgkmcnt(8)
  v_mfma_f32_32x32x16_bf16 v[32:47], v[116:119], v[68:71], v[32:47]
  ds_read_b64 v[56:57], v7 offset:20480
  ds_read_b64 v[58:59], v7 offset:20992
  s_waitcnt lgkmcnt(8)
  v_mfma_f32_32x32x16_bf16 v[32:47], v[120:123], v[72:75], v[32:47]
  ds_read_b64 v[60:61], v7 offset:22528
  ds_read_b64 v[62:63], v7 offset:23040
  s_waitcnt lgkmcnt(8)
  v_mfma_f32_32x32x16_bf16 v[32:47], v[124:127], v[76:79], v[32:47]
  s_waitcnt vmcnt(5)
  s_barrier
  ds_read_b32 v88, v9 offset:0
  ds_read_b64 v[64:65], v7 offset:24576
  ds_read_b64 v[66:67], v7 offset:25088
  s_waitcnt lgkmcnt(9)
  v_mfma_f32_32x32x16_bf16 v[32:47], v[128:131], v[48:51], v[32:47]
  ds_read_b64 v[68:69], v7 offset:26624
  ds_read_b64 v[70:71], v7 offset:27136
  s_waitcnt lgkmcnt(9)
  v_mfma_f32_32x32x16_bf16 v[32:47], v[132:135], v[52:55], v[32:47]
  ds_read_b64 v[72:73], v7 offset:28672
  ds_read_b64 v[74:75], v7 offset:29184
  s_waitcnt lgkmcnt(9)
  v_mfma_f32_32x32x16_bf16 v[32:47], v[136:139], v[56:59], v[32:47]
  s_waitcnt lgkmcnt(6)
  v_mul_f32 v24, v24, v88
  v_mul_f32 v25, v25, v88
  v_cvt_pk_bf16_f32 v84, v24, v25
  ds_read_b64 v[76:77], v7 offset:30720
  ds_read_b64 v[78:79], v7 offset:31232
  v_mfma_f32_32x32x16_bf16 v[32:47], v[140:143], v[60:63], v[32:47]
  v_mul_f32 v26, v26, v88
  v_mul_f32 v27, v27, v88
  v_cvt_pk_bf16_f32 v85, v26, v27
  ds_read_b64 v[48:49], v7 offset:32768
  ds_read_b64 v[50:51], v7 offset:33280
  s_waitcnt lgkmcnt(8)
  v_mfma_f32_32x32x16_bf16 v[32:47], v[144:147], v[64:67], v[32:47]
  v_mul_f32 v28, v28, v88
  v_mul_f32 v29, v29, v88
  v_cvt_pk_bf16_f32 v86, v28, v29
  ds_read_b64 v[52:53], v7 offset:34816
  ds_read_b64 v[54:55], v7 offset:35328
  s_waitcnt lgkmcnt(8)
  v_mfma_f32_32x32x16_bf16 v[32:47], v[148:151], v[68:71], v[32:47]
  v_mul_f32 v30, v30, v88
  v_mul_f32 v31, v31, v88
  v_cvt_pk_bf16_f32 v87, v30, v31
  ds_read_b64 v[56:57], v7 offset:36864
  ds_read_b64 v[58:59], v7 offset:37376
  s_waitcnt lgkmcnt(8)
  v_mfma_f32_32x32x16_bf16 v[32:47], v[152:155], v[72:75], v[32:47]
  buffer_store_dwordx4 v[84:87], v13, s[32:35], s64 offen offset:0 sc1
  v_mul_f32 v16, v16, v88
  v_mul_f32 v17, v17, v88
  ds_read_b64 v[60:61], v7 offset:38912
  ds_read_b64 v[62:63], v7 offset:39424
  s_waitcnt lgkmcnt(8)
  v_mfma_f32_32x32x16_bf16 v[32:47], v[156:159], v[76:79], v[32:47]
  v_cvt_pk_bf16_f32 v80, v16, v17
  v_mul_f32 v18, v18, v88
  v_mul_f32 v19, v19, v88
  s_waitcnt vmcnt(4)
  s_barrier
  ds_read_b64 v[64:65], v7 offset:40960
  ds_read_b64 v[66:67], v7 offset:41472
  s_waitcnt lgkmcnt(8)
  v_mfma_f32_32x32x16_bf16 v[32:47], v[160:163], v[48:51], v[32:47]
  v_cvt_pk_bf16_f32 v81, v18, v19
  v_mul_f32 v20, v20, v88
  v_mul_f32 v21, v21, v88
  ds_read_b64 v[68:69], v7 offset:43008
  ds_read_b64 v[70:71], v7 offset:43520
  s_waitcnt lgkmcnt(8)
  v_mfma_f32_32x32x16_bf16 v[32:47], v[164:167], v[52:55], v[32:47]
  v_cvt_pk_bf16_f32 v82, v20, v21
  v_mul_f32 v22, v22, v88
  v_mul_f32 v23, v23, v88
  ds_read_b64 v[72:73], v7 offset:45056
  ds_read_b64 v[74:75], v7 offset:45568
  s_waitcnt lgkmcnt(8)
  v_mfma_f32_32x32x16_bf16 v[32:47], v[168:171], v[56:59], v[32:47]
  v_cvt_pk_bf16_f32 v83, v22, v23
  buffer_store_dwordx4 v[80:83], v12, s[32:35], s62 offen offset:0 sc1
  v_mul_f32 v104, v24, v24
  ds_read_b64 v[76:77], v7 offset:47104
  ds_read_b64 v[78:79], v7 offset:47616
  s_waitcnt lgkmcnt(8)
  v_mfma_f32_32x32x16_bf16 v[32:47], v[172:175], v[60:63], v[32:47]
  v_fmac_f32 v104, v25, v25
  v_fmac_f32 v104, v26, v26
  v_fmac_f32 v104, v27, v27
  ds_read_b64 v[48:49], v7 offset:49152
  ds_read_b64 v[50:51], v7 offset:49664
  s_waitcnt lgkmcnt(8)
  v_mfma_f32_32x32x16_bf16 v[32:47], v[176:179], v[64:67], v[32:47]
  v_fmac_f32 v104, v28, v28
  v_fmac_f32 v104, v29, v29
  v_fmac_f32 v104, v30, v30
  ds_read_b64 v[52:53], v7 offset:51200
  ds_read_b64 v[54:55], v7 offset:51712
  s_waitcnt lgkmcnt(8)
  v_mfma_f32_32x32x16_bf16 v[32:47], v[180:183], v[68:71], v[32:47]
  v_fmac_f32 v104, v31, v31
  ds_read_b64 v[56:57], v7 offset:53248
  ds_read_b64 v[58:59], v7 offset:53760
  s_waitcnt lgkmcnt(8)
  v_mfma_f32_32x32x16_bf16 v[32:47], v[184:187], v[72:75], v[32:47]
  ds_read_b64 v[60:61], v7 offset:55296
  ds_read_b64 v[62:63], v7 offset:55808
  s_waitcnt lgkmcnt(8)
  v_mfma_f32_32x32x16_bf16 v[32:47], v[188:191], v[76:79], v[32:47]
  s_waitcnt vmcnt(4)
  s_barrier
  ds_read_b64 v[64:65], v7 offset:57344
  ds_read_b64 v[66:67], v7 offset:57856
  s_waitcnt lgkmcnt(8)
  v_mfma_f32_32x32x16_bf16 v[32:47], v[192:195], v[48:51], v[32:47]
  ds_read_b64 v[68:69], v7 offset:59392
  ds_read_b64 v[70:71], v7 offset:59904
  s_waitcnt lgkmcnt(8)
  v_mfma_f32_32x32x16_bf16 v[32:47], v[196:199], v[52:55], v[32:47]
  ds_read_b64 v[72:73], v7 offset:61440
  ds_read_b64 v[74:75], v7 offset:61952
  s_waitcnt lgkmcnt(8)
  v_mfma_f32_32x32x16_bf16 v[32:47], v[200:203], v[56:59], v[32:47]
  ds_read_b64 v[76:77], v7 offset:63488
  ds_read_b64 v[78:79], v7 offset:64000
  s_waitcnt lgkmcnt(8)
  v_mfma_f32_32x32x16_bf16 v[32:47], v[204:207], v[60:63], v[32:47]
  s_waitcnt vmcnt(3)
  s_barrier
  ds_read_b64 v[48:49], v8 offset:0
  ds_read_b64 v[50:51], v8 offset:512
  s_waitcnt lgkmcnt(8)
  v_mfma_f32_32x32x16_bf16 v[32:47], v[208:211], v[64:67], v[32:47]
  ds_read_b64 v[52:53], v8 offset:2048
  ds_read_b64 v[54:55], v8 offset:2560
  s_waitcnt lgkmcnt(8)
  v_mfma_f32_32x32x16_bf16 v[32:47], v[212:215], v[68:71], v[32:47]
  ds_read_b64 v[56:57], v8 offset:4096
  ds_read_b64 v[58:59], v8 offset:4608
  s_waitcnt lgkmcnt(8)
  v_mfma_f32_32x32x16_bf16 v[32:47], v[216:219], v[72:75], v[32:47]
  ds_read_b64 v[60:61], v8 offset:6144
  ds_read_b64 v[62:63], v8 offset:6656
  s_waitcnt lgkmcnt(8)
  v_mfma_f32_32x32x16_bf16 v[32:47], v[220:223], v[76:79], v[32:47]
  s_waitcnt vmcnt(2)
  s_barrier
  ds_read_b64 v[64:65], v8 offset:8192
  ds_read_b64 v[66:67], v8 offset:8704
  s_waitcnt lgkmcnt(8)
  v_mfma_f32_32x32x16_bf16 v[32:47], v[224:227], v[48:51], v[32:47]
  ds_read_b64 v[68:69], v8 offset:10240
  ds_read_b64 v[70:71], v8 offset:10752
  s_waitcnt lgkmcnt(8)
  v_mfma_f32_32x32x16_bf16 v[32:47], v[228:231], v[52:55], v[32:47]
  ds_read_b64 v[72:73], v8 offset:12288
  ds_read_b64 v[74:75], v8 offset:12800
  s_waitcnt lgkmcnt(8)
  v_mfma_f32_32x32x16_bf16 v[32:47], v[232:235], v[56:59], v[32:47]
  ds_read_b64 v[76:77], v8 offset:14336
  ds_read_b64 v[78:79], v8 offset:14848
  s_waitcnt lgkmcnt(8)
  v_mfma_f32_32x32x16_bf16 v[32:47], v[236:239], v[60:63], v[32:47]
  s_waitcnt lgkmcnt(6)
  v_mfma_f32_32x32x16_bf16 v[32:47], v[240:243], v[64:67], v[32:47]
  s_waitcnt lgkmcnt(4)
  v_mfma_f32_32x32x16_bf16 v[32:47], v[244:247], v[68:71], v[32:47]
  s_waitcnt lgkmcnt(2)
  v_mfma_f32_32x32x16_bf16 v[32:47], v[248:251], v[72:75], v[32:47]
  s_barrier
  ds_read_b32 v89, v9 offset:256
  s_waitcnt lgkmcnt(1)
  v_mfma_f32_32x32x16_bf16 v[32:47], v[252:255], v[76:79], v[32:47]
  s_waitcnt lgkmcnt(0)
  s_nop 10
  v_mul_f32 v40, v40, v89
  v_mul_f32 v41, v41, v89
  v_cvt_pk_bf16_f32 v84, v40, v41
  v_mul_f32 v42, v42, v89
  v_mul_f32 v43, v43, v89
  v_cvt_pk_bf16_f32 v85, v42, v43
  v_mul_f32 v44, v44, v89
  v_mul_f32 v45, v45, v89
  v_cvt_pk_bf16_f32 v86, v44, v45
  v_mul_f32 v46, v46, v89
  v_mul_f32 v47, v47, v89
  v_cvt_pk_bf16_f32 v87, v46, v47
  buffer_store_dwordx4 v[84:87], v13, s[32:35], s64 offen offset:512 sc1
  v_mul_f32 v32, v32, v89
  v_mul_f32 v33, v33, v89
  v_cvt_pk_bf16_f32 v80, v32, v33
  v_mul_f32 v34, v34, v89
  v_mul_f32 v35, v35, v89
  v_cvt_pk_bf16_f32 v81, v34, v35
  v_mul_f32 v36, v36, v89
  v_mul_f32 v37, v37, v89
  v_cvt_pk_bf16_f32 v82, v36, v37
  v_mul_f32 v38, v38, v89
  v_mul_f32 v39, v39, v89
  v_cvt_pk_bf16_f32 v83, v38, v39
  buffer_store_dwordx4 v[80:83], v12, s[32:35], s62 offen offset:1024 sc1
  v_mul_f32 v105, v40, v40
  v_fmac_f32 v105, v41, v41
  v_fmac_f32 v105, v42, v42
  v_fmac_f32 v105, v43, v43
  v_fmac_f32 v105, v44, v44
  v_fmac_f32 v105, v45, v45
  v_fmac_f32 v105, v46, v46
  v_fmac_f32 v105, v47, v47
  s_nop 1
  v_permlane32_swap_b32 v104, v105
  v_add_f32 v104, v104, v105
qkv_kmx:
  s_nop 1
  v_max_f32_dpp v104, v104, v104 quad_perm:[1,0,3,2] row_mask:0xf bank_mask:0xf
  s_nop 1
  v_max_f32_dpp v104, v104, v104 quad_perm:[2,3,0,1] row_mask:0xf bank_mask:0xf
  s_nop 1
  v_max_f32_dpp v104, v104, v104 row_half_mirror row_mask:0xf bank_mask:0xf
  s_nop 1
  v_max_f32_dpp v104, v104, v104 row_mirror row_mask:0xf bank_mask:0xf
  v_mov_b32 v105, v104
  s_nop 1
  v_permlane16_swap_b32 v104, v105
  v_max_f32 v104, v104, v105
  s_nop 0
  v_readlane_b32 s41, v104, 0
  v_readlane_b32 s42, v104, 32
  s_nop 0
  s_max_u32 s41, s41, s42
  s_add_u32 s41, s41, 0x3ffff
  s_lshr_b32 s41, s41, 16
  s_or_b32 s41, s41, s100
  v_mov_b32 v4, s41
  s_branch qkv_pub
qkv_v:
  s_cmp_eq_u32 s45, 2
  s_cbranch_scc1 qkv_v2
  s_waitcnt vmcnt(7)
  s_barrier
  ds_read_b64 v[48:49], v6 offset:0
  ds_read_b64 v[50:51], v6 offset:512
  ds_read_b64 v[52:53], v9 offset:0
  ds_read_b64 v[54:55], v9 offset:512
  ds_read_b64 v[56:57], v6 offset:4096
  ds_read_b64 v[58:59], v6 offset:4608
  ds_read_b64 v[60:61], v9 offset:4096
  ds_read_b64 v[62:63], v9 offset:4608
  s_waitcnt vmcnt(6)
  s_barrier
  s_waitcnt lgkmcnt(6)
  v_and_b32 v48, v111, v48
  s_nop 1
  v_mfma_f32_16x16x32_bf16 v[32:35], v[48:51], v[48:51], 0
  ds_read_b64 v[64:65], v6 offset:8192
  s_waitcnt lgkmcnt(5)
  v_and_b32 v52, v111, v52
  s_nop 1
  v_mfma_f32_16x16x32_bf16 v[36:39], v[52:55], v[52:55], 0
  ds_read_b64 v[66:67], v6 offset:8704
  v_mfma_f32_16x16x32_bf16 v[16:19], v[112:115], v[48:51], 0
  ds_read_b64 v[68:69], v9 offset:8192
  buffer_load_dwordx4 v5, s[24:27], s48 offen sc1 lds
  s_add_u32 m0, m0, 8192
  s_sub_u32 s48, s48, 2096640
  v_mfma_f32_16x16x32_bf16 v[20:23], v[112:115], v[52:55], 0
  ds_read_b64 v[70:71], v9 offset:8704
  buffer_load_dwordx4 v5, s[24:27], s48 offen sc1 lds
  s_add_u32 m0, m0, 8192
  s_add_u32 s48, s48, 262144
  s_waitcnt lgkmcnt(6)
  v_mfma_f32_16x16x32_bf16 v[32:35], v[56:59], v[56:59], v[32:35]
  ds_read_b64 v[72:73], v6 offset:12288
  s_waitcnt lgkmcnt(5)
  v_mfma_f32_16x16x32_bf16 v[36:39], v[60:63], v[60:63], v[36:39]
  ds_read_b64 v[74:75], v6 offset:12800
  v_mfma_f32_16x16x32_bf16 v[16:19], v[120:123], v[56:59], v[16:19]
  ds_read_b64 v[76:77], v9 offset:12288
  buffer_load_dwordx4 v5, s[24:27], s48 offen sc1 lds
  s_add_u32 m0, m0, 8192
  s_add_u32 s48, s48, 262144
  v_mfma_f32_16x16x32_bf16 v[20:23], v[120:123], v[60:63], v[20:23]
  ds_read_b64 v[78:79], v9 offset:12800
  buffer_load_dwordx4 v5, s[24:27], s48 offen sc1 lds
  s_add_u32 m0, m0, 8192
  s_add_u32 s48, s48, 262144
  s_waitcnt vmcnt(9)
  s_barrier
  s_waitcnt lgkmcnt(6)
  v_mfma_f32_16x16x32_bf16 v[32:35], v[64:67], v[64:67], v[32:35]
  ds_read_b64 v[48:49], v6 offset:16384
  s_waitcnt lgkmcnt(5)
  v_mfma_f32_16x16x32_bf16 v[36:39], v[68:71], v[68:71], v[36:39]
  ds_read_b64 v[50:51], v6 offset:16896
  v_mfma_f32_16x16x32_bf16 v[16:19], v[128:131], v[64:67], v[16:19]
  ds_read_b64 v[52:53], v9 offset:16384
  buffer_load_dwordx4 v5, s[24:27], s48 offen sc1 lds
  s_add_u32 m0, m0, 8192
  s_add_u32 s48, s48, 262144
  v_mfma_f32_16x16x32_bf16 v[20:23], v[128:131], v[68:71], v[20:23]
  ds_read_b64 v[54:55], v9 offset:16896
  buffer_load_dwordx4 v5, s[24:27], s48 offen sc1 lds
  s_add_u32 m0, m0, 8192
  s_add_u32 s48, s48, 262144
  s_waitcnt lgkmcnt(6)
  v_mfma_f32_16x16x32_bf16 v[32:35], v[72:75], v[72:75], v[32:35]
  ds_read_b64 v[56:57], v6 offset:20480
  s_waitcnt lgkmcnt(5)
  v_mfma_f32_16x16x32_bf16 v[36:39], v[76:79], v[76:79], v[36:39]
  ds_read_b64 v[58:59], v6 offset:20992
  v_mfma_f32_16x16x32_bf16 v[16:19], v[136:139], v[72:75], v[16:19]
  ds_read_b64 v[60:61], v9 offset:20480
  buffer_load_dwordx4 v5, s[24:27], s48 offen sc1 lds
  s_add_u32 m0, m0, 8192
  s_add_u32 s48, s48, 262144
  v_mfma_f32_16x16x32_bf16 v[20:23], v[136:139], v[76:79], v[20:23]
  ds_read_b64 v[62:63], v9 offset:20992
  buffer_load_dwordx4 v5, s[24:27], s48 offen sc1 lds
  s_add_u32 m0, m0, 8192
  s_add_u32 s48, s48, 262144
  s_waitcnt vmcnt(11)
  s_barrier
  s_waitcnt lgkmcnt(6)
  v_mfma_f32_16x16x32_bf16 v[32:35], v[48:51], v[48:51], v[32:35]
  ds_read_b64 v[64:65], v6 offset:24576
  s_waitcnt lgkmcnt(5)
  v_mfma_f32_16x16x32_bf16 v[36:39], v[52:55], v[52:55], v[36:39]
  ds_read_b64 v[66:67], v6 offset:25088
  v_mfma_f32_16x16x32_bf16 v[16:19], v[144:147], v[48:51], v[16:19]
  ds_read_b64 v[68:69], v9 offset:24576
  buffer_load_dwordx4 v5, s[24:27], s48 offen sc1 lds
  s_add_u32 m0, m0, 8192
  s_add_u32 s48, s48, 262144
  v_mfma_f32_16x16x32_bf16 v[20:23], v[144:147], v[52:55], v[20:23]
  ds_read_b64 v[70:71], v9 offset:25088
  buffer_load_dwordx4 v5, s[24:27], s48 offen sc1 lds
  s_waitcnt lgkmcnt(6)
  v_mfma_f32_16x16x32_bf16 v[32:35], v[56:59], v[56:59], v[32:35]
  ds_read_b64 v[72:73], v6 offset:28672
  s_waitcnt lgkmcnt(5)
  v_mfma_f32_16x16x32_bf16 v[36:39], v[60:63], v[60:63], v[36:39]
  ds_read_b64 v[74:75], v6 offset:29184
  v_mfma_f32_16x16x32_bf16 v[16:19], v[152:155], v[56:59], v[16:19]
  ds_read_b64 v[76:77], v9 offset:28672
  v_mfma_f32_16x16x32_bf16 v[20:23], v[152:155], v[60:63], v[20:23]
  ds_read_b64 v[78:79], v9 offset:29184
  s_waitcnt lgkmcnt(6)
  v_mfma_f32_16x16x32_bf16 v[32:35], v[64:67], v[64:67], v[32:35]
  ds_read_b64 v[48:49], v6 offset:32768
  s_waitcnt lgkmcnt(5)
  v_mfma_f32_16x16x32_bf16 v[36:39], v[68:71], v[68:71], v[36:39]
  ds_read_b64 v[50:51], v6 offset:33280
  v_mfma_f32_16x16x32_bf16 v[16:19], v[160:163], v[64:67], v[16:19]
  ds_read_b64 v[52:53], v9 offset:32768
  v_mfma_f32_16x16x32_bf16 v[20:23], v[160:163], v[68:71], v[20:23]
  ds_read_b64 v[54:55], v9 offset:33280
  s_waitcnt lgkmcnt(6)
  v_mfma_f32_16x16x32_bf16 v[32:35], v[72:75], v[72:75], v[32:35]
  ds_read_b64 v[56:57], v6 offset:36864
  s_waitcnt lgkmcnt(5)
  v_mfma_f32_16x16x32_bf16 v[36:39], v[76:79], v[76:79], v[36:39]
  ds_read_b64 v[58:59], v6 offset:37376
  v_mfma_f32_16x16x32_bf16 v[16:19], v[168:171], v[72:75], v[16:19]
  ds_read_b64 v[60:61], v9 offset:36864
  v_mfma_f32_16x16x32_bf16 v[20:23], v[168:171], v[76:79], v[20:23]
  ds_read_b64 v[62:63], v9 offset:37376
  s_waitcnt vmcnt(11)
  s_barrier
  s_waitcnt lgkmcnt(6)
  v_mfma_f32_16x16x32_bf16 v[32:35], v[48:51], v[48:51], v[32:35]
  ds_read_b64 v[64:65], v6 offset:40960
  s_waitcnt lgkmcnt(5)
  v_mfma_f32_16x16x32_bf16 v[36:39], v[52:55], v[52:55], v[36:39]
  ds_read_b64 v[66:67], v6 offset:41472
  v_mfma_f32_16x16x32_bf16 v[16:19], v[176:179], v[48:51], v[16:19]
  ds_read_b64 v[68:69], v9 offset:40960
  v_mfma_f32_16x16x32_bf16 v[20:23], v[176:179], v[52:55], v[20:23]
  ds_read_b64 v[70:71], v9 offset:41472
  s_waitcnt lgkmcnt(6)
  v_mfma_f32_16x16x32_bf16 v[32:35], v[56:59], v[56:59], v[32:35]
  ds_read_b64 v[72:73], v6 offset:45056
  s_waitcnt lgkmcnt(5)
  v_mfma_f32_16x16x32_bf16 v[36:39], v[60:63], v[60:63], v[36:39]
  ds_read_b64 v[74:75], v6 offset:45568
  v_mfma_f32_16x16x32_bf16 v[16:19], v[184:187], v[56:59], v[16:19]
  ds_read_b64 v[76:77], v9 offset:45056
  v_mfma_f32_16x16x32_bf16 v[20:23], v[184:187], v[60:63], v[20:23]
  ds_read_b64 v[78:79], v9 offset:45568
  s_waitcnt lgkmcnt(6)
  v_mfma_f32_16x16x32_bf16 v[32:35], v[64:67], v[64:67], v[32:35]
  ds_read_b64 v[48:49], v6 offset:49152
  s_waitcnt lgkmcnt(5)
  v_mfma_f32_16x16x32_bf16 v[36:39], v[68:71], v[68:71], v[36:39]
  ds_read_b64 v[50:51], v6 offset:49664
  v_mfma_f32_16x16x32_bf16 v[16:19], v[192:195], v[64:67], v[16:19]
  ds_read_b64 v[52:53], v9 offset:49152
  v_mfma_f32_16x16x32_bf16 v[20:23], v[192:195], v[68:71], v[20:23]
  ds_read_b64 v[54:55], v9 offset:49664
  s_waitcnt lgkmcnt(6)
  v_mfma_f32_16x16x32_bf16 v[32:35], v[72:75], v[72:75], v[32:35]
  ds_read_b64 v[56:57], v6 offset:53248
  s_waitcnt lgkmcnt(5)
  v_mfma_f32_16x16x32_bf16 v[36:39], v[76:79], v[76:79], v[36:39]
  ds_read_b64 v[58:59], v6 offset:53760
  v_mfma_f32_16x16x32_bf16 v[16:19], v[200:203], v[72:75], v[16:19]
  ds_read_b64 v[60:61], v9 offset:53248
  v_mfma_f32_16x16x32_bf16 v[20:23], v[200:203], v[76:79], v[20:23]
  ds_read_b64 v[62:63], v9 offset:53760
  s_waitcnt vmcnt(9)
  s_barrier
  s_waitcnt lgkmcnt(6)
  v_mfma_f32_16x16x32_bf16 v[32:35], v[48:51], v[48:51], v[32:35]
  ds_read_b64 v[64:65], v6 offset:57344
  s_waitcnt lgkmcnt(5)
  v_mfma_f32_16x16x32_bf16 v[36:39], v[52:55], v[52:55], v[36:39]
  ds_read_b64 v[66:67], v6 offset:57856
  v_mfma_f32_16x16x32_bf16 v[16:19], v[208:211], v[48:51], v[16:19]
  ds_read_b64 v[68:69], v9 offset:57344
  v_mfma_f32_16x16x32_bf16 v[20:23], v[208:211], v[52:55], v[20:23]
  ds_read_b64 v[70:71], v9 offset:57856
  s_waitcnt lgkmcnt(6)
  v_mfma_f32_16x16x32_bf16 v[32:35], v[56:59], v[56:59], v[32:35]
  ds_read_b64 v[72:73], v6 offset:61440
  s_waitcnt lgkmcnt(5)
  v_mfma_f32_16x16x32_bf16 v[36:39], v[60:63], v[60:63], v[36:39]
  ds_read_b64 v[74:75], v6 offset:61952
  v_mfma_f32_16x16x32_bf16 v[16:19], v[216:219], v[56:59], v[16:19]
  ds_read_b64 v[76:77], v9 offset:61440
  v_mfma_f32_16x16x32_bf16 v[20:23], v[216:219], v[60:63], v[20:23]
  ds_read_b64 v[78:79], v9 offset:61952
  s_waitcnt lgkmcnt(6)
  v_mfma_f32_16x16x32_bf16 v[32:35], v[64:67], v[64:67], v[32:35]
  ds_read_b64 v[48:49], v7 offset:0
  s_waitcnt lgkmcnt(5)
  v_mfma_f32_16x16x32_bf16 v[36:39], v[68:71], v[68:71], v[36:39]
  ds_read_b64 v[50:51], v7 offset:512
  v_mfma_f32_16x16x32_bf16 v[16:19], v[224:227], v[64:67], v[16:19]
  ds_read_b64 v[52:53], v10 offset:0
  v_mfma_f32_16x16x32_bf16 v[20:23], v[224:227], v[68:71], v[20:23]
  ds_read_b64 v[54:55], v10 offset:512
  s_waitcnt lgkmcnt(6)
  v_mfma_f32_16x16x32_bf16 v[32:35], v[72:75], v[72:75], v[32:35]
  ds_read_b64 v[56:57], v7 offset:4096
  s_waitcnt lgkmcnt(5)
  v_mfma_f32_16x16x32_bf16 v[36:39], v[76:79], v[76:79], v[36:39]
  ds_read_b64 v[58:59], v7 offset:4608
  v_mfma_f32_16x16x32_bf16 v[16:19], v[232:235], v[72:75], v[16:19]
  ds_read_b64 v[60:61], v10 offset:4096
  v_mfma_f32_16x16x32_bf16 v[20:23], v[232:235], v[76:79], v[20:23]
  ds_read_b64 v[62:63], v10 offset:4608
  s_waitcnt vmcnt(7)
  s_barrier
  s_waitcnt lgkmcnt(6)
  v_mfma_f32_16x16x32_bf16 v[32:35], v[48:51], v[48:51], v[32:35]
  ds_read_b64 v[64:65], v7 offset:8192
  s_waitcnt lgkmcnt(5)
  v_mfma_f32_16x16x32_bf16 v[36:39], v[52:55], v[52:55], v[36:39]
  ds_read_b64 v[66:67], v7 offset:8704
  v_mfma_f32_16x16x32_bf16 v[16:19], v[240:243], v[48:51], v[16:19]
  ds_read_b64 v[68:69], v10 offset:8192
  v_mfma_f32_16x16x32_bf16 v[20:23], v[240:243], v[52:55], v[20:23]
  ds_read_b64 v[70:71], v10 offset:8704
  s_waitcnt lgkmcnt(6)
  v_mfma_f32_16x16x32_bf16 v[32:35], v[56:59], v[56:59], v[32:35]
  ds_read_b64 v[72:73], v7 offset:12288
  s_waitcnt lgkmcnt(5)
  v_mfma_f32_16x16x32_bf16 v[36:39], v[60:63], v[60:63], v[36:39]
  ds_read_b64 v[74:75], v7 offset:12800
  v_mfma_f32_16x16x32_bf16 v[16:19], v[248:251], v[56:59], v[16:19]
  ds_read_b64 v[76:77], v10 offset:12288
  v_mfma_f32_16x16x32_bf16 v[20:23], v[248:251], v[60:63], v[20:23]
  ds_read_b64 v[78:79], v10 offset:12800
  s_waitcnt lgkmcnt(6)
  v_and_b32 v64, v111, v64
  s_nop 1
  v_mfma_f32_16x16x32_bf16 v[40:43], v[64:67], v[64:67], 0
  ds_read_b64 v[48:49], v7 offset:16384
  v_cndmask_b32 v32, v32, v33, s[54:55]
  v_cndmask_b32 v34, v34, v35, s[54:55]
  s_waitcnt lgkmcnt(5)
  v_and_b32 v68, v111, v68
  s_nop 1
  v_mfma_f32_16x16x32_bf16 v[44:47], v[68:71], v[68:71], 0
  ds_read_b64 v[50:51], v7 offset:16896
  v_cndmask_b32 v32, v32, v34, s[56:57]
  v_fmamk_f32 v32, v32, 0x3ae38e39, v110
  v_mfma_f32_16x16x32_bf16 v[24:27], v[112:115], v[64:67], 0
  ds_read_b64 v[52:53], v10 offset:16384
  v_rsq_f32 v32, v32
  v_cndmask_b32 v36, v36, v37, s[54:55]
  v_mfma_f32_16x16x32_bf16 v[28:31], v[112:115], v[68:71], 0
  ds_read_b64 v[54:55], v10 offset:16896
  v_cndmask_b32 v38, v38, v39, s[54:55]
  v_cndmask_b32 v36, v36, v38, s[56:57]
  s_waitcnt lgkmcnt(6)
  v_mfma_f32_16x16x32_bf16 v[40:43], v[72:75], v[72:75], v[40:43]
  ds_read_b64 v[56:57], v7 offset:20480
  v_fmamk_f32 v36, v36, 0x3ae38e39, v110
  v_rsq_f32 v36, v36
  s_waitcnt lgkmcnt(5)
  v_mfma_f32_16x16x32_bf16 v[44:47], v[76:79], v[76:79], v[44:47]
  ds_read_b64 v[58:59], v7 offset:20992
  s_mov_b64 exec, s[58:59]
  ds_write_b32 v12, v32 offset:0
  ds_write_b32 v12, v36 offset:64
  s_mov_b64 exec, -1
  v_mfma_f32_16x16x32_bf16 v[24:27], v[120:123], v[72:75], v[24:27]
  ds_read_b64 v[60:61], v10 offset:20480
  v_mfma_f32_16x16x32_bf16 v[28:31], v[120:123], v[76:79], v[28:31]
  ds_read_b64 v[62:63], v10 offset:20992
  s_waitcnt lgkmcnt(2)
  s_waitcnt vmcnt(5)
  s_barrier
  ds_read_b32 v88, v12 offset:0
  ds_read_b32 v89, v12 offset:64
  v_mfma_f32_16x16x32_bf16 v[40:43], v[48:51], v[48:51], v[40:43]
  ds_read_b64 v[64:65], v7 offset:24576
  s_waitcnt lgkmcnt(2)
  v_mul_f32 v18, v18, v88
  v_mul_f32 v19, v19, v88
  v_mfma_f32_16x16x32_bf16 v[44:47], v[52:55], v[52:55], v[44:47]
  ds_read_b64 v[66:67], v7 offset:25088
  v_mul_f32 v16, v16, v88
  v_mul_f32 v17, v17, v88
  v_mfma_f32_16x16x32_bf16 v[24:27], v[128:131], v[48:51], v[24:27]
  ds_read_b64 v[68:69], v10 offset:24576
  v_cvt_pk_bf16_f32 v84, v18, v19
  v_cvt_pk_bf16_f32 v80, v16, v17
  v_mfma_f32_16x16x32_bf16 v[28:31], v[128:131], v[52:55], v[28:31]
  ds_read_b64 v[70:71], v10 offset:25088
  s_mov_b32 exec_hi, 0
  ds_write_b16 v13, v84 offset:0
  ds_write_b16_d16_hi v13, v84 offset:16
  s_mov_b32 exec_hi, -1
  s_waitcnt lgkmcnt(6)
  v_mul_f32 v22, v22, v89
  v_mul_f32 v23, v23, v89
  v_mfma_f32_16x16x32_bf16 v[40:43], v[56:59], v[56:59], v[40:43]
  ds_read_b64 v[72:73], v7 offset:28672
  v_mul_f32 v20, v20, v89
  v_mul_f32 v21, v21, v89
  v_mfma_f32_16x16x32_bf16 v[44:47], v[60:63], v[60:63], v[44:47]
  ds_read_b64 v[74:75], v7 offset:29184
  v_cvt_pk_bf16_f32 v85, v22, v23
  v_cvt_pk_bf16_f32 v82, v20, v21
  v_mfma_f32_16x16x32_bf16 v[24:27], v[136:139], v[56:59], v[24:27]
  ds_read_b64 v[76:77], v10 offset:28672
  s_mov_b32 exec_hi, 0
  ds_write_b16 v13, v85 offset:64
  ds_write_b16_d16_hi v13, v85 offset:80
  s_mov_b32 exec_hi, -1
  v_mul_f32 v16, v16, v16
  v_fmac_f32 v16, v17, v17
  v_mfma_f32_16x16x32_bf16 v[28:31], v[136:139], v[60:63], v[28:31]
  ds_read_b64 v[78:79], v10 offset:29184
  v_mul_f32 v20, v20, v20
  v_fmac_f32 v20, v21, v21
  s_waitcnt lgkmcnt(10)
  v_mfma_f32_16x16x32_bf16 v[40:43], v[64:67], v[64:67], v[40:43]
  ds_read_b64 v[48:49], v7 offset:32768
  s_waitcnt lgkmcnt(9)
  v_mfma_f32_16x16x32_bf16 v[44:47], v[68:71], v[68:71], v[44:47]
  ds_read_b64 v[50:51], v7 offset:33280
  v_mfma_f32_16x16x32_bf16 v[24:27], v[144:147], v[64:67], v[24:27]
  ds_read_b64 v[52:53], v10 offset:32768
  v_mfma_f32_16x16x32_bf16 v[28:31], v[144:147], v[68:71], v[28:31]
  ds_read_b64 v[54:55], v10 offset:33280
  s_waitcnt lgkmcnt(8)
  v_mfma_f32_16x16x32_bf16 v[40:43], v[72:75], v[72:75], v[40:43]
  ds_read_b64 v[56:57], v7 offset:36864
  s_waitcnt lgkmcnt(5)
  v_mfma_f32_16x16x32_bf16 v[44:47], v[76:79], v[76:79], v[44:47]
  ds_read_b64 v[58:59], v7 offset:37376
  v_mfma_f32_16x16x32_bf16 v[24:27], v[152:155], v[72:75], v[24:27]
  ds_read_b64 v[60:61], v10 offset:36864
  v_mfma_f32_16x16x32_bf16 v[28:31], v[152:155], v[76:79], v[28:31]
  ds_read_b64 v[62:63], v10 offset:37376
  s_waitcnt vmcnt(3)
  s_barrier
  s_waitcnt lgkmcnt(6)
  v_mfma_f32_16x16x32_bf16 v[40:43], v[48:51], v[48:51], v[40:43]
  ds_read_b64 v[64:65], v7 offset:40960
  s_waitcnt lgkmcnt(5)
  v_mfma_f32_16x16x32_bf16 v[44:47], v[52:55], v[52:55], v[44:47]
  ds_read_b64 v[66:67], v7 offset:41472
  v_mfma_f32_16x16x32_bf16 v[24:27], v[160:163], v[48:51], v[24:27]
  ds_read_b64 v[68:69], v10 offset:40960
  v_mfma_f32_16x16x32_bf16 v[28:31], v[160:163], v[52:55], v[28:31]
  ds_read_b64 v[70:71], v10 offset:41472
  s_waitcnt lgkmcnt(6)
  v_mfma_f32_16x16x32_bf16 v[40:43], v[56:59], v[56:59], v[40:43]
  ds_read_b64 v[72:73], v7 offset:45056
  s_waitcnt lgkmcnt(5)
  v_mfma_f32_16x16x32_bf16 v[44:47], v[60:63], v[60:63], v[44:47]
  ds_read_b64 v[74:75], v7 offset:45568
  v_mfma_f32_16x16x32_bf16 v[24:27], v[168:171], v[56:59], v[24:27]
  ds_read_b64 v[76:77], v10 offset:45056
  v_mfma_f32_16x16x32_bf16 v[28:31], v[168:171], v[60:63], v[28:31]
  ds_read_b64 v[78:79], v10 offset:45568
  s_waitcnt lgkmcnt(6)
  v_mfma_f32_16x16x32_bf16 v[40:43], v[64:67], v[64:67], v[40:43]
  ds_read_b64 v[48:49], v7 offset:49152
  s_waitcnt lgkmcnt(5)
  v_mfma_f32_16x16x32_bf16 v[44:47], v[68:71], v[68:71], v[44:47]
  ds_read_b64 v[50:51], v7 offset:49664
  v_mfma_f32_16x16x32_bf16 v[24:27], v[176:179], v[64:67], v[24:27]
  ds_read_b64 v[52:53], v10 offset:49152
  v_mfma_f32_16x16x32_bf16 v[28:31], v[176:179], v[68:71], v[28:31]
  ds_read_b64 v[54:55], v10 offset:49664
  s_waitcnt lgkmcnt(6)
  v_mfma_f32_16x16x32_bf16 v[40:43], v[72:75], v[72:75], v[40:43]
  ds_read_b64 v[56:57], v7 offset:53248
  s_waitcnt lgkmcnt(5)
  v_mfma_f32_16x16x32_bf16 v[44:47], v[76:79], v[76:79], v[44:47]
  ds_read_b64 v[58:59], v7 offset:53760
  v_mfma_f32_16x16x32_bf16 v[24:27], v[184:187], v[72:75], v[24:27]
  ds_read_b64 v[60:61], v10 offset:53248
  v_mfma_f32_16x16x32_bf16 v[28:31], v[184:187], v[76:79], v[28:31]
  ds_read_b64 v[62:63], v10 offset:53760
  s_waitcnt vmcnt(2)
  s_barrier
  s_waitcnt lgkmcnt(6)
  v_mfma_f32_16x16x32_bf16 v[40:43], v[48:51], v[48:51], v[40:43]
  ds_read_b64 v[64:65], v7 offset:57344
  s_waitcnt lgkmcnt(5)
  v_mfma_f32_16x16x32_bf16 v[44:47], v[52:55], v[52:55], v[44:47]
  ds_read_b64 v[66:67], v7 offset:57856
  v_mfma_f32_16x16x32_bf16 v[24:27], v[192:195], v[48:51], v[24:27]
  ds_read_b64 v[68:69], v10 offset:57344
  v_mfma_f32_16x16x32_bf16 v[28:31], v[192:195], v[52:55], v[28:31]
  ds_read_b64 v[70:71], v10 offset:57856
  s_waitcnt lgkmcnt(6)
  v_mfma_f32_16x16x32_bf16 v[40:43], v[56:59], v[56:59], v[40:43]
  ds_read_b64 v[72:73], v7 offset:61440
  s_waitcnt lgkmcnt(5)
  v_mfma_f32_16x16x32_bf16 v[44:47], v[60:63], v[60:63], v[44:47]
  ds_read_b64 v[74:75], v7 offset:61952
  v_mfma_f32_16x16x32_bf16 v[24:27], v[200:203], v[56:59], v[24:27]
  ds_read_b64 v[76:77], v10 offset:61440
  v_mfma_f32_16x16x32_bf16 v[28:31], v[200:203], v[60:63], v[28:31]
  ds_read_b64 v[78:79], v10 offset:61952
  s_waitcnt vmcnt(1)
  s_barrier
  s_waitcnt lgkmcnt(6)
  v_mfma_f32_16x16x32_bf16 v[40:43], v[64:67], v[64:67], v[40:43]
  ds_read_b64 v[48:49], v8 offset:0
  s_waitcnt lgkmcnt(5)
  v_mfma_f32_16x16x32_bf16 v[44:47], v[68:71], v[68:71], v[44:47]
  ds_read_b64 v[50:51], v8 offset:512
  v_mfma_f32_16x16x32_bf16 v[24:27], v[208:211], v[64:67], v[24:27]
  ds_read_b64 v[52:53], v11 offset:0
  v_mfma_f32_16x16x32_bf16 v[28:31], v[208:211], v[68:71], v[28:31]
  ds_read_b64 v[54:55], v11 offset:512
  s_waitcnt lgkmcnt(6)
  v_mfma_f32_16x16x32_bf16 v[40:43], v[72:75], v[72:75], v[40:43]
  ds_read_b64 v[56:57], v8 offset:4096
  s_waitcnt lgkmcnt(5)
  v_mfma_f32_16x16x32_bf16 v[44:47], v[76:79], v[76:79], v[44:47]
  ds_read_b64 v[58:59], v8 offset:4608
  v_mfma_f32_16x16x32_bf16 v[24:27], v[216:219], v[72:75], v[24:27]
  ds_read_b64 v[60:61], v11 offset:4096
  v_mfma_f32_16x16x32_bf16 v[28:31], v[216:219], v[76:79], v[28:31]
  ds_read_b64 v[62:63], v11 offset:4608
  s_waitcnt vmcnt(0)
  s_barrier
  ds_read_b64 v[64:65], v8 offset:8192
  ds_read_b64 v[66:67], v8 offset:8704
  s_waitcnt lgkmcnt(8)
  v_mfma_f32_16x16x32_bf16 v[40:43], v[48:51], v[48:51], v[40:43]
  ds_read_b64 v[68:69], v11 offset:8192
  s_waitcnt lgkmcnt(7)
  v_mfma_f32_16x16x32_bf16 v[44:47], v[52:55], v[52:55], v[44:47]
  ds_read_b64 v[70:71], v11 offset:8704
  v_mfma_f32_16x16x32_bf16 v[24:27], v[224:227], v[48:51], v[24:27]
  ds_read_b64 v[72:73], v8 offset:12288
  v_mfma_f32_16x16x32_bf16 v[28:31], v[224:227], v[52:55], v[28:31]
  ds_read_b64 v[74:75], v8 offset:12800
  s_waitcnt lgkmcnt(8)
  v_mfma_f32_16x16x32_bf16 v[40:43], v[56:59], v[56:59], v[40:43]
  ds_read_b64 v[76:77], v11 offset:12288
  s_waitcnt lgkmcnt(7)
  v_mfma_f32_16x16x32_bf16 v[44:47], v[60:63], v[60:63], v[44:47]
  ds_read_b64 v[78:79], v11 offset:12800
  s_waitcnt lgkmcnt(6)
  v_mfma_f32_16x16x32_bf16 v[40:43], v[64:67], v[64:67], v[40:43]
  s_waitcnt lgkmcnt(4)
  v_mfma_f32_16x16x32_bf16 v[44:47], v[68:71], v[68:71], v[44:47]
  s_waitcnt lgkmcnt(2)
  v_mfma_f32_16x16x32_bf16 v[40:43], v[72:75], v[72:75], v[40:43]
  s_waitcnt lgkmcnt(0)
  v_mfma_f32_16x16x32_bf16 v[44:47], v[76:79], v[76:79], v[44:47]
  v_mfma_f32_16x16x32_bf16 v[24:27], v[232:235], v[56:59], v[24:27]
  v_mfma_f32_16x16x32_bf16 v[28:31], v[232:235], v[60:63], v[28:31]
  v_mfma_f32_16x16x32_bf16 v[24:27], v[240:243], v[64:67], v[24:27]
  s_nop 2
  v_cndmask_b32 v40, v40, v41, s[54:55]
  v_cndmask_b32 v42, v42, v43, s[54:55]
  v_cndmask_b32 v40, v40, v42, s[56:57]
  v_fmamk_f32 v40, v40, 0x3ae38e39, v110
  v_rsq_f32 v40, v40
  v_mfma_f32_16x16x32_bf16 v[28:31], v[240:243], v[68:71], v[28:31]
  v_cndmask_b32 v44, v44, v45, s[54:55]
  v_cndmask_b32 v46, v46, v47, s[54:55]
  v_cndmask_b32 v44, v44, v46, s[56:57]
  v_fmamk_f32 v44, v44, 0x3ae38e39, v110
  v_rsq_f32 v44, v44
  s_mov_b64 exec, s[58:59]
  ds_write_b32 v12, v40 offset:256
  ds_write_b32 v12, v44 offset:320
  s_mov_b64 exec, -1
  ds_read_b32 v90, v12 offset:256
  ds_read_b32 v91, v12 offset:320
  s_waitcnt lgkmcnt(2)
  s_barrier
  v_mfma_f32_16x16x32_bf16 v[24:27], v[248:251], v[72:75], v[24:27]
  v_mfma_f32_16x16x32_bf16 v[28:31], v[248:251], v[76:79], v[28:31]
  s_waitcnt lgkmcnt(1)
  s_nop 5
  v_mul_f32 v26, v26, v90
  v_mul_f32 v27, v27, v90
  v_mul_f32 v24, v24, v90
  v_mul_f32 v25, v25, v90
  v_cvt_pk_bf16_f32 v84, v26, v27
  v_cvt_pk_bf16_f32 v81, v24, v25
  s_mov_b32 exec_hi, 0
  ds_write_b16 v13, v84 offset:128
  ds_write_b16_d16_hi v13, v84 offset:144
  s_mov_b32 exec_hi, -1
  s_waitcnt lgkmcnt(2)
  v_mul_f32 v30, v30, v91
  v_mul_f32 v31, v31, v91
  v_mul_f32 v28, v28, v91
  v_mul_f32 v29, v29, v91
  v_cvt_pk_bf16_f32 v85, v30, v31
  v_cvt_pk_bf16_f32 v83, v28, v29
  s_mov_b32 exec_hi, 0
  ds_write_b16 v13, v85 offset:192
  ds_write_b16_d16_hi v13, v85 offset:208
  s_mov_b32 exec_hi, -1
  buffer_store_dwordx4 v[80:83], v14, s[32:35], 0 offen sc1
  s_waitcnt lgkmcnt(0)
  ds_read_b128 v[92:95], v15
  v_mul_f32 v24, v24, v24
  v_fmac_f32 v24, v25, v25
  v_mul_f32 v28, v28, v28
  v_fmac_f32 v28, v29, v29
  v_max_f32 v104, v16, v20
  v_max3_f32 v104, v104, v24, v28
  s_mov_b32 exec_hi, 0
  v_mov_b32 v104, 0
  s_waitcnt lgkmcnt(0)
  buffer_store_dwordx4 v[92:95], v109, s[32:35], s64 offen sc1
  s_mov_b32 exec_hi, -1
  s_branch qkv_kmx
qkv_v2:
  s_waitcnt vmcnt(7)
  s_barrier
  ds_read_b64 v[48:49], v6 offset:0
  ds_read_b64 v[50:51], v6 offset:512
  ds_read_b64 v[52:53], v6 offset:2048
  ds_read_b64 v[54:55], v6 offset:2560
  ds_read_b64 v[56:57], v6 offset:4096
  ds_read_b64 v[58:59], v6 offset:4608
  ds_read_b64 v[60:61], v6 offset:6144
  ds_read_b64 v[62:63], v6 offset:6656
  s_waitcnt vmcnt(6)
  s_barrier
  ds_read_b64 v[64:65], v6 offset:8192
  ds_read_b64 v[66:67], v6 offset:8704
  s_waitcnt lgkmcnt(8)
  buffer_load_dwordx4 v5, s[24:27], s48 offen sc1 lds
  s_add_u32 m0, m0, 8192
  s_sub_u32 s48, s48, 2096640
  v_mfma_f32_32x32x16_bf16 v[16:31], v[48:51], v[112:115], 0
  ds_read_b64 v[68:69], v6 offset:10240
  ds_read_b64 v[70:71], v6 offset:10752
  s_waitcnt lgkmcnt(8)
  buffer_load_dwordx4 v5, s[24:27], s48 offen sc1 lds
  s_add_u32 m0, m0, 8192
  s_add_u32 s48, s48, 262144
  v_mfma_f32_32x32x16_bf16 v[16:31], v[52:55], v[116:119], v[16:31]
  ds_read_b64 v[72:73], v6 offset:12288
  ds_read_b64 v[74:75], v6 offset:12800
  s_waitcnt lgkmcnt(8)
  buffer_load_dwordx4 v5, s[24:27], s48 offen sc1 lds
  s_add_u32 m0, m0, 8192
  s_add_u32 s48, s48, 262144
  v_mfma_f32_32x32x16_bf16 v[16:31], v[56:59], v[120:123], v[16:31]
  ds_read_b64 v[76:77], v6 offset:14336
  ds_read_b64 v[78:79], v6 offset:14848
  s_waitcnt lgkmcnt(8)
  buffer_load_dwordx4 v5, s[24:27], s48 offen sc1 lds
  s_add_u32 m0, m0, 8192
  s_add_u32 s48, s48, 262144
  v_mfma_f32_32x32x16_bf16 v[16:31], v[60:63], v[124:127], v[16:31]
  s_waitcnt vmcnt(9)
  s_barrier
  ds_read_b64 v[48:49], v6 offset:16384
  ds_read_b64 v[50:51], v6 offset:16896
  s_waitcnt lgkmcnt(8)
  buffer_load_dwordx4 v5, s[24:27], s48 offen sc1 lds
  s_add_u32 m0, m0, 8192
  s_add_u32 s48, s48, 262144
  v_mfma_f32_32x32x16_bf16 v[16:31], v[64:67], v[128:131], v[16:31]
  ds_read_b64 v[52:53], v6 offset:18432
  ds_read_b64 v[54:55], v6 offset:18944
  s_waitcnt lgkmcnt(8)
  buffer_load_dwordx4 v5, s[24:27], s48 offen sc1 lds
  s_add_u32 m0, m0, 8192
  s_add_u32 s48, s48, 262144
  v_mfma_f32_32x32x16_bf16 v[16:31], v[68:71], v[132:135], v[16:31]
  ds_read_b64 v[56:57], v6 offset:20480
  ds_read_b64 v[58:59], v6 offset:20992
  s_waitcnt lgkmcnt(8)
  buffer_load_dwordx4 v5, s[24:27], s48 offen sc1 lds
  s_add_u32 m0, m0, 8192
  s_add_u32 s48, s48, 262144
  v_mfma_f32_32x32x16_bf16 v[16:31], v[72:75], v[136:139], v[16:31]
  ds_read_b64 v[60:61], v6 offset:22528
  ds_read_b64 v[62:63], v6 offset:23040
  s_waitcnt lgkmcnt(8)
  buffer_load_dwordx4 v5, s[24:27], s48 offen sc1 lds
  s_add_u32 m0, m0, 8192
  s_add_u32 s48, s48, 262144
  v_mfma_f32_32x32x16_bf16 v[16:31], v[76:79], v[140:143], v[16:31]
  s_waitcnt vmcnt(11)
  s_barrier
  ds_read_b64 v[64:65], v6 offset:24576
  ds_read_b64 v[66:67], v6 offset:25088
  s_waitcnt lgkmcnt(8)
  buffer_load_dwordx4 v5, s[24:27], s48 offen sc1 lds
  s_add_u32 m0, m0, 8192
  s_add_u32 s48, s48, 262144
  v_mfma_f32_32x32x16_bf16 v[16:31], v[48:51], v[144:147], v[16:31]
  ds_read_b64 v[68:69], v6 offset:26624
  ds_read_b64 v[70:71], v6 offset:27136
  s_waitcnt lgkmcnt(8)
  buffer_load_dwordx4 v5, s[24:27], s48 offen sc1 lds
  v_mfma_f32_32x32x16_bf16 v[16:31], v[52:55], v[148:151], v[16:31]
  ds_read_b64 v[72:73], v6 offset:28672
  ds_read_b64 v[74:75], v6 offset:29184
  s_waitcnt lgkmcnt(8)
  v_mfma_f32_32x32x16_bf16 v[16:31], v[56:59], v[152:155], v[16:31]
  ds_read_b64 v[76:77], v6 offset:30720
  ds_read_b64 v[78:79], v6 offset:31232
  s_waitcnt lgkmcnt(8)
  v_mfma_f32_32x32x16_bf16 v[16:31], v[60:63], v[156:159], v[16:31]
  ds_read_b64 v[48:49], v6 offset:32768
  ds_read_b64 v[50:51], v6 offset:33280
  s_waitcnt lgkmcnt(8)
  v_mfma_f32_32x32x16_bf16 v[16:31], v[64:67], v[160:163], v[16:31]
  ds_read_b64 v[52:53], v6 offset:34816
  ds_read_b64 v[54:55], v6 offset:35328
  s_waitcnt lgkmcnt(8)
  v_mfma_f32_32x32x16_bf16 v[16:31], v[68:71], v[164:167], v[16:31]
  ds_read_b64 v[56:57], v6 offset:36864
  ds_read_b64 v[58:59], v6 offset:37376
  s_waitcnt lgkmcnt(8)
  v_mfma_f32_32x32x16_bf16 v[16:31], v[72:75], v[168:171], v[16:31]
  ds_read_b64 v[60:61], v6 offset:38912
  ds_read_b64 v[62:63], v6 offset:39424
  s_waitcnt lgkmcnt(8)
  v_mfma_f32_32x32x16_bf16 v[16:31], v[76:79], v[172:175], v[16:31]
  s_waitcnt vmcnt(11)
  s_barrier
  ds_read_b64 v[64:65], v6 offset:40960
  ds_read_b64 v[66:67], v6 offset:41472
  s_waitcnt lgkmcnt(8)
  v_mfma_f32_32x32x16_bf16 v[16:31], v[48:51], v[176:179], v[16:31]
  ds_read_b64 v[68:69], v6 offset:43008
  ds_read_b64 v[70:71], v6 offset:43520
  s_waitcnt lgkmcnt(8)
  v_mfma_f32_32x32x16_bf16 v[16:31], v[52:55], v[180:183], v[16:31]
  ds_read_b64 v[72:73], v6 offset:45056
  ds_read_b64 v[74:75], v6 offset:45568
  s_waitcnt lgkmcnt(8)
  v_mfma_f32_32x32x16_bf16 v[16:31], v[56:59], v[184:187], v[16:31]
  ds_read_b64 v[76:77], v6 offset:47104
  ds_read_b64 v[78:79], v6 offset:47616
  s_waitcnt lgkmcnt(8)
  v_mfma_f32_32x32x16_bf16 v[16:31], v[60:63], v[188:191], v[16:31]
  ds_read_b64 v[48:49], v6 offset:49152
  ds_read_b64 v[50:51], v6 offset:49664
  s_waitcnt lgkmcnt(8)
  v_mfma_f32_32x32x16_bf16 v[16:31], v[64:67], v[192:195], v[16:31]
  ds_read_b64 v[52:53], v6 offset:51200
  ds_read_b64 v[54:55], v6 offset:51712
  s_waitcnt lgkmcnt(8)
  v_mfma_f32_32x32x16_bf16 v[16:31], v[68:71], v[196:199], v[16:31]
  ds_read_b64 v[56:57], v6 offset:53248
  ds_read_b64 v[58:59], v6 offset:53760
  s_waitcnt lgkmcnt(8)
  v_mfma_f32_32x32x16_bf16 v[16:31], v[72:75], v[200:203], v[16:31]
  ds_read_b64 v[60:61], v6 offset:55296
  ds_read_b64 v[62:63], v6 offset:55808
  s_waitcnt lgkmcnt(8)
  v_mfma_f32_32x32x16_bf16 v[16:31], v[76:79], v[204:207], v[16:31]
  s_waitcnt vmcnt(9)
  s_barrier
  ds_read_b64 v[64:65], v6 offset:57344
  ds_read_b64 v[66:67], v6 offset:57856
  s_waitcnt lgkmcnt(8)
  v_mfma_f32_32x32x16_bf16 v[16:31], v[48:51], v[208:211], v[16:31]
  ds_read_b64 v[68:69], v6 offset:59392
  ds_read_b64 v[70:71], v6 offset:59904
  s_waitcnt lgkmcnt(8)
  v_mfma_f32_32x32x16_bf16 v[16:31], v[52:55], v[212:215], v[16:31]
  ds_read_b64 v[72:73], v6 offset:61440
  ds_read_b64 v[74:75], v6 offset:61952
  s_waitcnt lgkmcnt(8)
  v_mfma_f32_32x32x16_bf16 v[16:31], v[56:59], v[216:219], v[16:31]
  ds_read_b64 v[76:77], v6 offset:63488
  ds_read_b64 v[78:79], v6 offset:64000
  s_waitcnt lgkmcnt(8)
  v_mfma_f32_32x32x16_bf16 v[16:31], v[60:63], v[220:223], v[16:31]
  ds_read_b64 v[48:49], v7 offset:0
  ds_read_b64 v[50:51], v7 offset:512
  s_waitcnt lgkmcnt(8)
  v_mfma_f32_32x32x16_bf16 v[16:31], v[64:67], v[224:227], v[16:31]
  ds_read_b64 v[52:53], v7 offset:2048
  ds_read_b64 v[54:55], v7 offset:2560
  s_waitcnt lgkmcnt(8)
  v_mfma_f32_32x32x16_bf16 v[16:31], v[68:71], v[228:231], v[16:31]
  ds_read_b64 v[56:57], v7 offset:4096
  ds_read_b64 v[58:59], v7 offset:4608
  s_waitcnt lgkmcnt(8)
  v_mfma_f32_32x32x16_bf16 v[16:31], v[72:75], v[232:235], v[16:31]
  ds_read_b64 v[60:61], v7 offset:6144
  ds_read_b64 v[62:63], v7 offset:6656
  s_waitcnt lgkmcnt(8)
  v_mfma_f32_32x32x16_bf16 v[16:31], v[76:79], v[236:239], v[16:31]
  s_waitcnt vmcnt(7)
  s_barrier
  ds_read_b64 v[64:65], v7 offset:8192
  ds_read_b64 v[66:67], v7 offset:8704
  s_waitcnt lgkmcnt(8)
  v_mfma_f32_32x32x16_bf16 v[16:31], v[48:51], v[240:243], v[16:31]
  ds_read_b64 v[68:69], v7 offset:10240
  ds_read_b64 v[70:71], v7 offset:10752
  s_waitcnt lgkmcnt(8)
  v_mfma_f32_32x32x16_bf16 v[16:31], v[52:55], v[244:247], v[16:31]
  ds_read_b64 v[72:73], v7 offset:12288
  ds_read_b64 v[74:75], v7 offset:12800
  s_waitcnt lgkmcnt(8)
  v_mfma_f32_32x32x16_bf16 v[16:31], v[56:59], v[248:251], v[16:31]
  ds_read_b64 v[76:77], v7 offset:14336
  ds_read_b64 v[78:79], v7 offset:14848
  s_waitcnt lgkmcnt(8)
  v_mfma_f32_32x32x16_bf16 v[16:31], v[60:63], v[252:255], v[16:31]
  ds_read_b64 v[48:49], v7 offset:16384
  ds_read_b64 v[50:51], v7 offset:16896
  s_waitcnt lgkmcnt(8)
  v_mfma_f32_32x32x16_bf16 v[32:47], v[64:67], v[112:115], 0
  ds_read_b64 v[52:53], v7 offset:18432
  ds_read_b64 v[54:55], v7 offset:18944
  s_waitcnt lgkmcnt(8)
  v_mfma_f32_32x32x16_bf16 v[32:47], v[68:71], v[116:119], v[32:47]
  ds_read_b64 v[56:57], v7 offset:20480
  ds_read_b64 v[58:59], v7 offset:20992
  s_waitcnt lgkmcnt(8)
  v_mfma_f32_32x32x16_bf16 v[32:47], v[72:75], v[120:123], v[32:47]
  ds_read_b64 v[60:61], v7 offset:22528
  ds_read_b64 v[62:63], v7 offset:23040
  s_waitcnt lgkmcnt(8)
  v_mfma_f32_32x32x16_bf16 v[32:47], v[76:79], v[124:127], v[32:47]
  s_waitcnt vmcnt(5)
  s_barrier
  ds_read_b128 v[88:91], v9 offset:0
  ds_read_b128 v[92:95], v9 offset:32
  ds_read_b128 v[96:99], v9 offset:64
  ds_read_b128 v[100:103], v9 offset:96
  ds_read_b64 v[64:65], v7 offset:24576
  ds_read_b64 v[66:67], v7 offset:25088
  s_waitcnt lgkmcnt(12)
  v_mfma_f32_32x32x16_bf16 v[32:47], v[48:51], v[128:131], v[32:47]
  ds_read_b64 v[68:69], v7 offset:26624
  ds_read_b64 v[70:71], v7 offset:27136
  s_waitcnt lgkmcnt(12)
  v_mfma_f32_32x32x16_bf16 v[32:47], v[52:55], v[132:135], v[32:47]
  ds_read_b64 v[72:73], v7 offset:28672
  ds_read_b64 v[74:75], v7 offset:29184
  s_waitcnt lgkmcnt(12)
  v_mfma_f32_32x32x16_bf16 v[32:47], v[56:59], v[136:139], v[32:47]
  s_waitcnt lgkmcnt(9)
  v_mul_f32 v16, v16, v88
  v_mul_f32 v17, v17, v89
  v_cvt_pk_bf16_f32 v80, v16, v17
  ds_read_b64 v[76:77], v7 offset:30720
  ds_read_b64 v[78:79], v7 offset:31232
  v_mfma_f32_32x32x16_bf16 v[32:47], v[60:63], v[140:143], v[32:47]
  v_mul_f32 v18, v18, v90
  v_mul_f32 v19, v19, v91
  v_cvt_pk_bf16_f32 v81, v18, v19
  ds_read_b64 v[48:49], v7 offset:32768
  ds_read_b64 v[50:51], v7 offset:33280
  s_waitcnt lgkmcnt(8)
  v_mfma_f32_32x32x16_bf16 v[32:47], v[64:67], v[144:147], v[32:47]
  v_mul_f32 v20, v20, v92
  v_mul_f32 v21, v21, v93
  v_cvt_pk_bf16_f32 v82, v20, v21
  ds_read_b64 v[52:53], v7 offset:34816
  ds_read_b64 v[54:55], v7 offset:35328
  s_waitcnt lgkmcnt(8)
  v_mfma_f32_32x32x16_bf16 v[32:47], v[68:71], v[148:151], v[32:47]
  v_mul_f32 v22, v22, v94
  v_mul_f32 v23, v23, v95
  v_cvt_pk_bf16_f32 v83, v22, v23
  ds_read_b64 v[56:57], v7 offset:36864
  ds_read_b64 v[58:59], v7 offset:37376
  s_waitcnt lgkmcnt(8)
  v_mfma_f32_32x32x16_bf16 v[32:47], v[72:75], v[152:155], v[32:47]
  buffer_store_dwordx4 v[80:83], v12, s[32:35], s64 offen offset:0 sc1
  v_mul_f32 v24, v24, v96
  v_mul_f32 v25, v25, v97
  ds_read_b64 v[60:61], v7 offset:38912
  ds_read_b64 v[62:63], v7 offset:39424
  s_waitcnt lgkmcnt(8)
  v_mfma_f32_32x32x16_bf16 v[32:47], v[76:79], v[156:159], v[32:47]
  v_cvt_pk_bf16_f32 v84, v24, v25
  v_mul_f32 v26, v26, v98
  v_mul_f32 v27, v27, v99
  s_waitcnt vmcnt(4)
  s_barrier
  ds_read_b64 v[64:65], v7 offset:40960
  ds_read_b64 v[66:67], v7 offset:41472
  s_waitcnt lgkmcnt(8)
  v_mfma_f32_32x32x16_bf16 v[32:47], v[48:51], v[160:163], v[32:47]
  v_cvt_pk_bf16_f32 v85, v26, v27
  v_mul_f32 v28, v28, v100
  v_mul_f32 v29, v29, v101
  ds_read_b64 v[68:69], v7 offset:43008
  ds_read_b64 v[70:71], v7 offset:43520
  s_waitcnt lgkmcnt(8)
  v_mfma_f32_32x32x16_bf16 v[32:47], v[52:55], v[164:167], v[32:47]
  v_cvt_pk_bf16_f32 v86, v28, v29
  v_mul_f32 v30, v30, v102
  v_mul_f32 v31, v31, v103
  ds_read_b64 v[72:73], v7 offset:45056
  ds_read_b64 v[74:75], v7 offset:45568
  s_waitcnt lgkmcnt(8)
  v_mfma_f32_32x32x16_bf16 v[32:47], v[56:59], v[168:171], v[32:47]
  v_cvt_pk_bf16_f32 v87, v30, v31
  buffer_store_dwordx4 v[84:87], v12, s[32:35], s64 offen offset:576 sc1
  ds_read_b64 v[76:77], v7 offset:47104
  ds_read_b64 v[78:79], v7 offset:47616
  s_waitcnt lgkmcnt(8)
  v_mfma_f32_32x32x16_bf16 v[32:47], v[60:63], v[172:175], v[32:47]
  ds_read_b64 v[48:49], v7 offset:49152
  ds_read_b64 v[50:51], v7 offset:49664
  s_waitcnt lgkmcnt(8)
  v_mfma_f32_32x32x16_bf16 v[32:47], v[64:67], v[176:179], v[32:47]
  ds_read_b64 v[52:53], v7 offset:51200
  ds_read_b64 v[54:55], v7 offset:51712
  s_waitcnt lgkmcnt(8)
  v_mfma_f32_32x32x16_bf16 v[32:47], v[68:71], v[180:183], v[32:47]
  ds_read_b64 v[56:57], v7 offset:53248
  ds_read_b64 v[58:59], v7 offset:53760
  s_waitcnt lgkmcnt(8)
  v_mfma_f32_32x32x16_bf16 v[32:47], v[72:75], v[184:187], v[32:47]
  ds_read_b64 v[60:61], v7 offset:55296
  ds_read_b64 v[62:63], v7 offset:55808
  s_waitcnt lgkmcnt(8)
  v_mfma_f32_32x32x16_bf16 v[32:47], v[76:79], v[188:191], v[32:47]
  s_waitcnt vmcnt(4)
  s_barrier
  ds_read_b64 v[64:65], v7 offset:57344
  ds_read_b64 v[66:67], v7 offset:57856
  s_waitcnt lgkmcnt(8)
  v_mfma_f32_32x32x16_bf16 v[32:47], v[48:51], v[192:195], v[32:47]
  ds_read_b64 v[68:69], v7 offset:59392
  ds_read_b64 v[70:71], v7 offset:59904
  s_waitcnt lgkmcnt(8)
  v_mfma_f32_32x32x16_bf16 v[32:47], v[52:55], v[196:199], v[32:47]
  ds_read_b64 v[72:73], v7 offset:61440
  ds_read_b64 v[74:75], v7 offset:61952
  s_waitcnt lgkmcnt(8)
  v_mfma_f32_32x32x16_bf16 v[32:47], v[56:59], v[200:203], v[32:47]
  ds_read_b64 v[76:77], v7 offset:63488
  ds_read_b64 v[78:79], v7 offset:64000
  s_waitcnt lgkmcnt(8)
  v_mfma_f32_32x32x16_bf16 v[32:47], v[60:63], v[204:207], v[32:47]
  s_waitcnt vmcnt(3)
  s_barrier
  ds_read_b64 v[48:49], v8 offset:0
  ds_read_b64 v[50:51], v8 offset:512
  s_waitcnt lgkmcnt(8)
  v_mfma_f32_32x32x16_bf16 v[32:47], v[64:67], v[208:211], v[32:47]
  ds_read_b64 v[52:53], v8 offset:2048
  ds_read_b64 v[54:55], v8 offset:2560
  s_waitcnt lgkmcnt(8)
  v_mfma_f32_32x32x16_bf16 v[32:47], v[68:71], v[212:215], v[32:47]
  ds_read_b64 v[56:57], v8 offset:4096
  ds_read_b64 v[58:59], v8 offset:4608
  s_waitcnt lgkmcnt(8)
  v_mfma_f32_32x32x16_bf16 v[32:47], v[72:75], v[216:219], v[32:47]
  ds_read_b64 v[60:61], v8 offset:6144
  ds_read_b64 v[62:63], v8 offset:6656
  s_waitcnt lgkmcnt(8)
  v_mfma_f32_32x32x16_bf16 v[32:47], v[76:79], v[220:223], v[32:47]
  s_waitcnt vmcnt(2)
  s_barrier
  ds_read_b64 v[64:65], v8 offset:8192
  ds_read_b64 v[66:67], v8 offset:8704
  s_waitcnt lgkmcnt(8)
  v_mfma_f32_32x32x16_bf16 v[32:47], v[48:51], v[224:227], v[32:47]
  ds_read_b64 v[68:69], v8 offset:10240
  ds_read_b64 v[70:71], v8 offset:10752
  s_waitcnt lgkmcnt(8)
  v_mfma_f32_32x32x16_bf16 v[32:47], v[52:55], v[228:231], v[32:47]
  ds_read_b64 v[72:73], v8 offset:12288
  ds_read_b64 v[74:75], v8 offset:12800
  s_waitcnt lgkmcnt(8)
  v_mfma_f32_32x32x16_bf16 v[32:47], v[56:59], v[232:235], v[32:47]
  ds_read_b64 v[76:77], v8 offset:14336
  ds_read_b64 v[78:79], v8 offset:14848
  s_waitcnt lgkmcnt(8)
  v_mfma_f32_32x32x16_bf16 v[32:47], v[60:63], v[236:239], v[32:47]
  s_waitcnt lgkmcnt(6)
  v_mfma_f32_32x32x16_bf16 v[32:47], v[64:67], v[240:243], v[32:47]
  s_waitcnt lgkmcnt(4)
  v_mfma_f32_32x32x16_bf16 v[32:47], v[68:71], v[244:247], v[32:47]
  s_waitcnt lgkmcnt(2)
  v_mfma_f32_32x32x16_bf16 v[32:47], v[72:75], v[248:251], v[32:47]
  s_barrier
  ds_read_b128 v[88:91], v9 offset:256
  ds_read_b128 v[92:95], v9 offset:288
  ds_read_b128 v[96:99], v9 offset:320
  ds_read_b128 v[100:103], v9 offset:352
  s_waitcnt lgkmcnt(4)
  v_mfma_f32_32x32x16_bf16 v[32:47], v[76:79], v[252:255], v[32:47]
  s_waitcnt lgkmcnt(3)
  s_nop 10
  v_mul_f32 v32, v32, v88
  v_mul_f32 v33, v33, v89
  v_cvt_pk_bf16_f32 v80, v32, v33
  v_mul_f32 v34, v34, v90
  v_mul_f32 v35, v35, v91
  v_cvt_pk_bf16_f32 v81, v34, v35
  s_waitcnt lgkmcnt(2)
  v_mul_f32 v36, v36, v92
  v_mul_f32 v37, v37, v93
  v_cvt_pk_bf16_f32 v82, v36, v37
  v_mul_f32 v38, v38, v94
  v_mul_f32 v39, v39, v95
  v_cvt_pk_bf16_f32 v83, v38, v39
  buffer_store_dwordx4 v[80:83], v12, s[32:35], s64 offen offset:1152 sc1
  s_waitcnt lgkmcnt(1)
  v_mul_f32 v40, v40, v96
  v_mul_f32 v41, v41, v97
  v_cvt_pk_bf16_f32 v84, v40, v41
  v_mul_f32 v42, v42, v98
  v_mul_f32 v43, v43, v99
  v_cvt_pk_bf16_f32 v85, v42, v43
  s_waitcnt lgkmcnt(0)
  v_mul_f32 v44, v44, v100
  v_mul_f32 v45, v45, v101
  v_cvt_pk_bf16_f32 v86, v44, v45
  v_mul_f32 v46, v46, v102
  v_mul_f32 v47, v47, v103
  v_cvt_pk_bf16_f32 v87, v46, v47
  buffer_store_dwordx4 v[84:87], v12, s[32:35], s64 offen offset:1728 sc1
  v_mov_b32 v4, s100
qkv_pub:
  v_mov_b32 v5, s101
  s_lshl_b32 s43, s43, 7
  s_add_u32 s43, s43, s65
  s_mov_b64 exec, 1
  s_waitcnt vmcnt(0)
  buffer_store_dwordx2 v[4:5], off, s[68:71], s43 sc1
  s_mov_b64 exec, -1
  s_mov_b32 s40, s22
  s_mov_b64 exec, -1
  s_setprio 0
  s_cmp_lg_u32 s23, 0
  s_cbranch_scc1 attn_nw
  s_add_u32 s60, s10, 2359296
  s_addc_u32 s61, s11, 0
  s_mov_b32 s62, 1990656
  s_mov_b32 s63, 0x20000
  s_and_b32 s41, s22, 1
  s_mul_i32 s41, s41, 54
  v_add_u32 v4, s41, v1
  v_bfe_u32 v5, v4, 4, 1
  v_bfe_u32 v6, v4, 5, 1
  v_mul_u32_u24 v7, 576, v5
  v_mad_u32_u24 v7, v6, 18, v7
  v_bfe_u32 v6, v4, 2, 1
  v_lshl_add_u32 v7, v6, 3, v7
  v_bfe_u32 v6, v4, 3, 1
  v_lshl_add_u32 v7, v6, 2, v7
  v_and_b32 v6, 3, v4
  v_add_u32 v7, v7, v6
  v_lshl_add_u32 v5, v5, 1, v4
  v_add_u32 v5, 1088, v5
  v_cmp_gt_u32 vcc, 64, v4
  s_nop 1
  v_cndmask_b32 v7, v5, v7, vcc
  v_bfe_u32 v5, v4, 2, 2
  v_mul_u32_u24 v5, 576, v5
  v_lshrrev_b32 v6, 1, v6
  v_mad_u32_u24 v5, v6, 18, v5
  v_and_or_b32 v6, v4, 1, 16
  v_add_u32 v5, v5, v6
  v_cmp_gt_u32 vcc, 96, v4
  s_nop 1
  v_cndmask_b32 v7, v5, v7, vcc
  s_lshr_b32 s41, s88, 4
  s_mul_i32 s41, s41, 36
  v_add_lshl_u32 v220, v7, s41, 4
  s_bfm_b64 s[94:95], 54, 0
  s_bfe_u32 s64, s22, 0x10001
  s_mul_i32 s64, s64, 27648
  s_and_b32 s96, s22, 3
  s_mul_i32 s96, s96, 864
attn_nw:
  s_and_b32 s41, s2, 7
  s_lshl_b32 s46, s41, 2
  s_bfe_u32 s41, s2, 0x20003
  s_add_u32 s46, s46, s41
  v_lshlrev_b32 v5, 4, v1
  s_lshr_b32 s47, s2, 5
  s_lshl_b32 s47, s47, 2
  s_and_b32 s41, s40, 3
  s_add_u32 s47, s47, s41
  s_lshr_b32 s44, s40, 2
  s_mov_b32 s48, 0
  s_mul_i32 s49, s46, 147456
  s_lshl_b32 m0, s40, 10
  s_add_u32 s49, s49, m0
  s_lshl_b32 s41, s47, 6
  s_lshl_b32 s42, s44, 5
  s_add_u32 s42, s42, s41
  v_add_u32 v9, s42, v2
  v_lshlrev_b32 v4, 15, v3
  v_lshl_add_u32 v11, v9, 4, v4
  v_lshlrev_b32 v9, 2, v9
  s_and_b32 s41, s47, -2
  s_add_u32 s41, s41, s44
  s_lshl_b32 s41, s41, 8
  s_bitcmp1_b32 s47, 0
  s_cselect_b32 s51, 4, 0
  s_add_u32 s41, s41, s51
  v_and_b32 v14, 15, v2
  v_lshrrev_b32 v4, 4, v2
  v_lshlrev_b32 v4, 3, v4
  v_lshl_add_u32 v14, v14, 4, v4
  v_add_u32 v10, s41, v14
  s_lshl_b32 s51, s46, 16
  s_lshl_b32 s52, s46, 13
  s_add_u32 s52, s52, 2097152
  s_add_u32 s43, s42, s46
  s_add_u32 s43, s43, 6144
  v_mov_b32 v4, 158720
  s_add_u32 s24, s20, 7143424
  s_addc_u32 s25, s21, 0
  s_mov_b32 s26, 4718592
  s_mov_b32 s27, 0x20000
  s_add_u32 s28, s20, 4784128
  s_addc_u32 s29, s21, 0
  s_mov_b32 s30, 2359296
  s_mov_b32 s31, 0x20000
  s_add_u32 s32, s20, 11862016
  s_addc_u32 s33, s21, 0
  s_mov_b32 s34, 2359296
  s_mov_b32 s35, 0x20000
  v_lshlrev_b32 v13, 4, v2
  v_lshl_add_u32 v13, v3, 11, v13
  v_lshl_add_u32 v14, v3, 8, v14
  v_add_u32 v14, 4096, v14
  v_bfe_u32 v6, v2, 2, 1
  v_lshl_add_u32 v6, v3, 1, v6
  v_bfe_u32 v15, v2, 3, 1
  v_lshl_add_u32 v6, v6, 1, v15
  v_and_b32 v15, 3, v2
  v_lshl_add_u32 v6, v6, 2, v15
  v_and_b32 v15, 1, v2
  v_lshl_add_u32 v15, v3, 1, v15
  v_add_u32 v15, 32, v15
  v_cmp_gt_u32 vcc, 16, v2
  s_nop 1
  v_cndmask_b32 v6, v15, v6, vcc
  v_lshlrev_b32 v15, 4, v6
  v_add_u32 v15, 4608, v15
  s_mov_b32 s56, 0x00440000
  s_mov_b32 s57, s56
  v_mov_b32 v6, 0x3f803f80
  s_mov_b32 s58, 0x3ffff
  s_mov_b32 s59, s58
  v_cndmask_b32 v224, 0, v6, s[56:57]
  v_cndmask_b32 v225, 0, v6, s[56:57]
  v_cndmask_b32 v226, 0, v6, s[56:57]
  v_cndmask_b32 v227, 0, v6, s[56:57]
  v_cndmask_b32 v228, 0, v6, s[56:57]
  v_cndmask_b32 v229, 0, v6, s[56:57]
  v_cndmask_b32 v230, 0, v6, s[56:57]
  v_cndmask_b32 v231, 0, v6, s[56:57]
  v_cndmask_b32 v232, 0, v6, s[56:57]
  v_cndmask_b32 v233, 0, v6, s[56:57]
  v_cndmask_b32 v234, 0, v6, s[56:57]
  v_cndmask_b32 v235, 0, v6, s[56:57]
  v_cndmask_b32 v236, 0, v6, s[56:57]
  v_cndmask_b32 v237, 0, v6, s[56:57]
  v_cndmask_b32 v238, 0, v6, s[56:57]
  v_cndmask_b32 v239, 0, v6, s[56:57]
  v_mov_b32 v92, 0
  v_mov_b32 v93, 0
  v_mov_b32 v94, 0
  v_mov_b32 v95, 0
  v_mov_b32 v96, 0
  v_mov_b32 v97, 0
  v_mov_b32 v98, 0
  v_mov_b32 v99, 0
  s_lshl_b32 s53, s40, 2
  s_add_u32 s53, s53, 162816
  v_mov_b32 v6, s53
  ds_write_b32 v6, v92
  s_and_b32 s41, s40, 3
  s_cmp_eq_u32 s41, 2
  s_cbranch_scc0 attn_np
  s_lshr_b32 s41, s46, 1
  s_lshl_b32 s41, s41, 7
  s_lshl_b32 s42, s40, 4
  s_add_u32 s41, s41, s42
  s_add_u32 s41, s41, 4064
  v_add_u32 v12, s41, v1
  v_lshrrev_b32 v6, 2, v1
  v_and_b32 v6, 12, v6
  s_lshl_b32 s41, s40, 2
  s_add_u32 s41, s41, 158712
  v_add_u32 v6, s41, v6
  s_mov_b32 s41, 0x99999999
  s_bitcmp1_b32 s46, 0
  s_cselect_b32 s56, 0xaaaaaaaa, s41
  s_mov_b32 s57, s56
  v_lshlrev_b32 v12, 7, v12
  s_mov_b32 s3, 65536
poll11:
  buffer_load_dwordx2 v[240:241], v12, s[68:71], s65 offen sc1
  s_waitcnt vmcnt(0)
  v_xor_b32 v242, s100, v240
  v_cmp_ne_u32 s[66:67], s101, v241
  v_cmp_lt_u32 vcc, 0xffff, v242
  s_nop 0
  s_or_b64 vcc, s[66:67], vcc
  s_sub_u32 s3, s3, 1
  s_cbranch_scc1 poll11_x
  s_mov_b64 exec, vcc
  s_cbranch_vccnz poll11
poll11_x:
  s_mov_b64 exec, -1
  v_lshlrev_b32 v240, 16, v240
  v_cndmask_b32 v240, 0, v240, s[56:57]
  s_nop 1
  v_add_f32_dpp v240, v240, v240 quad_perm:[2,3,0,1] row_mask:0xf bank_mask:0xf
  s_nop 1
  v_add_f32_dpp v240, v240, v240 quad_perm:[1,0,3,2] row_mask:0xf bank_mask:0xf
  s_nop 1
  v_max_f32_dpp v240, v240, v240 row_half_mirror row_mask:0xf bank_mask:0xf
  s_nop 1
  v_max_f32_dpp v240, v240, v240 row_mirror row_mask:0xf bank_mask:0xf
  ds_write_b32 v6, v240
attn_np:
  s_waitcnt lgkmcnt(0)
  s_barrier
  buffer_load_dwordx4 v[88:91], v11, s[28:31], s51 offen sc1
  buffer_load_dword v244, v10, s[28:31], s52 offen sc1
  ds_read_b128 v[240:243], v4
  ds_read_b128 v[248:251], v4 offset:16
  buffer_load_dwordx4 v5, s[24:27], s49 offen sc1 lds
  s_add_u32 m0, m0, 8192
  s_add_u32 s49, s49, 8192
  buffer_load_dwordx4 v5, s[24:27], s49 offen sc1 lds
  s_add_u32 m0, m0, 8192
  s_add_u32 s49, s49, 8192
  buffer_load_dwordx4 v5, s[24:27], s49 offen sc1 lds
  s_add_u32 m0, m0, 8192
  s_add_u32 s49, s49, 8192
  v_cmp_eq_u32 vcc, 0, v3
  v_mov_b32 v10, s53
  s_waitcnt lgkmcnt(0)
  v_max3_f32 v240, v240, v241, v248
  v_max3_f32 v240, v240, v242, v243
  v_max3_f32 v240, v240, v249, v250
  v_max_f32 v240, v240, v251
  s_waitcnt vmcnt(3)
  v_cndmask_b32 v92, 0, v244, vcc
  v_cndmask_b32 v96, v244, 0, vcc
  v_dot2_f32_bf16 v242, v92, v92, 0
  v_dot2_f32_bf16 v242, v88, v88, v242
  v_dot2_f32_bf16 v242, v89, v89, v242
  v_dot2_f32_bf16 v242, v90, v90, v242
  v_dot2_f32_bf16 v242, v91, v91, v242
  v_mov_b32 v95, v92
  v_mov_b32 v99, v96
  s_nop 0
  v_mov_b32 v244, v242
  s_nop 1
  v_permlane32_swap_b32 v242, v244
  v_add_f32 v242, v242, v244
  v_mul_f32 v242, v242, v240
  v_sqrt_f32 v242, v242
attn_setm:
  v_mov_b32 v6, v13
  v_mov_b32 v7, v14
  v_mov_b32 v8, v15
  v_sub_f32 v64, 0, v242
  v_mov_b32 v16, 0
  v_sub_f32 v65, 0, v242
  v_mov_b32 v17, 0
  v_sub_f32 v66, 0, v242
  v_mov_b32 v18, 0
  v_sub_f32 v67, 0, v242
  v_mov_b32 v19, 0
  v_sub_f32 v68, 0, v242
  v_mov_b32 v20, 0
  v_sub_f32 v69, 0, v242
  v_mov_b32 v21, 0
  v_sub_f32 v70, 0, v242
  v_mov_b32 v22, 0
  v_sub_f32 v71, 0, v242
  v_mov_b32 v23, 0
  v_sub_f32 v72, 0, v242
  v_mov_b32 v24, 0
  v_sub_f32 v73, 0, v242
  v_mov_b32 v25, 0
  v_sub_f32 v74, 0, v242
  v_mov_b32 v26, 0
  v_sub_f32 v75, 0, v242
  v_mov_b32 v27, 0
  v_sub_f32 v76, 0, v242
  v_mov_b32 v28, 0
  v_sub_f32 v77, 0, v242
  v_mov_b32 v29, 0
  v_sub_f32 v78, 0, v242
  v_mov_b32 v30, 0
  v_sub_f32 v79, 0, v242
  v_mov_b32 v31, 0
  v_mov_b32 v84, 0
  v_mov_b32 v85, 0
  v_mov_b32 v86, 0
  v_mov_b32 v87, 0
  s_setprio 1
  s_mov_b32 s54, 0
  s_cmp_lg_u32 s48, 0
  s_cbranch_scc1 attn_nb
  s_waitcnt vmcnt(0)
  s_barrier
attn_nb:
  ds_read_b64 v[100:101], v7 offset:0
  ds_read_b128 v[104:107], v6 offset:0
  ds_read_b128 v[108:111], v6 offset:512
  s_mov_b64 exec, s[58:59]
  ds_read_b128 v[224:227], v8 offset:0
  ds_read_b128 v[228:231], v8 offset:576
  s_mov_b64 exec, -1
  s_waitcnt lgkmcnt(3)
  v_mfma_f32_32x32x8bf16_1k v[32:47], v[100:101], v[92:93], v[64:79]
  v_mfma_f32_32x32x16_bf16 v[32:47], v[104:107], v[88:91], v[32:47]
  s_waitcnt lgkmcnt(2)
  ds_read_b128 v[104:107], v6 offset:1024
  s_nop 7
  s_cbranch_scc1 attn_loop
  s_cmp_lt_u32 s40, 4
  s_nop 5
  s_cbranch_scc1 attn_nc
  v_mov_b32 v240, -1
  v_mov_b32 v241, -1
  v_mov_b32 v242, -1
  v_mov_b32 v243, -1
  buffer_store_dwordx4 v[240:243], v11, s[32:35], s51 offen sc1
  buffer_store_dword v240, v9, s[32:35], s52 offen sc1
attn_nc:
  v_mfma_f32_32x32x8bf16_1k v[48:63], v[100:101], v[94:95], v[64:79]
  v_exp_f32 v32, v32
  v_exp_f32 v33, v33
  v_exp_f32 v34, v34
  v_exp_f32 v35, v35
  v_mfma_f32_32x32x16_bf16 v[16:31], v[236:239], v[84:87], v[16:31]
  buffer_load_dwordx4 v5, s[24:27], s49 offen sc1 lds
  s_add_u32 m0, m0, 8192
  s_add_u32 s49, s49, 8192
  v_exp_f32 v36, v36
  v_exp_f32 v37, v37
  v_exp_f32 v38, v38
  v_exp_f32 v39, v39
  v_cvt_pk_bf16_f32 v80, v32, v33
  v_cvt_pk_bf16_f32 v81, v34, v35
  v_cvt_pk_bf16_f32 v82, v36, v37
  v_cvt_pk_bf16_f32 v83, v38, v39
  v_mfma_f32_32x32x16_bf16 v[48:63], v[108:111], v[88:91], v[48:63]
  buffer_load_dwordx4 v5, s[24:27], s49 offen sc1 lds
  s_add_u32 m0, m0, 8192
  s_add_u32 s49, s49, 8192
  v_exp_f32 v40, v40
  v_exp_f32 v41, v41
  v_exp_f32 v42, v42
  v_exp_f32 v43, v43
  s_waitcnt lgkmcnt(0)
  v_mfma_f32_32x32x16_bf16 v[16:31], v[224:227], v[80:83], v[16:31]
  s_mov_b64 exec, s[58:59]
  ds_read_b128 v[232:235], v8 offset:1152
  ds_read_b128 v[236:239], v8 offset:1728
  s_mov_b64 exec, -1
  ds_read_b128 v[108:111], v6 offset:1536
  buffer_load_dwordx4 v5, s[24:27], s49 offen sc1 lds
  s_add_u32 m0, m0, 8192
  s_add_u32 s49, s49, 8192
  v_exp_f32 v44, v44
  v_exp_f32 v45, v45
  v_exp_f32 v46, v46
  v_exp_f32 v47, v47
  v_cvt_pk_bf16_f32 v84, v40, v41
  v_cvt_pk_bf16_f32 v85, v42, v43
  v_cvt_pk_bf16_f32 v86, v44, v45
  v_cvt_pk_bf16_f32 v87, v46, v47
  v_mfma_f32_32x32x8bf16_1k v[32:47], v[100:101], v[96:97], v[64:79]
  v_exp_f32 v48, v48
  v_exp_f32 v49, v49
  v_exp_f32 v50, v50
  v_exp_f32 v51, v51
  v_mfma_f32_32x32x16_bf16 v[16:31], v[228:231], v[84:87], v[16:31]
  buffer_load_dwordx4 v5, s[24:27], s49 offen sc1 lds
  s_add_u32 m0, m0, 8192
  s_add_u32 s49, s49, 8192
  v_exp_f32 v52, v52
  v_exp_f32 v53, v53
  v_exp_f32 v54, v54
  v_exp_f32 v55, v55
  v_cvt_pk_bf16_f32 v80, v48, v49
  v_cvt_pk_bf16_f32 v81, v50, v51
  v_cvt_pk_bf16_f32 v82, v52, v53
  v_cvt_pk_bf16_f32 v83, v54, v55
  v_mfma_f32_32x32x16_bf16 v[32:47], v[104:107], v[88:91], v[32:47]
  buffer_load_dwordx4 v5, s[24:27], s49 offen sc1 lds
  s_add_u32 m0, m0, 8192
  s_add_u32 s49, s49, 8192
  v_exp_f32 v56, v56
  v_exp_f32 v57, v57
  v_exp_f32 v58, v58
  v_exp_f32 v59, v59
  s_waitcnt lgkmcnt(0)
  v_mfma_f32_32x32x16_bf16 v[16:31], v[232:235], v[80:83], v[16:31]
  s_mov_b64 exec, s[58:59]
  ds_read_b128 v[224:227], v8 offset:2304
  ds_read_b128 v[228:231], v8 offset:2880
  s_mov_b64 exec, -1
  ds_read_b128 v[104:107], v6 offset:9216
  ds_read_b64 v[102:103], v7 offset:9216
  buffer_load_dwordx4 v5, s[24:27], s49 offen sc1 lds
  s_add_u32 m0, m0, 8192
  s_add_u32 s49, s49, 8192
  v_exp_f32 v60, v60
  v_exp_f32 v61, v61
  v_exp_f32 v62, v62
  v_exp_f32 v63, v63
  v_cvt_pk_bf16_f32 v84, v56, v57
  v_cvt_pk_bf16_f32 v85, v58, v59
  v_cvt_pk_bf16_f32 v86, v60, v61
  v_cvt_pk_bf16_f32 v87, v62, v63
  v_mfma_f32_32x32x8bf16_1k v[48:63], v[100:101], v[98:99], v[64:79]
  v_exp_f32 v32, v32
  v_exp_f32 v33, v33
  v_exp_f32 v34, v34
  v_exp_f32 v35, v35
  v_mfma_f32_32x32x16_bf16 v[16:31], v[236:239], v[84:87], v[16:31]
  buffer_load_dwordx4 v5, s[24:27], s49 offen sc1 lds
  s_add_u32 m0, m0, 8192
  s_add_u32 s49, s49, 8192
  v_exp_f32 v36, v36
  v_exp_f32 v37, v37
  v_exp_f32 v38, v38
  v_exp_f32 v39, v39
  v_cvt_pk_bf16_f32 v80, v32, v33
  v_cvt_pk_bf16_f32 v81, v34, v35
  v_cvt_pk_bf16_f32 v82, v36, v37
  v_cvt_pk_bf16_f32 v83, v38, v39
  v_mfma_f32_32x32x16_bf16 v[48:63], v[108:111], v[88:91], v[48:63]
  buffer_load_dwordx4 v5, s[24:27], s49 offen sc1 lds
  s_add_u32 m0, m0, 8192
  s_add_u32 s49, s49, 8192
  v_exp_f32 v40, v40
  v_exp_f32 v41, v41
  v_exp_f32 v42, v42
  v_exp_f32 v43, v43
  s_waitcnt lgkmcnt(0)
  v_mfma_f32_32x32x16_bf16 v[16:31], v[224:227], v[80:83], v[16:31]
  s_mov_b64 exec, s[58:59]
  ds_read_b128 v[232:235], v8 offset:3456
  ds_read_b128 v[236:239], v8 offset:4032
  s_mov_b64 exec, -1
  ds_read_b128 v[108:111], v6 offset:9728
  buffer_load_dwordx4 v5, s[24:27], s49 offen sc1 lds
  s_add_u32 m0, m0, 8192
  s_add_u32 s49, s49, 8192
  v_exp_f32 v44, v44
  v_exp_f32 v45, v45
  v_exp_f32 v46, v46
  v_exp_f32 v47, v47
  v_cvt_pk_bf16_f32 v84, v40, v41
  v_cvt_pk_bf16_f32 v85, v42, v43
  v_cvt_pk_bf16_f32 v86, v44, v45
  v_cvt_pk_bf16_f32 v87, v46, v47
  v_mfma_f32_32x32x8bf16_1k v[32:47], v[102:103], v[92:93], v[64:79]
  v_exp_f32 v48, v48
  v_exp_f32 v49, v49
  v_exp_f32 v50, v50
  v_exp_f32 v51, v51
  v_mfma_f32_32x32x16_bf16 v[16:31], v[228:231], v[84:87], v[16:31]
  buffer_load_dwordx4 v5, s[24:27], s49 offen sc1 lds
  s_add_u32 m0, m0, 8192
  s_add_u32 s49, s49, 8192
  v_exp_f32 v52, v52
  v_exp_f32 v53, v53
  v_exp_f32 v54, v54
  v_exp_f32 v55, v55
  v_cvt_pk_bf16_f32 v80, v48, v49
  v_cvt_pk_bf16_f32 v81, v50, v51
  v_cvt_pk_bf16_f32 v82, v52, v53
  v_cvt_pk_bf16_f32 v83, v54, v55
  v_mfma_f32_32x32x16_bf16 v[32:47], v[104:107], v[88:91], v[32:47]
  buffer_load_dwordx4 v5, s[24:27], s49 offen sc1 lds
  s_add_u32 m0, m0, 8192
  s_add_u32 s49, s49, 8192
  v_exp_f32 v56, v56
  v_exp_f32 v57, v57
  v_exp_f32 v58, v58
  v_exp_f32 v59, v59
  s_waitcnt lgkmcnt(0)
  v_mfma_f32_32x32x16_bf16 v[16:31], v[232:235], v[80:83], v[16:31]
  s_mov_b64 exec, s[58:59]
  ds_read_b128 v[224:227], v8 offset:9216
  ds_read_b128 v[228:231], v8 offset:9792
  s_mov_b64 exec, -1
  ds_read_b128 v[104:107], v6 offset:10240
  buffer_load_dwordx4 v5, s[24:27], s49 offen sc1 lds
  s_add_u32 m0, m0, 8192
  s_add_u32 s49, s49, 8192
  v_exp_f32 v60, v60
  v_exp_f32 v61, v61
  v_exp_f32 v62, v62
  v_exp_f32 v63, v63
  v_cvt_pk_bf16_f32 v84, v56, v57
  v_cvt_pk_bf16_f32 v85, v58, v59
  v_cvt_pk_bf16_f32 v86, v60, v61
  v_cvt_pk_bf16_f32 v87, v62, v63
  v_mfma_f32_32x32x8bf16_1k v[48:63], v[102:103], v[94:95], v[64:79]
  v_exp_f32 v32, v32
  v_exp_f32 v33, v33
  v_exp_f32 v34, v34
  v_exp_f32 v35, v35
  v_mfma_f32_32x32x16_bf16 v[16:31], v[236:239], v[84:87], v[16:31]
  buffer_load_dwordx4 v5, s[24:27], s49 offen sc1 lds
  s_add_u32 m0, m0, 8192
  s_add_u32 s49, s49, 8192
  v_exp_f32 v36, v36
  v_exp_f32 v37, v37
  v_exp_f32 v38, v38
  v_exp_f32 v39, v39
  v_cvt_pk_bf16_f32 v80, v32, v33
  v_cvt_pk_bf16_f32 v81, v34, v35
  v_cvt_pk_bf16_f32 v82, v36, v37
  v_cvt_pk_bf16_f32 v83, v38, v39
  v_mfma_f32_32x32x16_bf16 v[48:63], v[108:111], v[88:91], v[48:63]
  buffer_load_dwordx4 v5, s[24:27], s49 offen sc1 lds
  s_add_u32 m0, m0, 8192
  s_add_u32 s49, s49, 8192
  v_exp_f32 v40, v40
  v_exp_f32 v41, v41
  v_exp_f32 v42, v42
  v_exp_f32 v43, v43
  s_waitcnt lgkmcnt(0)
  v_mfma_f32_32x32x16_bf16 v[16:31], v[224:227], v[80:83], v[16:31]
  s_mov_b64 exec, s[58:59]
  ds_read_b128 v[232:235], v8 offset:10368
  ds_read_b128 v[236:239], v8 offset:10944
  s_mov_b64 exec, -1
  ds_read_b128 v[108:111], v6 offset:10752
  buffer_load_dwordx4 v5, s[24:27], s49 offen sc1 lds
  s_add_u32 m0, m0, 8192
  s_add_u32 s49, s49, 8192
  v_exp_f32 v44, v44
  v_exp_f32 v45, v45
  v_exp_f32 v46, v46
  v_exp_f32 v47, v47
  v_cvt_pk_bf16_f32 v84, v40, v41
  v_cvt_pk_bf16_f32 v85, v42, v43
  v_cvt_pk_bf16_f32 v86, v44, v45
  v_cvt_pk_bf16_f32 v87, v46, v47
  v_mfma_f32_32x32x8bf16_1k v[32:47], v[102:103], v[96:97], v[64:79]
  v_exp_f32 v48, v48
  v_exp_f32 v49, v49
  v_exp_f32 v50, v50
  v_exp_f32 v51, v51
  v_mfma_f32_32x32x16_bf16 v[16:31], v[228:231], v[84:87], v[16:31]
  v_exp_f32 v52, v52
  v_exp_f32 v53, v53
  v_exp_f32 v54, v54
  v_exp_f32 v55, v55
  v_cvt_pk_bf16_f32 v80, v48, v49
  v_cvt_pk_bf16_f32 v81, v50, v51
  v_cvt_pk_bf16_f32 v82, v52, v53
  v_cvt_pk_bf16_f32 v83, v54, v55
  v_mfma_f32_32x32x16_bf16 v[32:47], v[104:107], v[88:91], v[32:47]
  v_exp_f32 v56, v56
  v_exp_f32 v57, v57
  v_exp_f32 v58, v58
  v_exp_f32 v59, v59
  s_waitcnt lgkmcnt(0)
  v_mfma_f32_32x32x16_bf16 v[16:31], v[232:235], v[80:83], v[16:31]
  s_mov_b64 exec, s[58:59]
  ds_read_b128 v[224:227], v8 offset:11520
  ds_read_b128 v[228:231], v8 offset:12096
  s_mov_b64 exec, -1
  ds_read_b128 v[104:107], v6 offset:18432
  ds_read_b64 v[100:101], v7 offset:18432
  v_exp_f32 v60, v60
  v_exp_f32 v61, v61
  v_exp_f32 v62, v62
  v_exp_f32 v63, v63
  v_cvt_pk_bf16_f32 v84, v56, v57
  v_cvt_pk_bf16_f32 v85, v58, v59
  v_cvt_pk_bf16_f32 v86, v60, v61
  v_cvt_pk_bf16_f32 v87, v62, v63
  v_mfma_f32_32x32x8bf16_1k v[48:63], v[102:103], v[98:99], v[64:79]
  v_exp_f32 v32, v32
  v_exp_f32 v33, v33
  v_exp_f32 v34, v34
  v_exp_f32 v35, v35
  v_mfma_f32_32x32x16_bf16 v[16:31], v[236:239], v[84:87], v[16:31]
  v_exp_f32 v36, v36
  v_exp_f32 v37, v37
  v_exp_f32 v38, v38
  v_exp_f32 v39, v39
  v_cvt_pk_bf16_f32 v80, v32, v33
  v_cvt_pk_bf16_f32 v81, v34, v35
  v_cvt_pk_bf16_f32 v82, v36, v37
  v_cvt_pk_bf16_f32 v83, v38, v39
  v_mfma_f32_32x32x16_bf16 v[48:63], v[108:111], v[88:91], v[48:63]
  v_exp_f32 v40, v40
  v_exp_f32 v41, v41
  v_exp_f32 v42, v42
  v_exp_f32 v43, v43
  s_waitcnt lgkmcnt(0)
  v_mfma_f32_32x32x16_bf16 v[16:31], v[224:227], v[80:83], v[16:31]
  s_mov_b64 exec, s[58:59]
  ds_read_b128 v[232:235], v8 offset:12672
  ds_read_b128 v[236:239], v8 offset:13248
  s_mov_b64 exec, -1
  ds_read_b128 v[108:111], v6 offset:18944
  v_exp_f32 v44, v44
  v_exp_f32 v45, v45
  v_exp_f32 v46, v46
  v_exp_f32 v47, v47
  v_cvt_pk_bf16_f32 v84, v40, v41
  v_cvt_pk_bf16_f32 v85, v42, v43
  v_cvt_pk_bf16_f32 v86, v44, v45
  v_cvt_pk_bf16_f32 v87, v46, v47
  v_mfma_f32_32x32x8bf16_1k v[32:47], v[100:101], v[92:93], v[64:79]
  v_exp_f32 v48, v48
  v_exp_f32 v49, v49
  v_exp_f32 v50, v50
  v_exp_f32 v51, v51
  v_mfma_f32_32x32x16_bf16 v[16:31], v[228:231], v[84:87], v[16:31]
  v_exp_f32 v52, v52
  v_exp_f32 v53, v53
  v_exp_f32 v54, v54
  v_exp_f32 v55, v55
  v_cvt_pk_bf16_f32 v80, v48, v49
  v_cvt_pk_bf16_f32 v81, v50, v51
  v_cvt_pk_bf16_f32 v82, v52, v53
  v_cvt_pk_bf16_f32 v83, v54, v55
  v_mfma_f32_32x32x16_bf16 v[32:47], v[104:107], v[88:91], v[32:47]
  v_exp_f32 v56, v56
  v_exp_f32 v57, v57
  v_exp_f32 v58, v58
  v_exp_f32 v59, v59
  s_waitcnt lgkmcnt(0)
  v_mfma_f32_32x32x16_bf16 v[16:31], v[232:235], v[80:83], v[16:31]
  s_mov_b64 exec, s[58:59]
  ds_read_b128 v[224:227], v8 offset:18432
  ds_read_b128 v[228:231], v8 offset:19008
  s_mov_b64 exec, -1
  ds_read_b128 v[104:107], v6 offset:19456
  v_exp_f32 v60, v60
  v_exp_f32 v61, v61
  v_exp_f32 v62, v62
  v_exp_f32 v63, v63
  v_cvt_pk_bf16_f32 v84, v56, v57
  v_cvt_pk_bf16_f32 v85, v58, v59
  v_cvt_pk_bf16_f32 v86, v60, v61
  v_cvt_pk_bf16_f32 v87, v62, v63
  v_add_u32 v6, 18432, v6
  v_add_u32 v7, 18432, v7
  v_add_u32 v8, 18432, v8
  s_mov_b32 s54, 1
  s_lshl_b32 s41, s40, 6
  s_max_u32 s41, s41, s2
  s_cmp_ge_u32 s40, 4
  s_cselect_b32 s41, s41, s2
  s_cmp_ge_u32 s41, 192
  s_waitcnt vmcnt(0)
  s_barrier
  s_cbranch_scc1 attn_loop
  s_lshl_b32 s41, s40, 3
  v_xor_b32 v12, s41, v2
  s_lshr_b32 s41, s2, 5
  s_mul_i32 s41, s41, 96
  v_mul_u32_u24 v4, 576, v3
  v_add_u32 v4, s41, v4
  s_cmp_lg_u32 s23, 0
  s_cbranch_scc1 attn_pf1
  v_add_lshl_u32 v12, v12, v4, 4
  s_mul_i32 s53, s40, 147456
  s_add_u32 s36, s10, 4718592
  s_addc_u32 s37, s11, 0
  s_mov_b32 s38, 663552
  s_mov_b32 s39, 0x20000
  buffer_load_dwordx4 v[112:115], v12, s[36:39], s53 offen offset:0 sc1
  buffer_load_dwordx4 v[116:119], v12, s[36:39], s53 offen offset:512 sc1
  buffer_load_dwordx4 v[120:123], v12, s[36:39], s53 offen offset:1024 sc1
  s_add_u32 s53, s53, 18432
  buffer_load_dwordx4 v[124:127], v12, s[36:39], s53 offen offset:0 sc1
  buffer_load_dwordx4 v[128:131], v12, s[36:39], s53 offen offset:512 sc1
  buffer_load_dwordx4 v[132:135], v12, s[36:39], s53 offen offset:1024 sc1
  s_add_u32 s53, s53, 18432
  buffer_load_dwordx4 v[136:139], v12, s[36:39], s53 offen offset:0 sc1
  buffer_load_dwordx4 v[140:143], v12, s[36:39], s53 offen offset:512 sc1
  buffer_load_dwordx4 v[144:147], v12, s[36:39], s53 offen offset:1024 sc1
  s_add_u32 s53, s53, 18432
  buffer_load_dwordx4 v[148:151], v12, s[36:39], s53 offen offset:0 sc1
  buffer_load_dwordx4 v[152:155], v12, s[36:39], s53 offen offset:512 sc1
  buffer_load_dwordx4 v[156:159], v12, s[36:39], s53 offen offset:1024 sc1
  s_add_u32 s53, s53, 18432
  buffer_load_dwordx4 v[160:163], v12, s[36:39], s53 offen offset:0 sc1
  buffer_load_dwordx4 v[164:167], v12, s[36:39], s53 offen offset:512 sc1
  buffer_load_dwordx4 v[168:171], v12, s[36:39], s53 offen offset:1024 sc1
  s_add_u32 s53, s53, 18432
  buffer_load_dwordx4 v[172:175], v12, s[36:39], s53 offen offset:0 sc1
  buffer_load_dwordx4 v[176:179], v12, s[36:39], s53 offen offset:512 sc1
  buffer_load_dwordx4 v[180:183], v12, s[36:39], s53 offen offset:1024 sc1
  s_add_u32 s53, s53, 18432
  buffer_load_dwordx4 v[184:187], v12, s[36:39], s53 offen offset:0 sc1
  buffer_load_dwordx4 v[188:191], v12, s[36:39], s53 offen offset:512 sc1
  buffer_load_dwordx4 v[192:195], v12, s[36:39], s53 offen offset:1024 sc1
  s_add_u32 s53, s53, 18432
  buffer_load_dwordx4 v[196:199], v12, s[36:39], s53 offen offset:0 sc1
  buffer_load_dwordx4 v[200:203], v12, s[36:39], s53 offen offset:512 sc1
  buffer_load_dwordx4 v[204:207], v12, s[36:39], s53 offen offset:1024 sc1
  s_add_u32 s53, s40, 32
  s_mul_i32 s53, s53, 18432
  buffer_load_dwordx4 v[208:211], v12, s[36:39], s53 offen offset:0 sc1
  buffer_load_dwordx4 v[212:215], v12, s[36:39], s53 offen offset:512 sc1
  buffer_load_dwordx4 v[216:219], v12, s[36:39], s53 offen offset:1024 sc1
  s_cmp_lg_u32 s40, 0
  s_cbranch_scc1 attn_pfx
  v_mov_b32 v252, -1
  v_mov_b32 v253, -1
  v_mov_b32 v254, -1
  v_mov_b32 v255, -1
  s_lshr_b32 s41, s2, 5
  s_mul_i32 s53, s41, 393216
  s_lshl_b32 s42, s46, 9
  s_add_u32 s53, s53, s42
  s_add_u32 s53, s53, 65536
  s_lshl_b32 s41, s41, 13
  s_lshl_b32 s42, s46, 8
  s_add_u32 s41, s41, s42
  v_lshlrev_b32 v4, 4, v2
  v_lshl_add_u32 v4, v3, 14, v4
  s_add_u32 s36, s20, 14221312
  s_addc_u32 s37, s21, 0
  s_mov_b32 s38, 2424832
  s_mov_b32 s39, 0x20000
  buffer_store_dwordx4 v[252:255], v4, s[36:39], s53 offen sc1
  s_add_u32 s53, s53, 32768
  buffer_store_dwordx4 v[252:255], v4, s[36:39], s53 offen sc1
  s_add_u32 s53, s53, 32768
  buffer_store_dwordx4 v[252:255], v4, s[36:39], s53 offen sc1
  s_add_u32 s53, s53, 32768
  buffer_store_dwordx4 v[252:255], v4, s[36:39], s53 offen sc1
  s_add_u32 s53, s53, 32768
  buffer_store_dwordx4 v[252:255], v4, s[36:39], s53 offen sc1
  s_add_u32 s53, s53, 32768
  buffer_store_dwordx4 v[252:255], v4, s[36:39], s53 offen sc1
  s_add_u32 s53, s53, 32768
  buffer_store_dwordx4 v[252:255], v4, s[36:39], s53 offen sc1
  s_add_u32 s53, s53, 32768
  buffer_store_dwordx4 v[252:255], v4, s[36:39], s53 offen sc1
  s_add_u32 s53, s53, 32768
  buffer_store_dwordx4 v[252:255], v4, s[36:39], s53 offen sc1
  s_add_u32 s53, s53, 32768
  buffer_store_dwordx4 v[252:255], v4, s[36:39], s53 offen sc1
  s_add_u32 s53, s53, 32768
  buffer_store_dwordx4 v[252:255], v4, s[36:39], s53 offen sc1
  s_add_u32 s53, s53, 32768
  buffer_store_dwordx4 v[252:255], v4, s[36:39], s53 offen sc1
  s_mov_b64 exec, 0xffff
  buffer_store_dwordx4 v[252:255], v4, s[36:39], s41 offen sc1
  s_mov_b64 exec, -1
  s_branch attn_pfx
attn_pf1:
  v_and_or_b32 v4, v12, 3, v4
  v_lshrrev_b32 v12, 2, v12
  v_mul_u32_u24 v12, 12, v12
  v_add_lshl_u32 v12, v12, v4, 4
  s_mul_i32 s53, s40, 165888
  s_getpc_b64 s[36:37]
  s_add_u32 s36, s36, T2@rel32@lo+4
  s_addc_u32 s37, s37, T2@rel32@hi+12
  s_mov_b32 s38, 663552
  s_mov_b32 s39, 0x20000
  buffer_load_dwordx4 v[112:115], v12, s[36:39], s53 offen offset:0
  buffer_load_dwordx4 v[116:119], v12, s[36:39], s53 offen offset:64
  buffer_load_dwordx4 v[120:123], v12, s[36:39], s53 offen offset:128
  s_add_u32 s53, s53, 18432
  buffer_load_dwordx4 v[124:127], v12, s[36:39], s53 offen offset:0
  buffer_load_dwordx4 v[128:131], v12, s[36:39], s53 offen offset:64
  buffer_load_dwordx4 v[132:135], v12, s[36:39], s53 offen offset:128
  s_add_u32 s53, s53, 18432
  buffer_load_dwordx4 v[136:139], v12, s[36:39], s53 offen offset:0
  buffer_load_dwordx4 v[140:143], v12, s[36:39], s53 offen offset:64
  buffer_load_dwordx4 v[144:147], v12, s[36:39], s53 offen offset:128
  s_add_u32 s53, s53, 18432
  buffer_load_dwordx4 v[148:151], v12, s[36:39], s53 offen offset:0
  buffer_load_dwordx4 v[152:155], v12, s[36:39], s53 offen offset:64
  buffer_load_dwordx4 v[156:159], v12, s[36:39], s53 offen offset:128
  s_add_u32 s53, s53, 18432
  buffer_load_dwordx4 v[160:163], v12, s[36:39], s53 offen offset:0
  buffer_load_dwordx4 v[164:167], v12, s[36:39], s53 offen offset:64
  buffer_load_dwordx4 v[168:171], v12, s[36:39], s53 offen offset:128
  s_add_u32 s53, s53, 18432
  buffer_load_dwordx4 v[172:175], v12, s[36:39], s53 offen offset:0
  buffer_load_dwordx4 v[176:179], v12, s[36:39], s53 offen offset:64
  buffer_load_dwordx4 v[180:183], v12, s[36:39], s53 offen offset:128
  s_add_u32 s53, s53, 18432
  buffer_load_dwordx4 v[184:187], v12, s[36:39], s53 offen offset:0
  buffer_load_dwordx4 v[188:191], v12, s[36:39], s53 offen offset:64
  buffer_load_dwordx4 v[192:195], v12, s[36:39], s53 offen offset:128
  s_add_u32 s53, s53, 18432
  buffer_load_dwordx4 v[196:199], v12, s[36:39], s53 offen offset:0
  buffer_load_dwordx4 v[200:203], v12, s[36:39], s53 offen offset:64
  buffer_load_dwordx4 v[204:207], v12, s[36:39], s53 offen offset:128
  s_add_u32 s53, s53, 18432
  buffer_load_dwordx4 v[208:211], v12, s[36:39], s53 offen offset:0
  buffer_load_dwordx4 v[212:215], v12, s[36:39], s53 offen offset:64
  buffer_load_dwordx4 v[216:219], v12, s[36:39], s53 offen offset:128
attn_pfx:
attn_loop:
  v_mfma_f32_32x32x8bf16_1k v[48:63], v[100:101], v[94:95], v[64:79]
  v_exp_f32 v32, v32
  v_exp_f32 v33, v33
  v_exp_f32 v34, v34
  v_exp_f32 v35, v35
  v_mfma_f32_32x32x16_bf16 v[16:31], v[236:239], v[84:87], v[16:31]
  v_exp_f32 v36, v36
  v_exp_f32 v37, v37
  v_exp_f32 v38, v38
  v_exp_f32 v39, v39
  v_cvt_pk_bf16_f32 v80, v32, v33
  v_cvt_pk_bf16_f32 v81, v34, v35
  v_cvt_pk_bf16_f32 v82, v36, v37
  v_cvt_pk_bf16_f32 v83, v38, v39
  v_mfma_f32_32x32x16_bf16 v[48:63], v[108:111], v[88:91], v[48:63]
  v_exp_f32 v40, v40
  v_exp_f32 v41, v41
  v_exp_f32 v42, v42
  v_exp_f32 v43, v43
  s_waitcnt lgkmcnt(0)
  v_mfma_f32_32x32x16_bf16 v[16:31], v[224:227], v[80:83], v[16:31]
  s_mov_b64 exec, s[58:59]
  ds_read_b128 v[232:235], v8 offset:1152
  ds_read_b128 v[236:239], v8 offset:1728
  s_mov_b64 exec, -1
  ds_read_b128 v[108:111], v6 offset:1536
  v_exp_f32 v44, v44
  v_exp_f32 v45, v45
  v_exp_f32 v46, v46
  v_exp_f32 v47, v47
  v_cvt_pk_bf16_f32 v84, v40, v41
  v_cvt_pk_bf16_f32 v85, v42, v43
  v_cvt_pk_bf16_f32 v86, v44, v45
  v_cvt_pk_bf16_f32 v87, v46, v47
  v_mfma_f32_32x32x8bf16_1k v[32:47], v[100:101], v[96:97], v[64:79]
  v_exp_f32 v48, v48
  v_exp_f32 v49, v49
  v_exp_f32 v50, v50
  v_exp_f32 v51, v51
  v_mfma_f32_32x32x16_bf16 v[16:31], v[228:231], v[84:87], v[16:31]
  v_exp_f32 v52, v52
  v_exp_f32 v53, v53
  v_exp_f32 v54, v54
  v_exp_f32 v55, v55
  v_cvt_pk_bf16_f32 v80, v48, v49
  v_cvt_pk_bf16_f32 v81, v50, v51
  v_cvt_pk_bf16_f32 v82, v52, v53
  v_cvt_pk_bf16_f32 v83, v54, v55
  v_mfma_f32_32x32x16_bf16 v[32:47], v[104:107], v[88:91], v[32:47]
  v_exp_f32 v56, v56
  v_exp_f32 v57, v57
  v_exp_f32 v58, v58
  v_exp_f32 v59, v59
  s_waitcnt lgkmcnt(0)
  v_mfma_f32_32x32x16_bf16 v[16:31], v[232:235], v[80:83], v[16:31]
  s_mov_b64 exec, s[58:59]
  ds_read_b128 v[224:227], v8 offset:2304
  ds_read_b128 v[228:231], v8 offset:2880
  s_mov_b64 exec, -1
  ds_read_b128 v[104:107], v6 offset:9216
  ds_read_b64 v[102:103], v7 offset:9216
  v_exp_f32 v60, v60
  v_exp_f32 v61, v61
  v_exp_f32 v62, v62
  v_exp_f32 v63, v63
  v_cvt_pk_bf16_f32 v84, v56, v57
  v_cvt_pk_bf16_f32 v85, v58, v59
  v_cvt_pk_bf16_f32 v86, v60, v61
  v_cvt_pk_bf16_f32 v87, v62, v63
  v_mfma_f32_32x32x8bf16_1k v[48:63], v[100:101], v[98:99], v[64:79]
  v_exp_f32 v32, v32
  v_exp_f32 v33, v33
  v_exp_f32 v34, v34
  v_exp_f32 v35, v35
  v_mfma_f32_32x32x16_bf16 v[16:31], v[236:239], v[84:87], v[16:31]
  v_exp_f32 v36, v36
  v_exp_f32 v37, v37
  v_exp_f32 v38, v38
  v_exp_f32 v39, v39
  v_cvt_pk_bf16_f32 v80, v32, v33
  v_cvt_pk_bf16_f32 v81, v34, v35
  v_cvt_pk_bf16_f32 v82, v36, v37
  v_cvt_pk_bf16_f32 v83, v38, v39
  v_mfma_f32_32x32x16_bf16 v[48:63], v[108:111], v[88:91], v[48:63]
  v_exp_f32 v40, v40
  v_exp_f32 v41, v41
  v_exp_f32 v42, v42
  v_exp_f32 v43, v43
  s_waitcnt lgkmcnt(0)
  v_mfma_f32_32x32x16_bf16 v[16:31], v[224:227], v[80:83], v[16:31]
  s_mov_b64 exec, s[58:59]
  ds_read_b128 v[232:235], v8 offset:3456
  ds_read_b128 v[236:239], v8 offset:4032
  s_mov_b64 exec, -1
  ds_read_b128 v[108:111], v6 offset:9728
  v_exp_f32 v44, v44
  v_exp_f32 v45, v45
  v_exp_f32 v46, v46
  v_exp_f32 v47, v47
  v_cvt_pk_bf16_f32 v84, v40, v41
  v_cvt_pk_bf16_f32 v85, v42, v43
  v_cvt_pk_bf16_f32 v86, v44, v45
  v_cvt_pk_bf16_f32 v87, v46, v47
  v_mfma_f32_32x32x8bf16_1k v[32:47], v[102:103], v[92:93], v[64:79]
  v_exp_f32 v48, v48
  v_exp_f32 v49, v49
  v_exp_f32 v50, v50
  v_exp_f32 v51, v51
  v_mfma_f32_32x32x16_bf16 v[16:31], v[228:231], v[84:87], v[16:31]
  v_exp_f32 v52, v52
  v_exp_f32 v53, v53
  v_exp_f32 v54, v54
  v_exp_f32 v55, v55
  v_cvt_pk_bf16_f32 v80, v48, v49
  v_cvt_pk_bf16_f32 v81, v50, v51
  v_cvt_pk_bf16_f32 v82, v52, v53
  v_cvt_pk_bf16_f32 v83, v54, v55
  v_mfma_f32_32x32x16_bf16 v[32:47], v[104:107], v[88:91], v[32:47]
  v_exp_f32 v56, v56
  v_exp_f32 v57, v57
  v_exp_f32 v58, v58
  v_exp_f32 v59, v59
  s_waitcnt lgkmcnt(0)
  v_mfma_f32_32x32x16_bf16 v[16:31], v[232:235], v[80:83], v[16:31]
  s_mov_b64 exec, s[58:59]
  ds_read_b128 v[224:227], v8 offset:9216
  ds_read_b128 v[228:231], v8 offset:9792
  s_mov_b64 exec, -1
  ds_read_b128 v[104:107], v6 offset:10240
  v_exp_f32 v60, v60
  v_exp_f32 v61, v61
  v_exp_f32 v62, v62
  v_exp_f32 v63, v63
  v_cvt_pk_bf16_f32 v84, v56, v57
  v_cvt_pk_bf16_f32 v85, v58, v59
  v_cvt_pk_bf16_f32 v86, v60, v61
  v_cvt_pk_bf16_f32 v87, v62, v63
  v_mfma_f32_32x32x8bf16_1k v[48:63], v[102:103], v[94:95], v[64:79]
  v_exp_f32 v32, v32
  v_exp_f32 v33, v33
  v_exp_f32 v34, v34
  v_exp_f32 v35, v35
  v_mfma_f32_32x32x16_bf16 v[16:31], v[236:239], v[84:87], v[16:31]
  v_exp_f32 v36, v36
  v_exp_f32 v37, v37
  v_exp_f32 v38, v38
  v_exp_f32 v39, v39
  v_cvt_pk_bf16_f32 v80, v32, v33
  v_cvt_pk_bf16_f32 v81, v34, v35
  v_cvt_pk_bf16_f32 v82, v36, v37
  v_cvt_pk_bf16_f32 v83, v38, v39
  v_mfma_f32_32x32x16_bf16 v[48:63], v[108:111], v[88:91], v[48:63]
  v_exp_f32 v40, v40
  v_exp_f32 v41, v41
  v_exp_f32 v42, v42
  v_exp_f32 v43, v43
  s_waitcnt lgkmcnt(0)
  v_mfma_f32_32x32x16_bf16 v[16:31], v[224:227], v[80:83], v[16:31]
  s_mov_b64 exec, s[58:59]
  ds_read_b128 v[232:235], v8 offset:10368
  ds_read_b128 v[236:239], v8 offset:10944
  s_mov_b64 exec, -1
  ds_read_b128 v[108:111], v6 offset:10752
  v_exp_f32 v44, v44
  v_exp_f32 v45, v45
  v_exp_f32 v46, v46
  v_exp_f32 v47, v47
  v_cvt_pk_bf16_f32 v84, v40, v41
  v_cvt_pk_bf16_f32 v85, v42, v43
  v_cvt_pk_bf16_f32 v86, v44, v45
  v_cvt_pk_bf16_f32 v87, v46, v47
  v_mfma_f32_32x32x8bf16_1k v[32:47], v[102:103], v[96:97], v[64:79]
  v_exp_f32 v48, v48
  v_exp_f32 v49, v49
  v_exp_f32 v50, v50
  v_exp_f32 v51, v51
  v_mfma_f32_32x32x16_bf16 v[16:31], v[228:231], v[84:87], v[16:31]
  v_exp_f32 v52, v52
  v_exp_f32 v53, v53
  v_exp_f32 v54, v54
  v_exp_f32 v55, v55
  v_cvt_pk_bf16_f32 v80, v48, v49
  v_cvt_pk_bf16_f32 v81, v50, v51
  v_cvt_pk_bf16_f32 v82, v52, v53
  v_cvt_pk_bf16_f32 v83, v54, v55
  v_mfma_f32_32x32x16_bf16 v[32:47], v[104:107], v[88:91], v[32:47]
  v_exp_f32 v56, v56
  v_exp_f32 v57, v57
  v_exp_f32 v58, v58
  v_exp_f32 v59, v59
  s_waitcnt lgkmcnt(0)
  v_mfma_f32_32x32x16_bf16 v[16:31], v[232:235], v[80:83], v[16:31]
  s_mov_b64 exec, s[58:59]
  ds_read_b128 v[224:227], v8 offset:11520
  ds_read_b128 v[228:231], v8 offset:12096
  s_mov_b64 exec, -1
  ds_read_b128 v[104:107], v6 offset:18432
  ds_read_b64 v[100:101], v7 offset:18432
  v_exp_f32 v60, v60
  v_exp_f32 v61, v61
  v_exp_f32 v62, v62
  v_exp_f32 v63, v63
  v_cvt_pk_bf16_f32 v84, v56, v57
  v_cvt_pk_bf16_f32 v85, v58, v59
  v_cvt_pk_bf16_f32 v86, v60, v61
  v_cvt_pk_bf16_f32 v87, v62, v63
  v_mfma_f32_32x32x8bf16_1k v[48:63], v[102:103], v[98:99], v[64:79]
  v_exp_f32 v32, v32
  v_exp_f32 v33, v33
  v_exp_f32 v34, v34
  v_exp_f32 v35, v35
  v_mfma_f32_32x32x16_bf16 v[16:31], v[236:239], v[84:87], v[16:31]
  v_exp_f32 v36, v36
  v_exp_f32 v37, v37
  v_exp_f32 v38, v38
  v_exp_f32 v39, v39
  v_cvt_pk_bf16_f32 v80, v32, v33
  v_cvt_pk_bf16_f32 v81, v34, v35
  v_cvt_pk_bf16_f32 v82, v36, v37
  v_cvt_pk_bf16_f32 v83, v38, v39
  v_mfma_f32_32x32x16_bf16 v[48:63], v[108:111], v[88:91], v[48:63]
  v_exp_f32 v40, v40
  v_exp_f32 v41, v41
  v_exp_f32 v42, v42
  v_exp_f32 v43, v43
  s_waitcnt lgkmcnt(0)
  v_mfma_f32_32x32x16_bf16 v[16:31], v[224:227], v[80:83], v[16:31]
  s_mov_b64 exec, s[58:59]
  ds_read_b128 v[232:235], v8 offset:12672
  ds_read_b128 v[236:239], v8 offset:13248
  s_mov_b64 exec, -1
  ds_read_b128 v[108:111], v6 offset:18944
  v_exp_f32 v44, v44
  v_exp_f32 v45, v45
  v_exp_f32 v46, v46
  v_exp_f32 v47, v47
  v_cvt_pk_bf16_f32 v84, v40, v41
  v_cvt_pk_bf16_f32 v85, v42, v43
  v_cvt_pk_bf16_f32 v86, v44, v45
  v_cvt_pk_bf16_f32 v87, v46, v47
  v_mfma_f32_32x32x8bf16_1k v[32:47], v[100:101], v[92:93], v[64:79]
  v_exp_f32 v48, v48
  v_exp_f32 v49, v49
  v_exp_f32 v50, v50
  v_exp_f32 v51, v51
  v_mfma_f32_32x32x16_bf16 v[16:31], v[228:231], v[84:87], v[16:31]
  v_exp_f32 v52, v52
  v_exp_f32 v53, v53
  v_exp_f32 v54, v54
  v_exp_f32 v55, v55
  v_cvt_pk_bf16_f32 v80, v48, v49
  v_cvt_pk_bf16_f32 v81, v50, v51
  v_cvt_pk_bf16_f32 v82, v52, v53
  v_cvt_pk_bf16_f32 v83, v54, v55
  v_mfma_f32_32x32x16_bf16 v[32:47], v[104:107], v[88:91], v[32:47]
  v_exp_f32 v56, v56
  v_exp_f32 v57, v57
  v_exp_f32 v58, v58
  v_exp_f32 v59, v59
  s_waitcnt lgkmcnt(0)
  v_mfma_f32_32x32x16_bf16 v[16:31], v[232:235], v[80:83], v[16:31]
  s_mov_b64 exec, s[58:59]
  ds_read_b128 v[224:227], v8 offset:18432
  ds_read_b128 v[228:231], v8 offset:19008
  s_mov_b64 exec, -1
  ds_read_b128 v[104:107], v6 offset:19456
  v_exp_f32 v60, v60
  v_exp_f32 v61, v61
  v_exp_f32 v62, v62
  v_exp_f32 v63, v63
  v_cvt_pk_bf16_f32 v84, v56, v57
  v_cvt_pk_bf16_f32 v85, v58, v59
  v_cvt_pk_bf16_f32 v86, v60, v61
  v_cvt_pk_bf16_f32 v87, v62, v63
  v_add_u32 v6, 18432, v6
  v_add_u32 v7, 18432, v7
  v_add_u32 v8, 18432, v8
  s_add_u32 s54, s54, 1
  s_cmp_eq_u32 s54, 4
  s_cbranch_scc1 attn_prg
  s_cmp_lt_u32 s54, 8
  s_cbranch_scc1 attn_loop
  v_mfma_f32_32x32x16_bf16 v[16:31], v[236:239], v[84:87], v[16:31]
  v_mov_b32 v240, 0x21800000
  s_waitcnt lgkmcnt(0)
  s_cmp_lg_u32 s48, 0
  s_nop 8
  v_cmp_nge_f32 vcc, v26, v240
  v_rcp_f32 v240, v26
  s_cbranch_scc1 attn_fin
  s_cbranch_vccnz attn_fallback
attn_fin:
  ds_write_b32 v10, v10
  v_pk_mul_f32 v[16:17], v[16:17], v[240:241] op_sel_hi:[1,0]
  v_cvt_pk_bf16_f32 v80, v16, v17
  v_pk_mul_f32 v[18:19], v[18:19], v[240:241] op_sel_hi:[1,0]
  v_cvt_pk_bf16_f32 v81, v18, v19
  v_pk_mul_f32 v[20:21], v[20:21], v[240:241] op_sel_hi:[1,0]
  v_cvt_pk_bf16_f32 v82, v20, v21
  v_pk_mul_f32 v[22:23], v[22:23], v[240:241] op_sel_hi:[1,0]
  v_cvt_pk_bf16_f32 v83, v22, v23
  v_pk_mul_f32 v[24:25], v[24:25], v[240:241] op_sel_hi:[1,0]
  v_cvt_pk_bf16_f32 v84, v24, v25
  buffer_store_dwordx4 v[80:83], v11, s[32:35], s51 offen sc1
  s_mov_b32 exec_hi, 0
  buffer_store_dword v84, v9, s[32:35], s52 offen sc1
  s_cmp_ge_u32 s40, 4
  s_cbranch_scc1 attn_end
  v_mov_b32 v4, s100
  v_mov_b32 v5, s101
  s_lshl_b32 s43, s43, 7
  s_add_u32 s43, s43, s65
  s_mov_b64 exec, 1
  s_waitcnt vmcnt(0)
  buffer_store_dwordx2 v[4:5], off, s[68:71], s43 sc1
  s_mov_b64 exec, -1
attn_end:
  s_mov_b32 s40, s22
  s_mov_b64 exec, -1
  s_setprio 0
  s_cmp_lg_u32 s23, 0
  s_cbranch_scc1 k_last
  s_and_b32 s40, s40, 3
  s_cmp_ge_u32 s2, 192
  s_cbranch_scc1 p4_idle
  s_cmp_lt_u32 s22, 4
  s_cbranch_scc1 p4_se
  s_barrier
p4_se:
  s_add_u32 s28, s20, 2424832
  s_addc_u32 s29, s21, 0
  s_mov_b32 s30, 2359296
  s_mov_b32 s31, 0x20000
  s_and_b32 s46, s2, 7
  s_lshl_b32 s46, s46, 2
  s_bfe_u32 s41, s2, 0x20003
  s_add_u32 s46, s46, s41
  s_lshr_b32 s47, s2, 5
  s_mul_i32 s41, s47, 393216
  s_lshl_b32 s42, s40, 15
  s_add_u32 s41, s41, s42
  s_lshl_b32 s42, s46, 9
  s_add_u32 s41, s41, s42
  v_lshlrev_b32 v9, 14, v3
  v_lshl_add_u32 v9, v2, 3, v9
  v_add_u32 v9, s41, v9
  s_mov_b32 s48, 131072
  s_mov_b32 s49, 262144
  s_or_b32 s41, s47, s40
  v_or_b32 v4, s41, v3
  v_cmp_eq_u32 vcc, 0, v4
  v_mov_b32 v13, 0xffff
  s_nop 0
  v_cndmask_b32 v13, -1, v13, vcc
  s_xor_b32 s41, s22, 4
  s_lshl_b32 s41, s41, 7
  s_add_u32 s41, s41, 161280
  v_lshl_add_u32 v14, v2, 2, s41
  s_add_u32 s24, s20, 14286848
  s_addc_u32 s25, s21, 0
  s_mov_b32 s26, 2359296
  s_mov_b32 s27, 0x20000
  v_lshlrev_b32 v15, 4, v1
  s_cmp_lt_u32 s22, 4
  s_cbranch_scc1 p4_early
  s_mul_i32 s41, s40, 12288
  s_add_u32 s41, s41, 75264
  v_add_u32 v8, s41, v15
  v_and_b32 v4, 1, v2
  v_mul_u32_u24 v4, 131064, v4
  v_add_u32 v9, v9, v4
  s_mov_b32 s54, 0x55555555
  s_mov_b32 s55, s54
  s_barrier
  ds_read_b128 v[16:19], v8 offset:0
  ds_read_b128 v[20:23], v8 offset:3072
  ds_read_b128 v[24:27], v8 offset:6144
  ds_read_b128 v[28:31], v8 offset:9216
  ds_read_b128 v[32:35], v8 offset:1024
  ds_read_b128 v[36:39], v8 offset:4096
  ds_read_b128 v[40:43], v8 offset:7168
  ds_read_b128 v[44:47], v8 offset:10240
  ds_read_b128 v[48:51], v8 offset:2048
  ds_read_b128 v[52:55], v8 offset:5120
  ds_read_b128 v[56:59], v8 offset:8192
  ds_read_b128 v[60:63], v8 offset:11264
  s_waitcnt lgkmcnt(8)
  v_pk_add_f32 v[16:17], v[16:17], v[20:21]
  v_pk_add_f32 v[24:25], v[24:25], v[28:29]
  v_pk_add_f32 v[18:19], v[18:19], v[22:23]
  v_pk_add_f32 v[26:27], v[26:27], v[30:31]
  v_pk_add_f32 v[16:17], v[16:17], v[24:25]
  v_pk_add_f32 v[18:19], v[18:19], v[26:27]
  v_cvt_pk_bf16_f32 v240, v16, v17
  v_cvt_pk_bf16_f32 v241, v18, v19
  s_waitcnt lgkmcnt(4)
  v_pk_add_f32 v[32:33], v[32:33], v[36:37]
  v_pk_add_f32 v[40:41], v[40:41], v[44:45]
  v_pk_add_f32 v[34:35], v[34:35], v[38:39]
  v_pk_add_f32 v[42:43], v[42:43], v[46:47]
  v_pk_add_f32 v[32:33], v[32:33], v[40:41]
  v_pk_add_f32 v[34:35], v[34:35], v[42:43]
  v_cvt_pk_bf16_f32 v242, v32, v33
  v_cvt_pk_bf16_f32 v243, v34, v35
  s_mov_b64 vcc, s[54:55]
  v_cndmask_b32_dpp v220, v242, v240, vcc quad_perm:[1,0,3,2] row_mask:0xf bank_mask:0xf
  v_cndmask_b32_dpp v221, v243, v241, vcc quad_perm:[1,0,3,2] row_mask:0xf bank_mask:0xf
  s_not_b64 vcc, vcc
  v_cndmask_b32_dpp v222, v240, v242, vcc quad_perm:[1,0,3,2] row_mask:0xf bank_mask:0xf
  v_cndmask_b32_dpp v223, v241, v243, vcc quad_perm:[1,0,3,2] row_mask:0xf bank_mask:0xf
  buffer_store_dwordx4 v[220:223], v9, s[24:27], 0 offen offset:0 sc1
  s_waitcnt lgkmcnt(0)
  v_pk_add_f32 v[48:49], v[48:49], v[52:53]
  v_pk_add_f32 v[56:57], v[56:57], v[60:61]
  v_pk_add_f32 v[50:51], v[50:51], v[54:55]
  v_pk_add_f32 v[58:59], v[58:59], v[62:63]
  v_pk_add_f32 v[48:49], v[48:49], v[56:57]
  v_pk_add_f32 v[50:51], v[50:51], v[58:59]
  v_cvt_pk_bf16_f32 v244, v48, v49
  v_cvt_pk_bf16_f32 v245, v50, v51
  s_nop 0
  v_mov_b32_dpp v246, v244 quad_perm:[1,0,3,2] row_mask:0xf bank_mask:0xf
  v_mov_b32_dpp v247, v245 quad_perm:[1,0,3,2] row_mask:0xf bank_mask:0xf
  s_mov_b64 exec, s[54:55]
  buffer_store_dwordx4 v[244:247], v9, s[24:27], s49 offen offset:0 sc1
  s_mov_b64 exec, -1
  v_and_b32 v248, v13, v240
  v_dot2_f32_bf16 v249, v241, v241, 0
  v_dot2_f32_bf16 v248, v248, v248, 0
  v_dot2_f32_bf16 v248, v242, v242, v248
  v_dot2_f32_bf16 v249, v243, v243, v249
  v_dot2_f32_bf16 v248, v244, v244, v248
  v_dot2_f32_bf16 v249, v245, v245, v249
  s_nop 2
  v_add_f32 v248, v248, v249
  v_mov_b32 v249, v248
  s_nop 1
  v_permlane32_swap_b32 v248, v249
  v_add_f32 v248, v248, v249
  ds_write_b32 v14, v248
  s_branch p4_end
p4_idle:
  s_cmp_ge_u32 s22, 4
  s_cbranch_scc1 p4_bar
  v_and_b32 v4, 7, v1
  v_lshlrev_b32 v4, 2, v4
  v_add_u32 v4, 0x20000, v4
p4i_pw:
  ds_read_b32 v252, v4 offset:31744
  s_waitcnt lgkmcnt(0)
  v_cmp_eq_u32 vcc, 0, v252
  s_cbranch_vccz p4i_px
  s_sleep 4
  s_branch p4i_pw
p4i_px:
  s_mov_b64 exec, s[94:95]
  s_add_u32 m0, s96, 0
  s_nop 0
  buffer_load_dwordx4 v220, s[60:63], s64 offen sc1 lds
  s_add_u32 s64, s64, 55296
  s_add_u32 m0, s96, 3456
  s_nop 0
  buffer_load_dwordx4 v220, s[60:63], s64 offen sc1 lds
  s_add_u32 s64, s64, 55296
  s_add_u32 m0, s96, 6912
  s_nop 0
  buffer_load_dwordx4 v220, s[60:63], s64 offen sc1 lds
  s_add_u32 s64, s64, 55296
  s_add_u32 m0, s96, 10368
  s_nop 0
  buffer_load_dwordx4 v220, s[60:63], s64 offen sc1 lds
  s_add_u32 s64, s64, 55296
  s_add_u32 m0, s96, 13824
  s_nop 0
  buffer_load_dwordx4 v220, s[60:63], s64 offen sc1 lds
  s_add_u32 s64, s64, 55296
  s_add_u32 m0, s96, 17280
  s_nop 0
  buffer_load_dwordx4 v220, s[60:63], s64 offen sc1 lds
  s_add_u32 s64, s64, 55296
  s_add_u32 m0, s96, 20736
  s_nop 0
  buffer_load_dwordx4 v220, s[60:63], s64 offen sc1 lds
  s_add_u32 s64, s64, 55296
  s_add_u32 m0, s96, 24192
  s_nop 0
  buffer_load_dwordx4 v220, s[60:63], s64 offen sc1 lds
  s_add_u32 s64, s64, 55296
  s_add_u32 m0, s96, 27648
  s_nop 0
  buffer_load_dwordx4 v220, s[60:63], s64 offen sc1 lds
  s_add_u32 s64, s64, 55296
  s_add_u32 m0, s96, 31104
  s_nop 0
  buffer_load_dwordx4 v220, s[60:63], s64 offen sc1 lds
  s_add_u32 s64, s64, 55296
  s_add_u32 m0, s96, 34560
  s_nop 0
  buffer_load_dwordx4 v220, s[60:63], s64 offen sc1 lds
  s_add_u32 s64, s64, 55296
  s_add_u32 m0, s96, 38016
  s_nop 0
  buffer_load_dwordx4 v220, s[60:63], s64 offen sc1 lds
  s_add_u32 s64, s64, 55296
  s_add_u32 m0, s96, 41472
  s_nop 0
  buffer_load_dwordx4 v220, s[60:63], s64 offen sc1 lds
  s_add_u32 s64, s64, 55296
  s_add_u32 m0, s96, 44928
  s_nop 0
  buffer_load_dwordx4 v220, s[60:63], s64 offen sc1 lds
  s_add_u32 s64, s64, 55296
  s_add_u32 m0, s96, 48384
  s_nop 0
  buffer_load_dwordx4 v220, s[60:63], s64 offen sc1 lds
  s_add_u32 s64, s64, 55296
  s_add_u32 m0, s96, 51840
  s_nop 0
  buffer_load_dwordx4 v220, s[60:63], s64 offen sc1 lds
  s_add_u32 s64, s64, 55296
  s_add_u32 m0, s96, 55296
  s_nop 0
  buffer_load_dwordx4 v220, s[60:63], s64 offen sc1 lds
  s_add_u32 s64, s64, 55296
  s_add_u32 m0, s96, 58752
  s_nop 0
  buffer_load_dwordx4 v220, s[60:63], s64 offen sc1 lds
  s_add_u32 s64, s64, 55296
  s_add_u32 m0, s96, 62208
  s_nop 0
  buffer_load_dwordx4 v220, s[60:63], s64 offen sc1 lds
  s_add_u32 s64, s64, 55296
  s_add_u32 m0, s96, 65664
  s_nop 0
  buffer_load_dwordx4 v220, s[60:63], s64 offen sc1 lds
  s_add_u32 s64, s64, 55296
  s_mov_b64 exec, -1
p4_bar:
  s_barrier
  s_branch p4_end
p4_early:
  s_lshl_b32 s50, s40, 19
  s_lshl_b32 s51, s40, 16
  s_add_u32 s51, s51, 2097152
  s_lshl_b32 s41, s46, 6
  v_add_u32 v4, s41, v2
  v_lshl_add_u32 v10, v3, 11, v4
  v_lshlrev_b32 v10, 4, v10
  v_lshl_add_u32 v11, v3, 13, v4
  v_lshlrev_b32 v11, 2, v11
  s_lshl_b32 s42, s40, 3
  s_add_u32 s45, s41, s42
  s_add_u32 s45, s45, 6144
  s_xor_b32 s41, s40, 0
  s_mul_i32 s41, s41, 12288
  s_add_u32 s41, s41, 75264
  v_add_u32 v5, s41, v15
  s_xor_b32 s41, s40, 1
  s_mul_i32 s41, s41, 12288
  s_add_u32 s41, s41, 78336
  v_add_u32 v6, s41, v15
  s_xor_b32 s41, s40, 2
  s_mul_i32 s41, s41, 12288
  s_add_u32 s41, s41, 81408
  v_add_u32 v7, s41, v15
  s_xor_b32 s41, s40, 3
  s_mul_i32 s41, s41, 12288
  s_add_u32 s41, s41, 84480
  v_add_u32 v8, s41, v15
  s_add_u32 s36, s20, 14221312
  s_addc_u32 s37, s21, 0
  s_mov_b32 s38, 49152
  s_mov_b32 s39, 0x20000
  v_mov_b32 v12, v220
  buffer_load_dwordx2 v[32:33], v9, s[28:31], 0 offen offset:0 sc1
  buffer_load_dwordx2 v[34:35], v9, s[28:31], s48 offen offset:0 sc1
  buffer_load_dwordx2 v[36:37], v9, s[28:31], s49 offen offset:0 sc1
  buffer_load_dwordx2 v[24:25], v9, s[28:31], 0 offen offset:256 sc1
  buffer_load_dwordx2 v[26:27], v9, s[28:31], s48 offen offset:256 sc1
  buffer_load_dwordx2 v[28:29], v9, s[28:31], s49 offen offset:256 sc1
  v_add_u32 v4, s45, v1
  v_lshrrev_b32 v252, 3, v1
  v_and_b32 v253, 7, v1
  v_lshl_add_u32 v252, v252, 8, v253
  s_lshl_b32 s42, s40, 3
  s_add_u32 s42, s42, 5888
  v_add_u32 v252, s42, v252
  v_cmp_gt_u32 vcc, 8, v1
  s_nop 1
  v_cndmask_b32 v4, v252, v4, vcc
  s_bfm_b64 exec, 56, 0
  v_lshlrev_b32 v4, 7, v4
  s_mov_b32 s3, 65536
poll12:
  buffer_load_dwordx2 v[252:253], v4, s[68:71], s65 offen sc1
  s_waitcnt vmcnt(0)
  v_cmp_ne_u64 vcc, s[100:101], v[252:253]
  s_sub_u32 s3, s3, 1
  s_cbranch_scc1 poll12_x
  s_mov_b64 exec, vcc
  s_cbranch_vccnz poll12
poll12_x:
  s_mov_b64 exec, -1
  s_add_u32 s42, s50, 0
  buffer_load_dwordx4 v[220:223], v10, s[32:35], s42 offen offset:0 sc1
  s_add_u32 s42, s50, 65536
  buffer_load_dwordx4 v[224:227], v10, s[32:35], s42 offen offset:0 sc1
  s_add_u32 s42, s50, 131072
  buffer_load_dwordx4 v[228:231], v10, s[32:35], s42 offen offset:0 sc1
  s_add_u32 s42, s50, 196608
  buffer_load_dwordx4 v[232:235], v10, s[32:35], s42 offen offset:0 sc1
  s_add_u32 s42, s50, 262144
  buffer_load_dwordx4 v[236:239], v10, s[32:35], s42 offen offset:0 sc1
  s_add_u32 s42, s50, 327680
  buffer_load_dwordx4 v[240:243], v10, s[32:35], s42 offen offset:0 sc1
  s_add_u32 s42, s50, 393216
  buffer_load_dwordx4 v[244:247], v10, s[32:35], s42 offen offset:0 sc1
  s_add_u32 s42, s50, 458752
  buffer_load_dwordx4 v[248:251], v10, s[32:35], s42 offen offset:0 sc1
  s_add_u32 s42, s51, 0
  buffer_load_dword v252, v11, s[32:35], s42 offen offset:0 sc1
  s_add_u32 s42, s51, 8192
  buffer_load_dword v253, v11, s[32:35], s42 offen offset:0 sc1
  s_add_u32 s42, s51, 16384
  buffer_load_dword v254, v11, s[32:35], s42 offen offset:0 sc1
  s_add_u32 s42, s51, 24576
  buffer_load_dword v255, v11, s[32:35], s42 offen offset:0 sc1
  v_and_b32 v4, 7, v1
  v_lshlrev_b32 v4, 2, v4
  v_add_u32 v4, 0x20000, v4
p4e_pw:
  ds_read_b32 v16, v4 offset:31744
  s_waitcnt lgkmcnt(0)
  v_cmp_eq_u32 vcc, 0, v16
  s_cbranch_vccz p4e_px
  s_sleep 4
  s_branch p4e_pw
p4e_px:
  s_mov_b64 exec, s[94:95]
  s_add_u32 m0, s96, 0
  s_nop 0
  buffer_load_dwordx4 v12, s[60:63], s64 offen sc1 lds
  s_add_u32 s64, s64, 55296
  s_add_u32 m0, s96, 3456
  s_nop 0
  buffer_load_dwordx4 v12, s[60:63], s64 offen sc1 lds
  s_add_u32 s64, s64, 55296
  s_add_u32 m0, s96, 6912
  s_nop 0
  buffer_load_dwordx4 v12, s[60:63], s64 offen sc1 lds
  s_add_u32 s64, s64, 55296
  s_add_u32 m0, s96, 10368
  s_nop 0
  buffer_load_dwordx4 v12, s[60:63], s64 offen sc1 lds
  s_add_u32 s64, s64, 55296
  s_add_u32 m0, s96, 13824
  s_nop 0
  buffer_load_dwordx4 v12, s[60:63], s64 offen sc1 lds
  s_add_u32 s64, s64, 55296
  s_add_u32 m0, s96, 17280
  s_nop 0
  buffer_load_dwordx4 v12, s[60:63], s64 offen sc1 lds
  s_add_u32 s64, s64, 55296
  s_add_u32 m0, s96, 20736
  s_nop 0
  buffer_load_dwordx4 v12, s[60:63], s64 offen sc1 lds
  s_add_u32 s64, s64, 55296
  s_add_u32 m0, s96, 24192
  s_nop 0
  buffer_load_dwordx4 v12, s[60:63], s64 offen sc1 lds
  s_add_u32 s64, s64, 55296
  s_add_u32 m0, s96, 27648
  s_nop 0
  buffer_load_dwordx4 v12, s[60:63], s64 offen sc1 lds
  s_add_u32 s64, s64, 55296
  s_add_u32 m0, s96, 31104
  s_nop 0
  buffer_load_dwordx4 v12, s[60:63], s64 offen sc1 lds
  s_add_u32 s64, s64, 55296
  s_add_u32 m0, s96, 34560
  s_nop 0
  buffer_load_dwordx4 v12, s[60:63], s64 offen sc1 lds
  s_add_u32 s64, s64, 55296
  s_add_u32 m0, s96, 38016
  s_nop 0
  buffer_load_dwordx4 v12, s[60:63], s64 offen sc1 lds
  s_add_u32 s64, s64, 55296
  s_add_u32 m0, s96, 41472
  s_nop 0
  buffer_load_dwordx4 v12, s[60:63], s64 offen sc1 lds
  s_add_u32 s64, s64, 55296
  s_add_u32 m0, s96, 44928
  s_nop 0
  buffer_load_dwordx4 v12, s[60:63], s64 offen sc1 lds
  s_add_u32 s64, s64, 55296
  s_add_u32 m0, s96, 48384
  s_nop 0
  buffer_load_dwordx4 v12, s[60:63], s64 offen sc1 lds
  s_add_u32 s64, s64, 55296
  s_add_u32 m0, s96, 51840
  s_nop 0
  buffer_load_dwordx4 v12, s[60:63], s64 offen sc1 lds
  s_add_u32 s64, s64, 55296
  s_add_u32 m0, s96, 55296
  s_nop 0
  buffer_load_dwordx4 v12, s[60:63], s64 offen sc1 lds
  s_add_u32 s64, s64, 55296
  s_add_u32 m0, s96, 58752
  s_nop 0
  buffer_load_dwordx4 v12, s[60:63], s64 offen sc1 lds
  s_add_u32 s64, s64, 55296
  s_add_u32 m0, s96, 62208
  s_nop 0
  buffer_load_dwordx4 v12, s[60:63], s64 offen sc1 lds
  s_add_u32 s64, s64, 55296
  s_add_u32 m0, s96, 65664
  s_nop 0
  buffer_load_dwordx4 v12, s[60:63], s64 offen sc1 lds
  s_add_u32 s64, s64, 55296
  s_mov_b64 exec, -1
  v_lshlrev_b32 v80, 16, v32
  v_and_b32 v81, 0xffff0000, v32
  v_lshlrev_b32 v82, 16, v33
  v_and_b32 v83, 0xffff0000, v33
  v_lshlrev_b32 v84, 16, v34
  v_and_b32 v85, 0xffff0000, v34
  v_lshlrev_b32 v86, 16, v35
  v_and_b32 v87, 0xffff0000, v35
  v_lshlrev_b32 v88, 16, v36
  v_and_b32 v89, 0xffff0000, v36
  v_lshlrev_b32 v90, 16, v37
  v_and_b32 v91, 0xffff0000, v37
  v_lshlrev_b32 v64, 16, v24
  v_and_b32 v65, 0xffff0000, v24
  v_lshlrev_b32 v66, 16, v25
  v_and_b32 v67, 0xffff0000, v25
  v_lshlrev_b32 v68, 16, v26
  v_and_b32 v69, 0xffff0000, v26
  v_lshlrev_b32 v70, 16, v27
  v_and_b32 v71, 0xffff0000, v27
  v_lshlrev_b32 v72, 16, v28
  v_and_b32 v73, 0xffff0000, v28
  v_lshlrev_b32 v74, 16, v29
  v_and_b32 v75, 0xffff0000, v29
  v_and_b32 v4, 1, v2
  v_mul_u32_u24 v4, 131064, v4
  v_add_u32 v9, v9, v4
  s_mov_b32 s54, 0x55555555
  s_mov_b32 s55, s54
  v_lshlrev_b32 v76, 9, v3
  v_lshl_add_u32 v76, v2, 2, v76
  v_add_u32 v76, 161280, v76
  v_lshlrev_b32 v77, 2, v1
  s_lshl_b32 s52, s47, 13
  s_lshl_b32 s42, s46, 8
  s_add_u32 s52, s52, s42
  s_waitcnt vmcnt(31)
  v_mfma_f32_32x32x16_bf16 v[16:31], v[112:115], v[220:223], 0
  v_mfma_f32_32x32x16_bf16 v[32:47], v[116:119], v[220:223], 0
  v_mfma_f32_32x32x16_bf16 v[48:63], v[120:123], v[220:223], 0
  s_waitcnt vmcnt(30)
  v_mfma_f32_32x32x16_bf16 v[16:31], v[124:127], v[224:227], v[16:31]
  v_mfma_f32_32x32x16_bf16 v[32:47], v[128:131], v[224:227], v[32:47]
  v_mfma_f32_32x32x16_bf16 v[48:63], v[132:135], v[224:227], v[48:63]
  s_waitcnt vmcnt(29)
  v_mfma_f32_32x32x16_bf16 v[16:31], v[136:139], v[228:231], v[16:31]
  v_mfma_f32_32x32x16_bf16 v[32:47], v[140:143], v[228:231], v[32:47]
  v_mfma_f32_32x32x16_bf16 v[48:63], v[144:147], v[228:231], v[48:63]
  s_waitcnt vmcnt(28)
  v_mfma_f32_32x32x16_bf16 v[16:31], v[148:151], v[232:235], v[16:31]
  v_mfma_f32_32x32x16_bf16 v[32:47], v[152:155], v[232:235], v[32:47]
  v_mfma_f32_32x32x16_bf16 v[48:63], v[156:159], v[232:235], v[48:63]
  s_waitcnt vmcnt(27)
  v_mfma_f32_32x32x16_bf16 v[16:31], v[160:163], v[236:239], v[16:31]
  v_mfma_f32_32x32x16_bf16 v[32:47], v[164:167], v[236:239], v[32:47]
  v_mfma_f32_32x32x16_bf16 v[48:63], v[168:171], v[236:239], v[48:63]
  s_waitcnt vmcnt(26)
  v_mfma_f32_32x32x16_bf16 v[16:31], v[172:175], v[240:243], v[16:31]
  v_mfma_f32_32x32x16_bf16 v[32:47], v[176:179], v[240:243], v[32:47]
  v_mfma_f32_32x32x16_bf16 v[48:63], v[180:183], v[240:243], v[48:63]
  s_waitcnt vmcnt(25)
  v_mfma_f32_32x32x16_bf16 v[16:31], v[184:187], v[244:247], v[16:31]
  v_mfma_f32_32x32x16_bf16 v[32:47], v[188:191], v[244:247], v[32:47]
  v_mfma_f32_32x32x16_bf16 v[48:63], v[192:195], v[244:247], v[48:63]
  s_waitcnt vmcnt(24)
  v_mfma_f32_32x32x16_bf16 v[16:31], v[196:199], v[248:251], v[16:31]
  v_mfma_f32_32x32x16_bf16 v[32:47], v[200:203], v[248:251], v[32:47]
  v_mfma_f32_32x32x16_bf16 v[48:63], v[204:207], v[248:251], v[48:63]
  s_waitcnt vmcnt(20)
  v_mfma_f32_32x32x16_bf16 v[16:31], v[208:211], v[252:255], v[16:31]
  v_mfma_f32_32x32x16_bf16 v[32:47], v[212:215], v[252:255], v[32:47]
  v_mfma_f32_32x32x16_bf16 v[48:63], v[216:219], v[252:255], v[48:63]
  s_nop 9
  v_pk_add_f32 v[16:17], v[16:17], v[80:81]
  v_pk_add_f32 v[18:19], v[18:19], v[82:83]
  v_pk_add_f32 v[32:33], v[32:33], v[84:85]
  v_pk_add_f32 v[34:35], v[34:35], v[86:87]
  v_pk_add_f32 v[48:49], v[48:49], v[88:89]
  v_pk_add_f32 v[50:51], v[50:51], v[90:91]
  s_mov_b32 s57, -2
  s_mov_b32 s3, 65536
  s_barrier
  s_setprio 2
  s_add_u32 s42, s50, 0
  buffer_load_dwordx4 v[220:223], v10, s[32:35], s42 offen offset:512 sc1
  s_add_u32 s42, s50, 65536
  buffer_load_dwordx4 v[224:227], v10, s[32:35], s42 offen offset:512 sc1
  s_add_u32 s42, s50, 131072
  buffer_load_dwordx4 v[228:231], v10, s[32:35], s42 offen offset:512 sc1
  s_add_u32 s42, s50, 196608
  buffer_load_dwordx4 v[232:235], v10, s[32:35], s42 offen offset:512 sc1
  s_add_u32 s42, s50, 262144
  buffer_load_dwordx4 v[236:239], v10, s[32:35], s42 offen offset:512 sc1
  s_add_u32 s42, s50, 327680
  buffer_load_dwordx4 v[240:243], v10, s[32:35], s42 offen offset:512 sc1
  s_add_u32 s42, s50, 393216
  buffer_load_dwordx4 v[244:247], v10, s[32:35], s42 offen offset:512 sc1
  s_add_u32 s42, s50, 458752
  buffer_load_dwordx4 v[248:251], v10, s[32:35], s42 offen offset:512 sc1
  s_add_u32 s42, s51, 0
  buffer_load_dword v252, v11, s[32:35], s42 offen offset:128 sc1
  s_add_u32 s42, s51, 8192
  buffer_load_dword v253, v11, s[32:35], s42 offen offset:128 sc1
  s_add_u32 s42, s51, 16384
  buffer_load_dword v254, v11, s[32:35], s42 offen offset:128 sc1
  s_add_u32 s42, s51, 24576
  buffer_load_dword v255, v11, s[32:35], s42 offen offset:128 sc1
  ds_write_b128 v5, v[16:19] offset:0
  ds_write_b128 v6, v[20:23] offset:0
  ds_write_b128 v7, v[24:27] offset:0
  ds_write_b128 v8, v[28:31] offset:0
  ds_write_b128 v5, v[32:35] offset:1024
  ds_write_b128 v6, v[36:39] offset:1024
  ds_write_b128 v7, v[40:43] offset:1024
  ds_write_b128 v8, v[44:47] offset:1024
  ds_write_b128 v5, v[48:51] offset:2048
  ds_write_b128 v6, v[52:55] offset:2048
  ds_write_b128 v7, v[56:59] offset:2048
  ds_write_b128 v8, v[60:63] offset:2048
  s_xor_b32 s41, s40, 0
  s_mul_i32 s41, s41, 9216
  s_add_u32 s41, s41, 124416
  v_add_u32 v5, s41, v15
  s_xor_b32 s41, s40, 1
  s_mul_i32 s41, s41, 9216
  s_add_u32 s41, s41, 124416
  v_add_u32 v6, s41, v15
  s_xor_b32 s41, s40, 2
  s_mul_i32 s41, s41, 9216
  s_add_u32 s41, s41, 127488
  v_add_u32 v7, s41, v15
  s_xor_b32 s41, s40, 3
  s_mul_i32 s41, s41, 9216
  s_add_u32 s41, s41, 130560
  v_add_u32 v8, s41, v15
  s_waitcnt lgkmcnt(0)
  s_barrier
  s_cmp_ge_u32 s2, 144
  s_cbranch_scc1 p4_nb
  v_lshrrev_b32 v16, 4, v1
  v_lshlrev_b32 v16, 2, v16
  v_and_b32 v17, 15, v1
  s_and_b32 s41, s22, 3
  s_lshl_b32 s41, s41, 4
  v_add_u32 v18, s41, v17
  v_cvt_f32_u32 v16, v16
  v_cvt_f32_u32 v18, v18
  v_cvt_f32_u32 v17, v17
  v_mul_f32 v18, 0x3c800000, v18
  v_mul_f32 v17, 0x3d000000, v17
  v_mul_f32 v19, v16, v18
  v_mul_f32 v20, v16, v17
  v_cos_f32 v22, v19
  v_sin_f32 v23, v19
  s_nop 0
  v_cvt_pk_bf16_f32 v80, v22, v23
  v_cvt_pk_bf16_f32 v84, -v23, v22
  v_fmamk_f32 v21, v18, 0x3f800000, v19
  v_cos_f32 v22, v21
  v_sin_f32 v23, v21
  s_nop 0
  v_cvt_pk_bf16_f32 v81, v22, v23
  v_cvt_pk_bf16_f32 v85, -v23, v22
  v_fmamk_f32 v21, v18, 0x40000000, v19
  v_cos_f32 v22, v21
  v_sin_f32 v23, v21
  s_nop 0
  v_cvt_pk_bf16_f32 v82, v22, v23
  v_cvt_pk_bf16_f32 v86, -v23, v22
  v_fmamk_f32 v21, v18, 0x40400000, v19
  v_cos_f32 v22, v21
  v_sin_f32 v23, v21
  s_nop 0
  v_cvt_pk_bf16_f32 v83, v22, v23
  v_cvt_pk_bf16_f32 v87, -v23, v22
  v_cos_f32 v22, v20
  v_sin_f32 v23, v20
  s_nop 0
  v_cvt_pk_bf16_f32 v88, v22, v23
  v_cvt_pk_bf16_f32 v92, -v23, v22
  v_fmamk_f32 v21, v17, 0x3f800000, v20
  v_cos_f32 v22, v21
  v_sin_f32 v23, v21
  s_nop 0
  v_cvt_pk_bf16_f32 v89, v22, v23
  v_cvt_pk_bf16_f32 v93, -v23, v22
  v_fmamk_f32 v21, v17, 0x40000000, v20
  v_cos_f32 v22, v21
  v_sin_f32 v23, v21
  s_nop 0
  v_cvt_pk_bf16_f32 v90, v22, v23
  v_cvt_pk_bf16_f32 v94, -v23, v22
  v_fmamk_f32 v21, v17, 0x40400000, v20
  v_cos_f32 v22, v21
  v_sin_f32 v23, v21
  s_nop 0
  v_cvt_pk_bf16_f32 v91, v22, v23
  v_cvt_pk_bf16_f32 v95, -v23, v22
  v_mul_f32 v18, 0x3d000000, v18
  v_mul_f32 v19, 0x3d000000, v19
  v_fmamk_f32 v21, v18, 0x0, v19
  v_cos_f32 v96, v21
  v_sin_f32 v104, v21
  v_fmamk_f32 v21, v18, 0x3f800000, v19
  v_cos_f32 v97, v21
  v_sin_f32 v105, v21
  v_fmamk_f32 v21, v18, 0x40000000, v19
  v_cos_f32 v98, v21
  v_sin_f32 v106, v21
  v_fmamk_f32 v21, v18, 0x40400000, v19
  v_cos_f32 v99, v21
  v_sin_f32 v107, v21
  v_fmamk_f32 v21, v18, 0x41800000, v19
  v_cos_f32 v100, v21
  v_sin_f32 v108, v21
  v_fmamk_f32 v21, v18, 0x41880000, v19
  v_cos_f32 v101, v21
  v_sin_f32 v109, v21
  v_fmamk_f32 v21, v18, 0x41900000, v19
  v_cos_f32 v102, v21
  v_sin_f32 v110, v21
  v_fmamk_f32 v21, v18, 0x41980000, v19
  v_cos_f32 v103, v21
  v_sin_f32 v111, v21
p4_nb:
  s_branch p4_chk
p4_rt:
  s_sub_u32 s3, s3, 1
  s_cselect_b32 s57, -1, s57
  s_add_u32 s42, s50, 0
  buffer_load_dwordx4 v[220:223], v10, s[32:35], s42 offen offset:512 sc1
  s_add_u32 s42, s50, 65536
  buffer_load_dwordx4 v[224:227], v10, s[32:35], s42 offen offset:512 sc1
  s_add_u32 s42, s50, 131072
  buffer_load_dwordx4 v[228:231], v10, s[32:35], s42 offen offset:512 sc1
  s_add_u32 s42, s50, 196608
  buffer_load_dwordx4 v[232:235], v10, s[32:35], s42 offen offset:512 sc1
  s_add_u32 s42, s50, 262144
  buffer_load_dwordx4 v[236:239], v10, s[32:35], s42 offen offset:512 sc1
  s_add_u32 s42, s50, 327680
  buffer_load_dwordx4 v[240:243], v10, s[32:35], s42 offen offset:512 sc1
  s_add_u32 s42, s50, 393216
  buffer_load_dwordx4 v[244:247], v10, s[32:35], s42 offen offset:512 sc1
  s_add_u32 s42, s50, 458752
  buffer_load_dwordx4 v[248:251], v10, s[32:35], s42 offen offset:512 sc1
  s_add_u32 s42, s51, 0
  buffer_load_dword v252, v11, s[32:35], s42 offen offset:128 sc1
  s_add_u32 s42, s51, 8192
  buffer_load_dword v253, v11, s[32:35], s42 offen offset:128 sc1
  s_add_u32 s42, s51, 16384
  buffer_load_dword v254, v11, s[32:35], s42 offen offset:128 sc1
  s_add_u32 s42, s51, 24576
  buffer_load_dword v255, v11, s[32:35], s42 offen offset:128 sc1
p4_chk:
  s_waitcnt vmcnt(11)
  v_mfma_f32_32x32x16_bf16 v[16:31], v[112:115], v[220:223], 0
  v_max3_u32 v4, v220, v221, v222
  v_max_u32 v4, v4, v223
  v_cmp_lt_u32 vcc, s57, v4
  s_cbranch_vccnz p4_rt
  v_mfma_f32_32x32x16_bf16 v[32:47], v[116:119], v[220:223], 0
  v_mfma_f32_32x32x16_bf16 v[48:63], v[120:123], v[220:223], 0
  s_waitcnt vmcnt(10)
  v_mfma_f32_32x32x16_bf16 v[16:31], v[124:127], v[224:227], v[16:31]
  v_max3_u32 v4, v224, v225, v226
  v_max_u32 v4, v4, v227
  v_cmp_lt_u32 vcc, s57, v4
  s_cbranch_vccnz p4_rt
  v_mfma_f32_32x32x16_bf16 v[32:47], v[128:131], v[224:227], v[32:47]
  v_mfma_f32_32x32x16_bf16 v[48:63], v[132:135], v[224:227], v[48:63]
  s_waitcnt vmcnt(9)
  v_mfma_f32_32x32x16_bf16 v[16:31], v[136:139], v[228:231], v[16:31]
  v_max3_u32 v4, v228, v229, v230
  v_max_u32 v4, v4, v231
  v_cmp_lt_u32 vcc, s57, v4
  s_cbranch_vccnz p4_rt
  v_mfma_f32_32x32x16_bf16 v[32:47], v[140:143], v[228:231], v[32:47]
  v_mfma_f32_32x32x16_bf16 v[48:63], v[144:147], v[228:231], v[48:63]
  s_waitcnt vmcnt(8)
  v_mfma_f32_32x32x16_bf16 v[16:31], v[148:151], v[232:235], v[16:31]
  v_max3_u32 v4, v232, v233, v234
  v_max_u32 v4, v4, v235
  v_cmp_lt_u32 vcc, s57, v4
  s_cbranch_vccnz p4_rt
  v_mfma_f32_32x32x16_bf16 v[32:47], v[152:155], v[232:235], v[32:47]
  v_mfma_f32_32x32x16_bf16 v[48:63], v[156:159], v[232:235], v[48:63]
  s_waitcnt vmcnt(7)
  v_mfma_f32_32x32x16_bf16 v[16:31], v[160:163], v[236:239], v[16:31]
  v_max3_u32 v4, v236, v237, v238
  v_max_u32 v4, v4, v239
  v_cmp_lt_u32 vcc, s57, v4
  s_cbranch_vccnz p4_rt
  v_mfma_f32_32x32x16_bf16 v[32:47], v[164:167], v[236:239], v[32:47]
  v_mfma_f32_32x32x16_bf16 v[48:63], v[168:171], v[236:239], v[48:63]
  s_waitcnt vmcnt(6)
  v_mfma_f32_32x32x16_bf16 v[16:31], v[172:175], v[240:243], v[16:31]
  v_max3_u32 v4, v240, v241, v242
  v_max_u32 v4, v4, v243
  v_cmp_lt_u32 vcc, s57, v4
  s_cbranch_vccnz p4_rt
  v_mfma_f32_32x32x16_bf16 v[32:47], v[176:179], v[240:243], v[32:47]
  v_mfma_f32_32x32x16_bf16 v[48:63], v[180:183], v[240:243], v[48:63]
  s_waitcnt vmcnt(5)
  v_mfma_f32_32x32x16_bf16 v[16:31], v[184:187], v[244:247], v[16:31]
  v_max3_u32 v4, v244, v245, v246
  v_max_u32 v4, v4, v247
  v_cmp_lt_u32 vcc, s57, v4
  s_cbranch_vccnz p4_rt
  v_mfma_f32_32x32x16_bf16 v[32:47], v[188:191], v[244:247], v[32:47]
  v_mfma_f32_32x32x16_bf16 v[48:63], v[192:195], v[244:247], v[48:63]
  s_waitcnt vmcnt(4)
  v_mfma_f32_32x32x16_bf16 v[16:31], v[196:199], v[248:251], v[16:31]
  v_max3_u32 v4, v248, v249, v250
  v_max_u32 v4, v4, v251
  v_cmp_lt_u32 vcc, s57, v4
  s_cbranch_vccnz p4_rt
  v_mfma_f32_32x32x16_bf16 v[32:47], v[200:203], v[248:251], v[32:47]
  v_mfma_f32_32x32x16_bf16 v[48:63], v[204:207], v[248:251], v[48:63]
  s_waitcnt vmcnt(0)
  v_mfma_f32_32x32x16_bf16 v[16:31], v[208:211], v[252:255], v[16:31]
  v_max3_u32 v4, v252, v253, v254
  v_max_u32 v4, v4, v255
  v_cmp_lt_u32 vcc, s57, v4
  s_cbranch_vccnz p4_rt
  v_mfma_f32_32x32x16_bf16 v[32:47], v[212:215], v[252:255], v[32:47]
  v_mfma_f32_32x32x16_bf16 v[48:63], v[216:219], v[252:255], v[48:63]
  s_nop 5
  ds_write_b128 v6, v[20:23] offset:0
  ds_write_b128 v7, v[24:27] offset:0
  ds_write_b128 v8, v[28:31] offset:0
  s_nop 1
  ds_write_b128 v6, v[36:39] offset:1024
  ds_write_b128 v7, v[40:43] offset:1024
  ds_write_b128 v8, v[44:47] offset:1024
  ds_write_b128 v6, v[52:55] offset:2048
  ds_write_b128 v7, v[56:59] offset:2048
  ds_write_b128 v8, v[60:63] offset:2048
  s_waitcnt lgkmcnt(0)
  s_barrier
  ds_read_b128 v[20:23], v5 offset:0
  ds_read_b128 v[24:27], v5 offset:3072
  ds_read_b128 v[28:31], v5 offset:6144
  ds_read_b128 v[36:39], v5 offset:1024
  ds_read_b128 v[40:43], v5 offset:4096
  ds_read_b128 v[44:47], v5 offset:7168
  ds_read_b128 v[52:55], v5 offset:2048
  ds_read_b128 v[56:59], v5 offset:5120
  ds_read_b128 v[60:63], v5 offset:8192
  v_pk_add_f32 v[16:17], v[16:17], v[64:65]
  v_pk_add_f32 v[18:19], v[18:19], v[66:67]
  v_pk_add_f32 v[32:33], v[32:33], v[68:69]
  v_pk_add_f32 v[34:35], v[34:35], v[70:71]
  v_pk_add_f32 v[48:49], v[48:49], v[72:73]
  v_pk_add_f32 v[50:51], v[50:51], v[74:75]
  s_waitcnt lgkmcnt(6)
  v_pk_add_f32 v[16:17], v[16:17], v[20:21]
  v_pk_add_f32 v[24:25], v[24:25], v[28:29]
  v_pk_add_f32 v[18:19], v[18:19], v[22:23]
  v_pk_add_f32 v[26:27], v[26:27], v[30:31]
  v_pk_add_f32 v[16:17], v[16:17], v[24:25]
  v_pk_add_f32 v[18:19], v[18:19], v[26:27]
  v_cvt_pk_bf16_f32 v240, v16, v17
  v_cvt_pk_bf16_f32 v241, v18, v19
  s_waitcnt lgkmcnt(3)
  v_pk_add_f32 v[32:33], v[32:33], v[36:37]
  v_pk_add_f32 v[40:41], v[40:41], v[44:45]
  v_pk_add_f32 v[34:35], v[34:35], v[38:39]
  v_pk_add_f32 v[42:43], v[42:43], v[46:47]
  v_pk_add_f32 v[32:33], v[32:33], v[40:41]
  v_pk_add_f32 v[34:35], v[34:35], v[42:43]
  v_cvt_pk_bf16_f32 v242, v32, v33
  v_cvt_pk_bf16_f32 v243, v34, v35
  s_mov_b64 vcc, s[54:55]
  v_cndmask_b32_dpp v220, v242, v240, vcc quad_perm:[1,0,3,2] row_mask:0xf bank_mask:0xf
  v_cndmask_b32_dpp v221, v243, v241, vcc quad_perm:[1,0,3,2] row_mask:0xf bank_mask:0xf
  s_not_b64 vcc, vcc
  v_cndmask_b32_dpp v222, v240, v242, vcc quad_perm:[1,0,3,2] row_mask:0xf bank_mask:0xf
  v_cndmask_b32_dpp v223, v241, v243, vcc quad_perm:[1,0,3,2] row_mask:0xf bank_mask:0xf
  buffer_store_dwordx4 v[220:223], v9, s[24:27], 0 offen offset:256 sc1
  s_waitcnt lgkmcnt(0)
  v_pk_add_f32 v[48:49], v[48:49], v[52:53]
  v_pk_add_f32 v[56:57], v[56:57], v[60:61]
  v_pk_add_f32 v[50:51], v[50:51], v[54:55]
  v_pk_add_f32 v[58:59], v[58:59], v[62:63]
  v_pk_add_f32 v[48:49], v[48:49], v[56:57]
  v_pk_add_f32 v[50:51], v[50:51], v[58:59]
  v_cvt_pk_bf16_f32 v244, v48, v49
  v_cvt_pk_bf16_f32 v245, v50, v51
  s_nop 0
  v_mov_b32_dpp v246, v244 quad_perm:[1,0,3,2] row_mask:0xf bank_mask:0xf
  v_mov_b32_dpp v247, v245 quad_perm:[1,0,3,2] row_mask:0xf bank_mask:0xf
  s_mov_b64 exec, s[54:55]
  buffer_store_dwordx4 v[244:247], v9, s[24:27], s49 offen offset:256 sc1
  s_mov_b64 exec, -1
  v_and_b32 v248, v13, v240
  v_dot2_f32_bf16 v249, v241, v241, 0
  v_dot2_f32_bf16 v248, v248, v248, 0
  v_dot2_f32_bf16 v248, v242, v242, v248
  v_dot2_f32_bf16 v249, v243, v243, v249
  v_dot2_f32_bf16 v248, v244, v244, v248
  v_dot2_f32_bf16 v249, v245, v245, v249
  s_nop 2
  v_add_f32 v248, v248, v249
  v_mov_b32 v249, v248
  s_nop 1
  v_permlane32_swap_b32 v248, v249
  v_add_f32 v248, v248, v249
  ds_write_b32 v14, v248
  s_cmp_lg_u32 s40, 0
  s_waitcnt lgkmcnt(0)
  s_barrier
  s_cbranch_scc1 p4_end
  ds_read2_b32 v[24:25], v76 offset0:0 offset1:32
  ds_read2_b32 v[26:27], v76 offset0:64 offset1:96
  s_waitcnt lgkmcnt(0)
  v_add_f32 v24, v24, v25
  v_add_f32 v26, v26, v27
  v_add_f32 v24, v24, v26
  buffer_store_dword v24, v77, s[36:39], s52 offen sc1
p4_end:
  s_mov_b32 s23, 1
  s_mov_b32 s65, 4194304
  s_add_u32 s20, s20, 14221312
  s_addc_u32 s21, s21, 0
  s_branch k_layer
k_last:
  s_and_b32 s40, s40, 3
  s_cmp_ge_u32 s2, 192
  s_cbranch_scc1 p8_idle
  s_cmp_lt_u32 s22, 4
  s_cbranch_scc1 p8_se
  s_barrier
p8_se:
  s_add_u32 s28, s20, 2424832
  s_addc_u32 s29, s21, 0
  s_mov_b32 s30, 2359296
  s_mov_b32 s31, 0x20000
  s_and_b32 s46, s2, 7
  s_lshl_b32 s46, s46, 2
  s_bfe_u32 s41, s2, 0x20003
  s_add_u32 s46, s46, s41
  s_lshr_b32 s47, s2, 5
  s_lshr_b32 s41, s46, 3
  s_lshl_b32 s41, s41, 9
  s_and_b32 s42, s46, 1
  s_lshl_b32 s42, s42, 8
  s_add_u32 s41, s41, s42
  s_bfe_u32 s42, s46, 0x10001
  s_lshl_b32 s42, s42, 6
  s_add_u32 s41, s41, s42
  s_bfe_u32 s42, s46, 0x10002
  s_lshl_b32 s42, s42, 4
  s_add_u32 s41, s41, s42
  s_andn2_b32 s42, 4, s22
  s_lshl_b32 s42, s42, 5
  s_add_u32 s41, s41, s42
  v_and_b32 v4, 1, v2
  v_lshl_add_u32 v4, v4, 5, s41
  v_lshrrev_b32 v9, 1, v2
  v_add_u32 v9, v9, v4
  v_mul_u32_u24 v9, 1152, v9
  s_mul_i32 s41, s47, 192
  s_mul_i32 s42, s40, 48
  s_add_u32 s41, s41, s42
  v_mul_u32_u24 v4, 24, v3
  v_add3_u32 v9, v9, v4, s41
  s_mov_b32 s24, s16
  s_mov_b32 s25, s17
  s_mov_b32 s26, 2359296
  s_mov_b32 s27, 0x20000
  v_lshlrev_b32 v15, 4, v1
  s_cmp_lt_u32 s22, 4
  s_cbranch_scc1 p8_early
  s_mul_i32 s41, s40, 12288
  s_add_u32 s41, s41, 75264
  v_add_u32 v8, s41, v15
  s_barrier
  ds_read_b128 v[16:19], v8 offset:0
  ds_read_b128 v[20:23], v8 offset:3072
  ds_read_b128 v[24:27], v8 offset:6144
  ds_read_b128 v[28:31], v8 offset:9216
  ds_read_b128 v[32:35], v8 offset:1024
  ds_read_b128 v[36:39], v8 offset:4096
  ds_read_b128 v[40:43], v8 offset:7168
  ds_read_b128 v[44:47], v8 offset:10240
  ds_read_b128 v[48:51], v8 offset:2048
  ds_read_b128 v[52:55], v8 offset:5120
  ds_read_b128 v[56:59], v8 offset:8192
  ds_read_b128 v[60:63], v8 offset:11264
  s_waitcnt lgkmcnt(8)
  v_pk_add_f32 v[16:17], v[16:17], v[20:21]
  v_pk_add_f32 v[24:25], v[24:25], v[28:29]
  v_pk_add_f32 v[18:19], v[18:19], v[22:23]
  v_pk_add_f32 v[26:27], v[26:27], v[30:31]
  v_pk_add_f32 v[16:17], v[16:17], v[24:25]
  v_pk_add_f32 v[18:19], v[18:19], v[26:27]
  v_cvt_pk_bf16_f32 v240, v16, v17
  v_cvt_pk_bf16_f32 v241, v18, v19
  s_waitcnt lgkmcnt(4)
  v_pk_add_f32 v[32:33], v[32:33], v[36:37]
  v_pk_add_f32 v[40:41], v[40:41], v[44:45]
  v_pk_add_f32 v[34:35], v[34:35], v[38:39]
  v_pk_add_f32 v[42:43], v[42:43], v[46:47]
  v_pk_add_f32 v[32:33], v[32:33], v[40:41]
  v_pk_add_f32 v[34:35], v[34:35], v[42:43]
  v_cvt_pk_bf16_f32 v242, v32, v33
  v_cvt_pk_bf16_f32 v243, v34, v35
  buffer_store_dwordx4 v[240:243], v9, s[24:27], 0 offen
  s_waitcnt lgkmcnt(0)
  v_pk_add_f32 v[48:49], v[48:49], v[52:53]
  v_pk_add_f32 v[56:57], v[56:57], v[60:61]
  v_pk_add_f32 v[50:51], v[50:51], v[54:55]
  v_pk_add_f32 v[58:59], v[58:59], v[62:63]
  v_pk_add_f32 v[48:49], v[48:49], v[56:57]
  v_pk_add_f32 v[50:51], v[50:51], v[58:59]
  v_cvt_pk_bf16_f32 v244, v48, v49
  v_cvt_pk_bf16_f32 v245, v50, v51
  buffer_store_dwordx2 v[244:245], v9, s[24:27], 0 offen offset:16
  s_barrier
p8_idle:
  s_branch p8_end
p8_early:
  s_lshl_b32 s50, s40, 19
  s_lshl_b32 s51, s40, 16
  s_add_u32 s51, s51, 2097152
  s_lshl_b32 s41, s46, 6
  v_add_u32 v4, s41, v2
  v_lshl_add_u32 v10, v3, 11, v4
  v_lshlrev_b32 v10, 4, v10
  v_lshl_add_u32 v11, v3, 13, v4
  v_lshlrev_b32 v11, 2, v11
  s_lshl_b32 s42, s40, 3
  s_add_u32 s45, s41, s42
  s_add_u32 s45, s45, 6144
  s_xor_b32 s41, s40, 0
  s_mul_i32 s41, s41, 12288
  s_add_u32 s41, s41, 75264
  v_add_u32 v5, s41, v15
  s_xor_b32 s41, s40, 1
  s_mul_i32 s41, s41, 12288
  s_add_u32 s41, s41, 78336
  v_add_u32 v6, s41, v15
  s_xor_b32 s41, s40, 2
  s_mul_i32 s41, s41, 12288
  s_add_u32 s41, s41, 81408
  v_add_u32 v7, s41, v15
  s_xor_b32 s41, s40, 3
  s_mul_i32 s41, s41, 12288
  s_add_u32 s41, s41, 84480
  v_add_u32 v8, s41, v15
  v_lshl_add_u32 v13, v3, 12, v4
  v_lshlrev_b32 v13, 3, v13
  s_mul_i32 s56, s40, 589824
  s_mul_i32 s53, s40, 147456
  s_add_u32 s36, s10, 5505024
  s_addc_u32 s37, s11, 0
  s_mov_b32 s38, 663552
  s_mov_b32 s39, 0x20000
  s_add_u32 s42, s56, 0
  buffer_load_dwordx2 v[220:221], v13, s[28:31], s42 offen offset:0 sc1
  buffer_load_dwordx2 v[224:225], v13, s[28:31], s42 offen offset:256 sc1
  s_add_u32 s42, s56, 16384
  buffer_load_dwordx2 v[222:223], v13, s[28:31], s42 offen offset:0 sc1
  buffer_load_dwordx2 v[226:227], v13, s[28:31], s42 offen offset:256 sc1
  s_add_u32 s42, s56, 65536
  buffer_load_dwordx2 v[228:229], v13, s[28:31], s42 offen offset:0 sc1
  buffer_load_dwordx2 v[232:233], v13, s[28:31], s42 offen offset:256 sc1
  s_add_u32 s42, s56, 81920
  buffer_load_dwordx2 v[230:231], v13, s[28:31], s42 offen offset:0 sc1
  buffer_load_dwordx2 v[234:235], v13, s[28:31], s42 offen offset:256 sc1
  s_add_u32 s42, s56, 131072
  buffer_load_dwordx2 v[236:237], v13, s[28:31], s42 offen offset:0 sc1
  buffer_load_dwordx2 v[240:241], v13, s[28:31], s42 offen offset:256 sc1
  s_add_u32 s42, s56, 147456
  buffer_load_dwordx2 v[238:239], v13, s[28:31], s42 offen offset:0 sc1
  buffer_load_dwordx2 v[242:243], v13, s[28:31], s42 offen offset:256 sc1
  s_add_u32 s42, s56, 196608
  buffer_load_dwordx2 v[244:245], v13, s[28:31], s42 offen offset:0 sc1
  buffer_load_dwordx2 v[248:249], v13, s[28:31], s42 offen offset:256 sc1
  s_add_u32 s42, s56, 212992
  buffer_load_dwordx2 v[246:247], v13, s[28:31], s42 offen offset:0 sc1
  buffer_load_dwordx2 v[250:251], v13, s[28:31], s42 offen offset:256 sc1
  s_waitcnt vmcnt(12)
  v_mfma_f32_32x32x16_bf16 v[16:31], v[112:115], v[220:223], 0
  v_mfma_f32_32x32x16_bf16 v[32:47], v[116:119], v[220:223], 0
  v_mfma_f32_32x32x16_bf16 v[48:63], v[120:123], v[220:223], 0
  v_mfma_f32_32x32x16_bf16 v[64:79], v[112:115], v[224:227], 0
  v_mfma_f32_32x32x16_bf16 v[80:95], v[116:119], v[224:227], 0
  v_mfma_f32_32x32x16_bf16 v[96:111], v[120:123], v[224:227], 0
  s_add_u32 s42, s56, 262144
  buffer_load_dwordx2 v[220:221], v13, s[28:31], s42 offen offset:0 sc1
  buffer_load_dwordx2 v[224:225], v13, s[28:31], s42 offen offset:256 sc1
  s_add_u32 s42, s56, 278528
  buffer_load_dwordx2 v[222:223], v13, s[28:31], s42 offen offset:0 sc1
  buffer_load_dwordx2 v[226:227], v13, s[28:31], s42 offen offset:256 sc1
  buffer_load_dwordx4 v[112:115], v12, s[36:39], s53 offen offset:0 sc1
  buffer_load_dwordx4 v[116:119], v12, s[36:39], s53 offen offset:64 sc1
  buffer_load_dwordx4 v[120:123], v12, s[36:39], s53 offen offset:128 sc1
  s_add_u32 s53, s53, 18432
  s_waitcnt vmcnt(15)
  v_mfma_f32_32x32x16_bf16 v[16:31], v[124:127], v[228:231], v[16:31]
  v_mfma_f32_32x32x16_bf16 v[32:47], v[128:131], v[228:231], v[32:47]
  v_mfma_f32_32x32x16_bf16 v[48:63], v[132:135], v[228:231], v[48:63]
  v_mfma_f32_32x32x16_bf16 v[64:79], v[124:127], v[232:235], v[64:79]
  v_mfma_f32_32x32x16_bf16 v[80:95], v[128:131], v[232:235], v[80:95]
  v_mfma_f32_32x32x16_bf16 v[96:111], v[132:135], v[232:235], v[96:111]
  s_add_u32 s42, s56, 327680
  buffer_load_dwordx2 v[228:229], v13, s[28:31], s42 offen offset:0 sc1
  buffer_load_dwordx2 v[232:233], v13, s[28:31], s42 offen offset:256 sc1
  s_add_u32 s42, s56, 344064
  buffer_load_dwordx2 v[230:231], v13, s[28:31], s42 offen offset:0 sc1
  buffer_load_dwordx2 v[234:235], v13, s[28:31], s42 offen offset:256 sc1
  buffer_load_dwordx4 v[124:127], v12, s[36:39], s53 offen offset:0 sc1
  buffer_load_dwordx4 v[128:131], v12, s[36:39], s53 offen offset:64 sc1
  buffer_load_dwordx4 v[132:135], v12, s[36:39], s53 offen offset:128 sc1
  s_add_u32 s53, s53, 18432
  s_waitcnt vmcnt(18)
  v_mfma_f32_32x32x16_bf16 v[16:31], v[136:139], v[236:239], v[16:31]
  v_mfma_f32_32x32x16_bf16 v[32:47], v[140:143], v[236:239], v[32:47]
  v_mfma_f32_32x32x16_bf16 v[48:63], v[144:147], v[236:239], v[48:63]
  v_mfma_f32_32x32x16_bf16 v[64:79], v[136:139], v[240:243], v[64:79]
  v_mfma_f32_32x32x16_bf16 v[80:95], v[140:143], v[240:243], v[80:95]
  v_mfma_f32_32x32x16_bf16 v[96:111], v[144:147], v[240:243], v[96:111]
  s_add_u32 s42, s56, 393216
  buffer_load_dwordx2 v[236:237], v13, s[28:31], s42 offen offset:0 sc1
  buffer_load_dwordx2 v[240:241], v13, s[28:31], s42 offen offset:256 sc1
  s_add_u32 s42, s56, 409600
  buffer_load_dwordx2 v[238:239], v13, s[28:31], s42 offen offset:0 sc1
  buffer_load_dwordx2 v[242:243], v13, s[28:31], s42 offen offset:256 sc1
  buffer_load_dwordx4 v[136:139], v12, s[36:39], s53 offen offset:0 sc1
  buffer_load_dwordx4 v[140:143], v12, s[36:39], s53 offen offset:64 sc1
  buffer_load_dwordx4 v[144:147], v12, s[36:39], s53 offen offset:128 sc1
  s_add_u32 s53, s53, 18432
  s_waitcnt vmcnt(21)
  v_mfma_f32_32x32x16_bf16 v[16:31], v[148:151], v[244:247], v[16:31]
  v_mfma_f32_32x32x16_bf16 v[32:47], v[152:155], v[244:247], v[32:47]
  v_mfma_f32_32x32x16_bf16 v[48:63], v[156:159], v[244:247], v[48:63]
  v_mfma_f32_32x32x16_bf16 v[64:79], v[148:151], v[248:251], v[64:79]
  v_mfma_f32_32x32x16_bf16 v[80:95], v[152:155], v[248:251], v[80:95]
  v_mfma_f32_32x32x16_bf16 v[96:111], v[156:159], v[248:251], v[96:111]
  s_add_u32 s42, s56, 458752
  buffer_load_dwordx2 v[244:245], v13, s[28:31], s42 offen offset:0 sc1
  buffer_load_dwordx2 v[248:249], v13, s[28:31], s42 offen offset:256 sc1
  s_add_u32 s42, s56, 475136
  buffer_load_dwordx2 v[246:247], v13, s[28:31], s42 offen offset:0 sc1
  buffer_load_dwordx2 v[250:251], v13, s[28:31], s42 offen offset:256 sc1
  buffer_load_dwordx4 v[148:151], v12, s[36:39], s53 offen offset:0 sc1
  buffer_load_dwordx4 v[152:155], v12, s[36:39], s53 offen offset:64 sc1
  buffer_load_dwordx4 v[156:159], v12, s[36:39], s53 offen offset:128 sc1
  s_add_u32 s53, s53, 18432
  s_waitcnt vmcnt(24)
  v_mfma_f32_32x32x16_bf16 v[16:31], v[160:163], v[220:223], v[16:31]
  v_mfma_f32_32x32x16_bf16 v[32:47], v[164:167], v[220:223], v[32:47]
  v_mfma_f32_32x32x16_bf16 v[48:63], v[168:171], v[220:223], v[48:63]
  v_mfma_f32_32x32x16_bf16 v[64:79], v[160:163], v[224:227], v[64:79]
  v_mfma_f32_32x32x16_bf16 v[80:95], v[164:167], v[224:227], v[80:95]
  v_mfma_f32_32x32x16_bf16 v[96:111], v[168:171], v[224:227], v[96:111]
  s_add_u32 s42, s56, 524288
  buffer_load_dwordx2 v[220:221], v13, s[28:31], s42 offen offset:0 sc1
  buffer_load_dwordx2 v[224:225], v13, s[28:31], s42 offen offset:256 sc1
  s_add_u32 s42, s56, 540672
  buffer_load_dwordx2 v[222:223], v13, s[28:31], s42 offen offset:0 sc1
  buffer_load_dwordx2 v[226:227], v13, s[28:31], s42 offen offset:256 sc1
  buffer_load_dwordx4 v[160:163], v12, s[36:39], s53 offen offset:0 sc1
  buffer_load_dwordx4 v[164:167], v12, s[36:39], s53 offen offset:64 sc1
  buffer_load_dwordx4 v[168:171], v12, s[36:39], s53 offen offset:128 sc1
  s_add_u32 s53, s53, 18432
  s_waitcnt vmcnt(24)
  v_mfma_f32_32x32x16_bf16 v[16:31], v[172:175], v[228:231], v[16:31]
  v_mfma_f32_32x32x16_bf16 v[32:47], v[176:179], v[228:231], v[32:47]
  v_mfma_f32_32x32x16_bf16 v[48:63], v[180:183], v[228:231], v[48:63]
  v_mfma_f32_32x32x16_bf16 v[64:79], v[172:175], v[232:235], v[64:79]
  v_mfma_f32_32x32x16_bf16 v[80:95], v[176:179], v[232:235], v[80:95]
  v_mfma_f32_32x32x16_bf16 v[96:111], v[180:183], v[232:235], v[96:111]
  buffer_load_dwordx4 v[172:175], v12, s[36:39], s53 offen offset:0 sc1
  buffer_load_dwordx4 v[176:179], v12, s[36:39], s53 offen offset:64 sc1
  buffer_load_dwordx4 v[180:183], v12, s[36:39], s53 offen offset:128 sc1
  s_add_u32 s53, s53, 18432
  s_waitcnt vmcnt(20)
  v_mfma_f32_32x32x16_bf16 v[16:31], v[184:187], v[236:239], v[16:31]
  v_mfma_f32_32x32x16_bf16 v[32:47], v[188:191], v[236:239], v[32:47]
  v_mfma_f32_32x32x16_bf16 v[48:63], v[192:195], v[236:239], v[48:63]
  v_mfma_f32_32x32x16_bf16 v[64:79], v[184:187], v[240:243], v[64:79]
  v_mfma_f32_32x32x16_bf16 v[80:95], v[188:191], v[240:243], v[80:95]
  v_mfma_f32_32x32x16_bf16 v[96:111], v[192:195], v[240:243], v[96:111]
  buffer_load_dwordx4 v[184:187], v12, s[36:39], s53 offen offset:0 sc1
  buffer_load_dwordx4 v[188:191], v12, s[36:39], s53 offen offset:64 sc1
  buffer_load_dwordx4 v[192:195], v12, s[36:39], s53 offen offset:128 sc1
  s_add_u32 s53, s53, 18432
  s_waitcnt vmcnt(16)
  v_mfma_f32_32x32x16_bf16 v[16:31], v[196:199], v[244:247], v[16:31]
  v_mfma_f32_32x32x16_bf16 v[32:47], v[200:203], v[244:247], v[32:47]
  v_mfma_f32_32x32x16_bf16 v[48:63], v[204:207], v[244:247], v[48:63]
  v_mfma_f32_32x32x16_bf16 v[64:79], v[196:199], v[248:251], v[64:79]
  v_mfma_f32_32x32x16_bf16 v[80:95], v[200:203], v[248:251], v[80:95]
  v_mfma_f32_32x32x16_bf16 v[96:111], v[204:207], v[248:251], v[96:111]
  buffer_load_dwordx4 v[196:199], v12, s[36:39], s53 offen offset:0 sc1
  buffer_load_dwordx4 v[200:203], v12, s[36:39], s53 offen offset:64 sc1
  buffer_load_dwordx4 v[204:207], v12, s[36:39], s53 offen offset:128 sc1
  s_waitcnt vmcnt(12)
  v_mfma_f32_32x32x16_bf16 v[16:31], v[208:211], v[220:223], v[16:31]
  v_mfma_f32_32x32x16_bf16 v[32:47], v[212:215], v[220:223], v[32:47]
  v_mfma_f32_32x32x16_bf16 v[48:63], v[216:219], v[220:223], v[48:63]
  v_mfma_f32_32x32x16_bf16 v[64:79], v[208:211], v[224:227], v[64:79]
  v_mfma_f32_32x32x16_bf16 v[80:95], v[212:215], v[224:227], v[80:95]
  v_mfma_f32_32x32x16_bf16 v[96:111], v[216:219], v[224:227], v[96:111]
  s_add_u32 s53, s40, 32
  s_mul_i32 s53, s53, 18432
  buffer_load_dwordx4 v[208:211], v12, s[36:39], s53 offen offset:0 sc1
  buffer_load_dwordx4 v[212:215], v12, s[36:39], s53 offen offset:64 sc1
  buffer_load_dwordx4 v[216:219], v12, s[36:39], s53 offen offset:128 sc1
  v_add_u32 v4, s45, v1
  s_bfm_b64 exec, 8, 0
  v_lshlrev_b32 v4, 7, v4
  s_mov_b32 s3, 65536
poll13:
  buffer_load_dwordx2 v[252:253], v4, s[68:71], s65 offen sc1
  s_waitcnt vmcnt(0)
  v_cmp_ne_u64 vcc, s[100:101], v[252:253]
  s_sub_u32 s3, s3, 1
  s_cbranch_scc1 poll13_x
  s_mov_b64 exec, vcc
  s_cbranch_vccnz poll13
poll13_x:
  s_mov_b64 exec, -1
  s_add_u32 s42, s50, 0
  buffer_load_dwordx4 v[220:223], v10, s[32:35], s42 offen offset:0 sc1
  s_add_u32 s42, s50, 65536
  buffer_load_dwordx4 v[224:227], v10, s[32:35], s42 offen offset:0 sc1
  s_add_u32 s42, s50, 131072
  buffer_load_dwordx4 v[228:231], v10, s[32:35], s42 offen offset:0 sc1
  s_add_u32 s42, s50, 196608
  buffer_load_dwordx4 v[232:235], v10, s[32:35], s42 offen offset:0 sc1
  s_add_u32 s42, s50, 262144
  buffer_load_dwordx4 v[236:239], v10, s[32:35], s42 offen offset:0 sc1
  s_add_u32 s42, s50, 327680
  buffer_load_dwordx4 v[240:243], v10, s[32:35], s42 offen offset:0 sc1
  s_add_u32 s42, s50, 393216
  buffer_load_dwordx4 v[244:247], v10, s[32:35], s42 offen offset:0 sc1
  s_add_u32 s42, s50, 458752
  buffer_load_dwordx4 v[248:251], v10, s[32:35], s42 offen offset:0 sc1
  s_add_u32 s42, s51, 0
  buffer_load_dword v252, v11, s[32:35], s42 offen offset:0 sc1
  s_add_u32 s42, s51, 8192
  buffer_load_dword v253, v11, s[32:35], s42 offen offset:0 sc1
  s_add_u32 s42, s51, 16384
  buffer_load_dword v254, v11, s[32:35], s42 offen offset:0 sc1
  s_add_u32 s42, s51, 24576
  buffer_load_dword v255, v11, s[32:35], s42 offen offset:0 sc1
  s_waitcnt vmcnt(11)
  v_mfma_f32_32x32x16_bf16 v[16:31], v[112:115], v[220:223], v[16:31]
  v_mfma_f32_32x32x16_bf16 v[32:47], v[116:119], v[220:223], v[32:47]
  v_mfma_f32_32x32x16_bf16 v[48:63], v[120:123], v[220:223], v[48:63]
  s_waitcnt vmcnt(10)
  v_mfma_f32_32x32x16_bf16 v[16:31], v[124:127], v[224:227], v[16:31]
  v_mfma_f32_32x32x16_bf16 v[32:47], v[128:131], v[224:227], v[32:47]
  v_mfma_f32_32x32x16_bf16 v[48:63], v[132:135], v[224:227], v[48:63]
  s_waitcnt vmcnt(9)
  v_mfma_f32_32x32x16_bf16 v[16:31], v[136:139], v[228:231], v[16:31]
  v_mfma_f32_32x32x16_bf16 v[32:47], v[140:143], v[228:231], v[32:47]
  v_mfma_f32_32x32x16_bf16 v[48:63], v[144:147], v[228:231], v[48:63]
  s_waitcnt vmcnt(8)
  v_mfma_f32_32x32x16_bf16 v[16:31], v[148:151], v[232:235], v[16:31]
  v_mfma_f32_32x32x16_bf16 v[32:47], v[152:155], v[232:235], v[32:47]
  v_mfma_f32_32x32x16_bf16 v[48:63], v[156:159], v[232:235], v[48:63]
  s_waitcnt vmcnt(7)
  v_mfma_f32_32x32x16_bf16 v[16:31], v[160:163], v[236:239], v[16:31]
  v_mfma_f32_32x32x16_bf16 v[32:47], v[164:167], v[236:239], v[32:47]
  v_mfma_f32_32x32x16_bf16 v[48:63], v[168:171], v[236:239], v[48:63]
  s_waitcnt vmcnt(6)
  v_mfma_f32_32x32x16_bf16 v[16:31], v[172:175], v[240:243], v[16:31]
  v_mfma_f32_32x32x16_bf16 v[32:47], v[176:179], v[240:243], v[32:47]
  v_mfma_f32_32x32x16_bf16 v[48:63], v[180:183], v[240:243], v[48:63]
  s_waitcnt vmcnt(5)
  v_mfma_f32_32x32x16_bf16 v[16:31], v[184:187], v[244:247], v[16:31]
  v_mfma_f32_32x32x16_bf16 v[32:47], v[188:191], v[244:247], v[32:47]
  v_mfma_f32_32x32x16_bf16 v[48:63], v[192:195], v[244:247], v[48:63]
  s_waitcnt vmcnt(4)
  v_mfma_f32_32x32x16_bf16 v[16:31], v[196:199], v[248:251], v[16:31]
  v_mfma_f32_32x32x16_bf16 v[32:47], v[200:203], v[248:251], v[32:47]
  v_mfma_f32_32x32x16_bf16 v[48:63], v[204:207], v[248:251], v[48:63]
  s_waitcnt vmcnt(0)
  v_mfma_f32_32x32x16_bf16 v[16:31], v[208:211], v[252:255], v[16:31]
  v_mfma_f32_32x32x16_bf16 v[32:47], v[212:215], v[252:255], v[32:47]
  v_mfma_f32_32x32x16_bf16 v[48:63], v[216:219], v[252:255], v[48:63]
  s_mov_b32 s57, -2
  s_mov_b32 s3, 65536
  s_barrier
  s_setprio 2
  s_add_u32 s42, s50, 0
  buffer_load_dwordx4 v[220:223], v10, s[32:35], s42 offen offset:512 sc1
  s_add_u32 s42, s50, 65536
  buffer_load_dwordx4 v[224:227], v10, s[32:35], s42 offen offset:512 sc1
  s_add_u32 s42, s50, 131072
  buffer_load_dwordx4 v[228:231], v10, s[32:35], s42 offen offset:512 sc1
  s_add_u32 s42, s50, 196608
  buffer_load_dwordx4 v[232:235], v10, s[32:35], s42 offen offset:512 sc1
  s_add_u32 s42, s50, 262144
  buffer_load_dwordx4 v[236:239], v10, s[32:35], s42 offen offset:512 sc1
  s_add_u32 s42, s50, 327680
  buffer_load_dwordx4 v[240:243], v10, s[32:35], s42 offen offset:512 sc1
  s_add_u32 s42, s50, 393216
  buffer_load_dwordx4 v[244:247], v10, s[32:35], s42 offen offset:512 sc1
  s_add_u32 s42, s50, 458752
  buffer_load_dwordx4 v[248:251], v10, s[32:35], s42 offen offset:512 sc1
  s_add_u32 s42, s51, 0
  buffer_load_dword v252, v11, s[32:35], s42 offen offset:128 sc1
  s_add_u32 s42, s51, 8192
  buffer_load_dword v253, v11, s[32:35], s42 offen offset:128 sc1
  s_add_u32 s42, s51, 16384
  buffer_load_dword v254, v11, s[32:35], s42 offen offset:128 sc1
  s_add_u32 s42, s51, 24576
  buffer_load_dword v255, v11, s[32:35], s42 offen offset:128 sc1
  ds_write_b128 v5, v[16:19] offset:0
  ds_write_b128 v6, v[20:23] offset:0
  ds_write_b128 v7, v[24:27] offset:0
  ds_write_b128 v8, v[28:31] offset:0
  ds_write_b128 v5, v[32:35] offset:1024
  ds_write_b128 v6, v[36:39] offset:1024
  ds_write_b128 v7, v[40:43] offset:1024
  ds_write_b128 v8, v[44:47] offset:1024
  ds_write_b128 v5, v[48:51] offset:2048
  ds_write_b128 v6, v[52:55] offset:2048
  ds_write_b128 v7, v[56:59] offset:2048
  ds_write_b128 v8, v[60:63] offset:2048
  s_xor_b32 s41, s40, 0
  s_mul_i32 s41, s41, 9216
  s_add_u32 s41, s41, 124416
  v_add_u32 v5, s41, v15
  s_xor_b32 s41, s40, 1
  s_mul_i32 s41, s41, 9216
  s_add_u32 s41, s41, 124416
  v_add_u32 v6, s41, v15
  s_xor_b32 s41, s40, 2
  s_mul_i32 s41, s41, 9216
  s_add_u32 s41, s41, 127488
  v_add_u32 v7, s41, v15
  s_xor_b32 s41, s40, 3
  s_mul_i32 s41, s41, 9216
  s_add_u32 s41, s41, 130560
  v_add_u32 v8, s41, v15
  s_waitcnt lgkmcnt(0)
  s_barrier
  s_branch p8_chk
p8_rt:
  s_sub_u32 s3, s3, 1
  s_cselect_b32 s57, -1, s57
  s_add_u32 s42, s50, 0
  buffer_load_dwordx4 v[220:223], v10, s[32:35], s42 offen offset:512 sc1
  s_add_u32 s42, s50, 65536
  buffer_load_dwordx4 v[224:227], v10, s[32:35], s42 offen offset:512 sc1
  s_add_u32 s42, s50, 131072
  buffer_load_dwordx4 v[228:231], v10, s[32:35], s42 offen offset:512 sc1
  s_add_u32 s42, s50, 196608
  buffer_load_dwordx4 v[232:235], v10, s[32:35], s42 offen offset:512 sc1
  s_add_u32 s42, s50, 262144
  buffer_load_dwordx4 v[236:239], v10, s[32:35], s42 offen offset:512 sc1
  s_add_u32 s42, s50, 327680
  buffer_load_dwordx4 v[240:243], v10, s[32:35], s42 offen offset:512 sc1
  s_add_u32 s42, s50, 393216
  buffer_load_dwordx4 v[244:247], v10, s[32:35], s42 offen offset:512 sc1
  s_add_u32 s42, s50, 458752
  buffer_load_dwordx4 v[248:251], v10, s[32:35], s42 offen offset:512 sc1
  s_add_u32 s42, s51, 0
  buffer_load_dword v252, v11, s[32:35], s42 offen offset:128 sc1
  s_add_u32 s42, s51, 8192
  buffer_load_dword v253, v11, s[32:35], s42 offen offset:128 sc1
  s_add_u32 s42, s51, 16384
  buffer_load_dword v254, v11, s[32:35], s42 offen offset:128 sc1
  s_add_u32 s42, s51, 24576
  buffer_load_dword v255, v11, s[32:35], s42 offen offset:128 sc1
p8_chk:
  s_waitcnt vmcnt(11)
  v_mfma_f32_32x32x16_bf16 v[16:31], v[112:115], v[220:223], v[64:79]
  v_max3_u32 v4, v220, v221, v222
  v_max_u32 v4, v4, v223
  v_cmp_lt_u32 vcc, s57, v4
  s_cbranch_vccnz p8_rt
  v_mfma_f32_32x32x16_bf16 v[32:47], v[116:119], v[220:223], v[80:95]
  v_mfma_f32_32x32x16_bf16 v[48:63], v[120:123], v[220:223], v[96:111]
  s_waitcnt vmcnt(10)
  v_mfma_f32_32x32x16_bf16 v[16:31], v[124:127], v[224:227], v[16:31]
  v_max3_u32 v4, v224, v225, v226
  v_max_u32 v4, v4, v227
  v_cmp_lt_u32 vcc, s57, v4
  s_cbranch_vccnz p8_rt
  v_mfma_f32_32x32x16_bf16 v[32:47], v[128:131], v[224:227], v[32:47]
  v_mfma_f32_32x32x16_bf16 v[48:63], v[132:135], v[224:227], v[48:63]
  s_waitcnt vmcnt(9)
  v_mfma_f32_32x32x16_bf16 v[16:31], v[136:139], v[228:231], v[16:31]
  v_max3_u32 v4, v228, v229, v230
  v_max_u32 v4, v4, v231
  v_cmp_lt_u32 vcc, s57, v4
  s_cbranch_vccnz p8_rt
  v_mfma_f32_32x32x16_bf16 v[32:47], v[140:143], v[228:231], v[32:47]
  v_mfma_f32_32x32x16_bf16 v[48:63], v[144:147], v[228:231], v[48:63]
  s_waitcnt vmcnt(8)
  v_mfma_f32_32x32x16_bf16 v[16:31], v[148:151], v[232:235], v[16:31]
  v_max3_u32 v4, v232, v233, v234
  v_max_u32 v4, v4, v235
  v_cmp_lt_u32 vcc, s57, v4
  s_cbranch_vccnz p8_rt
  v_mfma_f32_32x32x16_bf16 v[32:47], v[152:155], v[232:235], v[32:47]
  v_mfma_f32_32x32x16_bf16 v[48:63], v[156:159], v[232:235], v[48:63]
  s_waitcnt vmcnt(7)
  v_mfma_f32_32x32x16_bf16 v[16:31], v[160:163], v[236:239], v[16:31]
  v_max3_u32 v4, v236, v237, v238
  v_max_u32 v4, v4, v239
  v_cmp_lt_u32 vcc, s57, v4
  s_cbranch_vccnz p8_rt
  v_mfma_f32_32x32x16_bf16 v[32:47], v[164:167], v[236:239], v[32:47]
  v_mfma_f32_32x32x16_bf16 v[48:63], v[168:171], v[236:239], v[48:63]
  s_waitcnt vmcnt(6)
  v_mfma_f32_32x32x16_bf16 v[16:31], v[172:175], v[240:243], v[16:31]
  v_max3_u32 v4, v240, v241, v242
  v_max_u32 v4, v4, v243
  v_cmp_lt_u32 vcc, s57, v4
  s_cbranch_vccnz p8_rt
  v_mfma_f32_32x32x16_bf16 v[32:47], v[176:179], v[240:243], v[32:47]
  v_mfma_f32_32x32x16_bf16 v[48:63], v[180:183], v[240:243], v[48:63]
  s_waitcnt vmcnt(5)
  v_mfma_f32_32x32x16_bf16 v[16:31], v[184:187], v[244:247], v[16:31]
  v_max3_u32 v4, v244, v245, v246
  v_max_u32 v4, v4, v247
  v_cmp_lt_u32 vcc, s57, v4
  s_cbranch_vccnz p8_rt
  v_mfma_f32_32x32x16_bf16 v[32:47], v[188:191], v[244:247], v[32:47]
  v_mfma_f32_32x32x16_bf16 v[48:63], v[192:195], v[244:247], v[48:63]
  s_waitcnt vmcnt(4)
  v_mfma_f32_32x32x16_bf16 v[16:31], v[196:199], v[248:251], v[16:31]
  v_max3_u32 v4, v248, v249, v250
  v_max_u32 v4, v4, v251
  v_cmp_lt_u32 vcc, s57, v4
  s_cbranch_vccnz p8_rt
  v_mfma_f32_32x32x16_bf16 v[32:47], v[200:203], v[248:251], v[32:47]
  v_mfma_f32_32x32x16_bf16 v[48:63], v[204:207], v[248:251], v[48:63]
  s_waitcnt vmcnt(0)
  v_mfma_f32_32x32x16_bf16 v[16:31], v[208:211], v[252:255], v[16:31]
  v_max3_u32 v4, v252, v253, v254
  v_max_u32 v4, v4, v255
  v_cmp_lt_u32 vcc, s57, v4
  s_cbranch_vccnz p8_rt
  v_mfma_f32_32x32x16_bf16 v[32:47], v[212:215], v[252:255], v[32:47]
  v_mfma_f32_32x32x16_bf16 v[48:63], v[216:219], v[252:255], v[48:63]
  s_nop 5
  ds_write_b128 v6, v[20:23] offset:0
  ds_write_b128 v7, v[24:27] offset:0
  ds_write_b128 v8, v[28:31] offset:0
  s_nop 1
  ds_write_b128 v6, v[36:39] offset:1024
  ds_write_b128 v7, v[40:43] offset:1024
  ds_write_b128 v8, v[44:47] offset:1024
  ds_write_b128 v6, v[52:55] offset:2048
  ds_write_b128 v7, v[56:59] offset:2048
  ds_write_b128 v8, v[60:63] offset:2048
  s_waitcnt lgkmcnt(0)
  s_barrier
  ds_read_b128 v[20:23], v5 offset:0
  ds_read_b128 v[24:27], v5 offset:3072
  ds_read_b128 v[28:31], v5 offset:6144
  ds_read_b128 v[36:39], v5 offset:1024
  ds_read_b128 v[40:43], v5 offset:4096
  ds_read_b128 v[44:47], v5 offset:7168
  ds_read_b128 v[52:55], v5 offset:2048
  ds_read_b128 v[56:59], v5 offset:5120
  ds_read_b128 v[60:63], v5 offset:8192
  s_waitcnt lgkmcnt(6)
  v_pk_add_f32 v[16:17], v[16:17], v[20:21]
  v_pk_add_f32 v[24:25], v[24:25], v[28:29]
  v_pk_add_f32 v[18:19], v[18:19], v[22:23]
  v_pk_add_f32 v[26:27], v[26:27], v[30:31]
  v_pk_add_f32 v[16:17], v[16:17], v[24:25]
  v_pk_add_f32 v[18:19], v[18:19], v[26:27]
  v_cvt_pk_bf16_f32 v240, v16, v17
  v_cvt_pk_bf16_f32 v241, v18, v19
  s_waitcnt lgkmcnt(3)
  v_pk_add_f32 v[32:33], v[32:33], v[36:37]
  v_pk_add_f32 v[40:41], v[40:41], v[44:45]
  v_pk_add_f32 v[34:35], v[34:35], v[38:39]
  v_pk_add_f32 v[42:43], v[42:43], v[46:47]
  v_pk_add_f32 v[32:33], v[32:33], v[40:41]
  v_pk_add_f32 v[34:35], v[34:35], v[42:43]
  v_cvt_pk_bf16_f32 v242, v32, v33
  v_cvt_pk_bf16_f32 v243, v34, v35
  buffer_store_dwordx4 v[240:243], v9, s[24:27], 0 offen
  s_waitcnt lgkmcnt(0)
  v_pk_add_f32 v[48:49], v[48:49], v[52:53]
  v_pk_add_f32 v[56:57], v[56:57], v[60:61]
  v_pk_add_f32 v[50:51], v[50:51], v[54:55]
  v_pk_add_f32 v[58:59], v[58:59], v[62:63]
  v_pk_add_f32 v[48:49], v[48:49], v[56:57]
  v_pk_add_f32 v[50:51], v[50:51], v[58:59]
  v_cvt_pk_bf16_f32 v244, v48, v49
  v_cvt_pk_bf16_f32 v245, v50, v51
  buffer_store_dwordx2 v[244:245], v9, s[24:27], 0 offen offset:16
p8_end:
k_exit:
  s_endpgm
attn_prg:
  v_mov_b32 v4, 0x21800000
  v_cmp_nge_f32 vcc, v26, v4
  s_cbranch_vccnz attn_loop
  ds_write_b32 v10, v10
  s_branch attn_loop
attn_fallback:
  s_mov_b32 s48, 1
  v_mov_b32 v6, v13
  v_mov_b32 v7, v14
  v_mov_b32 v242, 0xff800000
  s_mov_b32 s54, 0
attn_mloop:
  ds_read_b64 v[100:101], v7 offset:0
  ds_read_b128 v[104:107], v6 offset:0
  ds_read_b128 v[108:111], v6 offset:512
  s_waitcnt lgkmcnt(0)
  v_mfma_f32_32x32x8bf16_1k v[32:47], v[100:101], v[92:93], 0
  v_mfma_f32_32x32x16_bf16 v[32:47], v[104:107], v[88:91], v[32:47]
  v_mfma_f32_32x32x8bf16_1k v[48:63], v[100:101], v[94:95], 0
  v_mfma_f32_32x32x16_bf16 v[48:63], v[108:111], v[88:91], v[48:63]
  s_nop 9
  v_max3_f32 v242, v32, v33, v242
  v_max3_f32 v242, v34, v35, v242
  v_max3_f32 v242, v36, v37, v242
  v_max3_f32 v242, v38, v39, v242
  v_max3_f32 v242, v40, v41, v242
  v_max3_f32 v242, v42, v43, v242
  v_max3_f32 v242, v44, v45, v242
  v_max3_f32 v242, v46, v47, v242
  v_max3_f32 v242, v48, v49, v242
  v_max3_f32 v242, v50, v51, v242
  v_max3_f32 v242, v52, v53, v242
  v_max3_f32 v242, v54, v55, v242
  v_max3_f32 v242, v56, v57, v242
  v_max3_f32 v242, v58, v59, v242
  v_max3_f32 v242, v60, v61, v242
  v_max3_f32 v242, v62, v63, v242
  ds_read_b128 v[104:107], v6 offset:1024
  ds_read_b128 v[108:111], v6 offset:1536
  s_waitcnt lgkmcnt(0)
  v_mfma_f32_32x32x8bf16_1k v[32:47], v[100:101], v[96:97], 0
  v_mfma_f32_32x32x16_bf16 v[32:47], v[104:107], v[88:91], v[32:47]
  v_mfma_f32_32x32x8bf16_1k v[48:63], v[100:101], v[98:99], 0
  v_mfma_f32_32x32x16_bf16 v[48:63], v[108:111], v[88:91], v[48:63]
  s_nop 9
  v_max3_f32 v242, v32, v33, v242
  v_max3_f32 v242, v34, v35, v242
  v_max3_f32 v242, v36, v37, v242
  v_max3_f32 v242, v38, v39, v242
  v_max3_f32 v242, v40, v41, v242
  v_max3_f32 v242, v42, v43, v242
  v_max3_f32 v242, v44, v45, v242
  v_max3_f32 v242, v46, v47, v242
  v_max3_f32 v242, v48, v49, v242
  v_max3_f32 v242, v50, v51, v242
  v_max3_f32 v242, v52, v53, v242
  v_max3_f32 v242, v54, v55, v242
  v_max3_f32 v242, v56, v57, v242
  v_max3_f32 v242, v58, v59, v242
  v_max3_f32 v242, v60, v61, v242
  v_max3_f32 v242, v62, v63, v242
  v_add_u32 v6, 9216, v6
  v_add_u32 v7, 9216, v7
  s_add_u32 s54, s54, 1
  s_cmp_lt_u32 s54, 16
  s_cbranch_scc1 attn_mloop
  v_mov_b32 v244, v242
  s_nop 1
  v_permlane32_swap_b32 v242, v244
  v_max_f32 v242, v242, v244
  s_branch attn_setm
k_end:
.section .rodata,"a"
.p2align 6
.amdhsa_kernel interleave_layers__spectral_gfnet__softmax_full_mha__prompt_kernel
  .amdhsa_next_free_vgpr 256
  .amdhsa_next_free_sgpr 102
  .amdhsa_accum_offset 256
  .amdhsa_group_segment_fixed_size 0
  .amdhsa_kernarg_size 72
  .amdhsa_user_sgpr_count 2
  .amdhsa_user_sgpr_kernarg_segment_ptr 1
  .amdhsa_system_sgpr_workgroup_id_x 1
.end_amdhsa_kernel
.set cs0, 0x3d71
.set cs1, 0x3d71
.set cs2, 0x3d71
.set cs3, 0x3d71
.set cs4, 0x3d71
.set cs5, 0x3d71
.set cs6, 0x3d71
.set cs7, 0x3d71
.set cs8, 0x3d70
.set cs9, 0x3d70
.set cs10, 0x3d70
.set cs11, 0x3d70
.set cs12, 0x3d6f
.set cs13, 0x3d6f
.set cs14, 0x3d6f
.set cs15, 0x3d6e
.set cs16, 0x3d6e
.set cs17, 0x3d6d
.set cs18, 0x3d6d
.set cs19, 0x3d6c
.set cs20, 0x3d6c
.set cs21, 0x3d6b
.set cs22, 0x3d6a
.set cs23, 0x3d6a
.set cs24, 0x3d69
.set cs25, 0x3d68
.set cs26, 0x3d68
.set cs27, 0x3d67
.set cs28, 0x3d66
.set cs29, 0x3d65
.set cs30, 0x3d65
.set cs31, 0x3d64
.set cs32, 0x3d63
.set cs33, 0x3d62
.set cs34, 0x3d61
.set cs35, 0x3d60
.set cs36, 0x3d5f
.set cs37, 0x3d5e
.set cs38, 0x3d5d
.set cs39, 0x3d5c
.set cs40, 0x3d5b
.set cs41, 0x3d5a
.set cs42, 0x3d58
.set cs43, 0x3d57
.set cs44, 0x3d56
.set cs45, 0x3d55
.set cs46, 0x3d54
.set cs47, 0x3d52
.set cs48, 0x3d51
.set cs49, 0x3d50
.set cs50, 0x3d4e
.set cs51, 0x3d4d
.set cs52, 0x3d4c
.set cs53, 0x3d4a
.set cs54, 0x3d49
.set cs55, 0x3d47
.set cs56, 0x3d46
.set cs57, 0x3d44
.set cs58, 0x3d43
.set cs59, 0x3d41
.set cs60, 0x3d3f
.set cs61, 0x3d3e
.set cs62, 0x3d3c
.set cs63, 0x3d3b
.set cs64, 0x3d39
.set cs65, 0x3d37
.set cs66, 0x3d35
.set cs67, 0x3d34
.set cs68, 0x3d32
.set cs69, 0x3d30
.set cs70, 0x3d2e
.set cs71, 0x3d2d
.set cs72, 0x3d2b
.set cs73, 0x3d29
.set cs74, 0x3d27
.set cs75, 0x3d25
.set cs76, 0x3d23
.set cs77, 0x3d21
.set cs78, 0x3d1f
.set cs79, 0x3d1d
.set cs80, 0x3d1b
.set cs81, 0x3d19
.set cs82, 0x3d17
.set cs83, 0x3d15
.set cs84, 0x3d13
.set cs85, 0x3d11
.set cs86, 0x3d0f
.set cs87, 0x3d0d
.set cs88, 0x3d0a
.set cs89, 0x3d08
.set cs90, 0x3d06
.set cs91, 0x3d04
.set cs92, 0x3d02
.set cs93, 0x3cff
.set cs94, 0x3cfa
.set cs95, 0x3cf6
.set cs96, 0x3cf1
.set cs97, 0x3ced
.set cs98, 0x3ce8
.set cs99, 0x3ce4
.set cs100, 0x3cdf
.set cs101, 0x3cda
.set cs102, 0x3cd6
.set cs103, 0x3cd1
.set cs104, 0x3ccc
.set cs105, 0x3cc7
.set cs106, 0x3cc2
.set cs107, 0x3cbe
.set cs108, 0x3cb9
.set cs109, 0x3cb4
.set cs110, 0x3caf
.set cs111, 0x3caa
.set cs112, 0x3ca5
.set cs113, 0x3ca0
.set cs114, 0x3c9b
.set cs115, 0x3c96
.set cs116, 0x3c91
.set cs117, 0x3c8c
.set cs118, 0x3c87
.set cs119, 0x3c82
.set cs120, 0x3c7a
.set cs121, 0x3c70
.set cs122, 0x3c65
.set cs123, 0x3c5b
.set cs124, 0x3c51
.set cs125, 0x3c47
.set cs126, 0x3c3c
.set cs127, 0x3c32
.set cs128, 0x3c28
.set cs129, 0x3c1d
.set cs130, 0x3c13
.set cs131, 0x3c08
.set cs132, 0x3bfc
.set cs133, 0x3be7
.set cs134, 0x3bd2
.set cs135, 0x3bbd
.set cs136, 0x3ba8
.set cs137, 0x3b93
.set cs138, 0x3b7d
.set cs139, 0x3b53
.set cs140, 0x3b28
.set cs141, 0x3afd
.set cs142, 0x3aa8
.set cs143, 0x3a28
.set cs144, 0x2285
.set cs145, 0xba28
.set cs146, 0xbaa8
.set cs147, 0xbafd
.set cs148, 0xbb28
.set cs149, 0xbb53
.set cs150, 0xbb7d
.set cs151, 0xbb93
.set cs152, 0xbba8
.set cs153, 0xbbbd
.set cs154, 0xbbd2
.set cs155, 0xbbe7
.set cs156, 0xbbfc
.set cs157, 0xbc08
.set cs158, 0xbc13
.set cs159, 0xbc1d
.set cs160, 0xbc28
.set cs161, 0xbc32
.set cs162, 0xbc3c
.set cs163, 0xbc47
.set cs164, 0xbc51
.set cs165, 0xbc5b
.set cs166, 0xbc65
.set cs167, 0xbc70
.set cs168, 0xbc7a
.set cs169, 0xbc82
.set cs170, 0xbc87
.set cs171, 0xbc8c
.set cs172, 0xbc91
.set cs173, 0xbc96
.set cs174, 0xbc9b
.set cs175, 0xbca0
.set cs176, 0xbca5
.set cs177, 0xbcaa
.set cs178, 0xbcaf
.set cs179, 0xbcb4
.set cs180, 0xbcb9
.set cs181, 0xbcbe
.set cs182, 0xbcc2
.set cs183, 0xbcc7
.set cs184, 0xbccc
.set cs185, 0xbcd1
.set cs186, 0xbcd6
.set cs187, 0xbcda
.set cs188, 0xbcdf
.set cs189, 0xbce4
.set cs190, 0xbce8
.set cs191, 0xbced
.set cs192, 0xbcf1
.set cs193, 0xbcf6
.set cs194, 0xbcfa
.set cs195, 0xbcff
.set cs196, 0xbd02
.set cs197, 0xbd04
.set cs198, 0xbd06
.set cs199, 0xbd08
.set cs200, 0xbd0a
.set cs201, 0xbd0d
.set cs202, 0xbd0f
.set cs203, 0xbd11
.set cs204, 0xbd13
.set cs205, 0xbd15
.set cs206, 0xbd17
.set cs207, 0xbd19
.set cs208, 0xbd1b
.set cs209, 0xbd1d
.set cs210, 0xbd1f
.set cs211, 0xbd21
.set cs212, 0xbd23
.set cs213, 0xbd25
.set cs214, 0xbd27
.set cs215, 0xbd29
.set cs216, 0xbd2b
.set cs217, 0xbd2d
.set cs218, 0xbd2e
.set cs219, 0xbd30
.set cs220, 0xbd32
.set cs221, 0xbd34
.set cs222, 0xbd35
.set cs223, 0xbd37
.set cs224, 0xbd39
.set cs225, 0xbd3b
.set cs226, 0xbd3c
.set cs227, 0xbd3e
.set cs228, 0xbd3f
.set cs229, 0xbd41
.set cs230, 0xbd43
.set cs231, 0xbd44
.set cs232, 0xbd46
.set cs233, 0xbd47
.set cs234, 0xbd49
.set cs235, 0xbd4a
.set cs236, 0xbd4c
.set cs237, 0xbd4d
.set cs238, 0xbd4e
.set cs239, 0xbd50
.set cs240, 0xbd51
.set cs241, 0xbd52
.set cs242, 0xbd54
.set cs243, 0xbd55
.set cs244, 0xbd56
.set cs245, 0xbd57
.set cs246, 0xbd58
.set cs247, 0xbd5a
.set cs248, 0xbd5b
.set cs249, 0xbd5c
.set cs250, 0xbd5d
.set cs251, 0xbd5e
.set cs252, 0xbd5f
.set cs253, 0xbd60
.set cs254, 0xbd61
.set cs255, 0xbd62
.set cs256, 0xbd63
.set cs257, 0xbd64
.set cs258, 0xbd65
.set cs259, 0xbd65
.set cs260, 0xbd66
.set cs261, 0xbd67
.set cs262, 0xbd68
.set cs263, 0xbd68
.set cs264, 0xbd69
.set cs265, 0xbd6a
.set cs266, 0xbd6a
.set cs267, 0xbd6b
.set cs268, 0xbd6c
.set cs269, 0xbd6c
.set cs270, 0xbd6d
.set cs271, 0xbd6d
.set cs272, 0xbd6e
.set cs273, 0xbd6e
.set cs274, 0xbd6f
.set cs275, 0xbd6f
.set cs276, 0xbd6f
.set cs277, 0xbd70
.set cs278, 0xbd70
.set cs279, 0xbd70
.set cs280, 0xbd70
.set cs281, 0xbd71
.set cs282, 0xbd71
.set cs283, 0xbd71
.set cs284, 0xbd71
.set cs285, 0xbd71
.set cs286, 0xbd71
.set cs287, 0xbd71
.set cs288, 0xbd71
.set cs289, 0xbd71
.set cs290, 0xbd71
.set cs291, 0xbd71
.set cs292, 0xbd71
.set cs293, 0xbd71
.set cs294, 0xbd71
.set cs295, 0xbd71
.set cs296, 0xbd70
.set cs297, 0xbd70
.set cs298, 0xbd70
.set cs299, 0xbd70
.set cs300, 0xbd6f
.set cs301, 0xbd6f
.set cs302, 0xbd6f
.set cs303, 0xbd6e
.set cs304, 0xbd6e
.set cs305, 0xbd6d
.set cs306, 0xbd6d
.set cs307, 0xbd6c
.set cs308, 0xbd6c
.set cs309, 0xbd6b
.set cs310, 0xbd6a
.set cs311, 0xbd6a
.set cs312, 0xbd69
.set cs313, 0xbd68
.set cs314, 0xbd68
.set cs315, 0xbd67
.set cs316, 0xbd66
.set cs317, 0xbd65
.set cs318, 0xbd65
.set cs319, 0xbd64
.set cs320, 0xbd63
.set cs321, 0xbd62
.set cs322, 0xbd61
.set cs323, 0xbd60
.set cs324, 0xbd5f
.set cs325, 0xbd5e
.set cs326, 0xbd5d
.set cs327, 0xbd5c
.set cs328, 0xbd5b
.set cs329, 0xbd5a
.set cs330, 0xbd58
.set cs331, 0xbd57
.set cs332, 0xbd56
.set cs333, 0xbd55
.set cs334, 0xbd54
.set cs335, 0xbd52
.set cs336, 0xbd51
.set cs337, 0xbd50
.set cs338, 0xbd4e
.set cs339, 0xbd4d
.set cs340, 0xbd4c
.set cs341, 0xbd4a
.set cs342, 0xbd49
.set cs343, 0xbd47
.set cs344, 0xbd46
.set cs345, 0xbd44
.set cs346, 0xbd43
.set cs347, 0xbd41
.set cs348, 0xbd3f
.set cs349, 0xbd3e
.set cs350, 0xbd3c
.set cs351, 0xbd3b
.set cs352, 0xbd39
.set cs353, 0xbd37
.set cs354, 0xbd35
.set cs355, 0xbd34
.set cs356, 0xbd32
.set cs357, 0xbd30
.set cs358, 0xbd2e
.set cs359, 0xbd2d
.set cs360, 0xbd2b
.set cs361, 0xbd29
.set cs362, 0xbd27
.set cs363, 0xbd25
.set cs364, 0xbd23
.set cs365, 0xbd21
.set cs366, 0xbd1f
.set cs367, 0xbd1d
.set cs368, 0xbd1b
.set cs369, 0xbd19
.set cs370, 0xbd17
.set cs371, 0xbd15
.set cs372, 0xbd13
.set cs373, 0xbd11
.set cs374, 0xbd0f
.set cs375, 0xbd0d
.set cs376, 0xbd0a
.set cs377, 0xbd08
.set cs378, 0xbd06
.set cs379, 0xbd04
.set cs380, 0xbd02
.set cs381, 0xbcff
.set cs382, 0xbcfa
.set cs383, 0xbcf6
.set cs384, 0xbcf1
.set cs385, 0xbced
.set cs386, 0xbce8
.set cs387, 0xbce4
.set cs388, 0xbcdf
.set cs389, 0xbcda
.set cs390, 0xbcd6
.set cs391, 0xbcd1
.set cs392, 0xbccc
.set cs393, 0xbcc7
.set cs394, 0xbcc2
.set cs395, 0xbcbe
.set cs396, 0xbcb9
.set cs397, 0xbcb4
.set cs398, 0xbcaf
.set cs399, 0xbcaa
.set cs400, 0xbca5
.set cs401, 0xbca0
.set cs402, 0xbc9b
.set cs403, 0xbc96
.set cs404, 0xbc91
.set cs405, 0xbc8c
.set cs406, 0xbc87
.set cs407, 0xbc82
.set cs408, 0xbc7a
.set cs409, 0xbc70
.set cs410, 0xbc65
.set cs411, 0xbc5b
.set cs412, 0xbc51
.set cs413, 0xbc47
.set cs414, 0xbc3c
.set cs415, 0xbc32
.set cs416, 0xbc28
.set cs417, 0xbc1d
.set cs418, 0xbc13
.set cs419, 0xbc08
.set cs420, 0xbbfc
.set cs421, 0xbbe7
.set cs422, 0xbbd2
.set cs423, 0xbbbd
.set cs424, 0xbba8
.set cs425, 0xbb93
.set cs426, 0xbb7d
.set cs427, 0xbb53
.set cs428, 0xbb28
.set cs429, 0xbafd
.set cs430, 0xbaa8
.set cs431, 0xba28
.set cs432, 0xa348
.set cs433, 0x3a28
.set cs434, 0x3aa8
.set cs435, 0x3afd
.set cs436, 0x3b28
.set cs437, 0x3b53
.set cs438, 0x3b7d
.set cs439, 0x3b93
.set cs440, 0x3ba8
.set cs441, 0x3bbd
.set cs442, 0x3bd2
.set cs443, 0x3be7
.set cs444, 0x3bfc
.set cs445, 0x3c08
.set cs446, 0x3c13
.set cs447, 0x3c1d
.set cs448, 0x3c28
.set cs449, 0x3c32
.set cs450, 0x3c3c
.set cs451, 0x3c47
.set cs452, 0x3c51
.set cs453, 0x3c5b
.set cs454, 0x3c65
.set cs455, 0x3c70
.set cs456, 0x3c7a
.set cs457, 0x3c82
.set cs458, 0x3c87
.set cs459, 0x3c8c
.set cs460, 0x3c91
.set cs461, 0x3c96
.set cs462, 0x3c9b
.set cs463, 0x3ca0
.set cs464, 0x3ca5
.set cs465, 0x3caa
.set cs466, 0x3caf
.set cs467, 0x3cb4
.set cs468, 0x3cb9
.set cs469, 0x3cbe
.set cs470, 0x3cc2
.set cs471, 0x3cc7
.set cs472, 0x3ccc
.set cs473, 0x3cd1
.set cs474, 0x3cd6
.set cs475, 0x3cda
.set cs476, 0x3cdf
.set cs477, 0x3ce4
.set cs478, 0x3ce8
.set cs479, 0x3ced
.set cs480, 0x3cf1
.set cs481, 0x3cf6
.set cs482, 0x3cfa
.set cs483, 0x3cff
.set cs484, 0x3d02
.set cs485, 0x3d04
.set cs486, 0x3d06
.set cs487, 0x3d08
.set cs488, 0x3d0a
.set cs489, 0x3d0d
.set cs490, 0x3d0f
.set cs491, 0x3d11
.set cs492, 0x3d13
.set cs493, 0x3d15
.set cs494, 0x3d17
.set cs495, 0x3d19
.set cs496, 0x3d1b
.set cs497, 0x3d1d
.set cs498, 0x3d1f
.set cs499, 0x3d21
.set cs500, 0x3d23
.set cs501, 0x3d25
.set cs502, 0x3d27
.set cs503, 0x3d29
.set cs504, 0x3d2b
.set cs505, 0x3d2d
.set cs506, 0x3d2e
.set cs507, 0x3d30
.set cs508, 0x3d32
.set cs509, 0x3d34
.set cs510, 0x3d35
.set cs511, 0x3d37
.set cs512, 0x3d39
.set cs513, 0x3d3b
.set cs514, 0x3d3c
.set cs515, 0x3d3e
.set cs516, 0x3d3f
.set cs517, 0x3d41
.set cs518, 0x3d43
.set cs519, 0x3d44
.set cs520, 0x3d46
.set cs521, 0x3d47
.set cs522, 0x3d49
.set cs523, 0x3d4a
.set cs524, 0x3d4c
.set cs525, 0x3d4d
.set cs526, 0x3d4e
.set cs527, 0x3d50
.set cs528, 0x3d51
.set cs529, 0x3d52
.set cs530, 0x3d54
.set cs531, 0x3d55
.set cs532, 0x3d56
.set cs533, 0x3d57
.set cs534, 0x3d58
.set cs535, 0x3d5a
.set cs536, 0x3d5b
.set cs537, 0x3d5c
.set cs538, 0x3d5d
.set cs539, 0x3d5e
.set cs540, 0x3d5f
.set cs541, 0x3d60
.set cs542, 0x3d61
.set cs543, 0x3d62
.set cs544, 0x3d63
.set cs545, 0x3d64
.set cs546, 0x3d65
.set cs547, 0x3d65
.set cs548, 0x3d66
.set cs549, 0x3d67
.set cs550, 0x3d68
.set cs551, 0x3d68
.set cs552, 0x3d69
.set cs553, 0x3d6a
.set cs554, 0x3d6a
.set cs555, 0x3d6b
.set cs556, 0x3d6c
.set cs557, 0x3d6c
.set cs558, 0x3d6d
.set cs559, 0x3d6d
.set cs560, 0x3d6e
.set cs561, 0x3d6e
.set cs562, 0x3d6f
.set cs563, 0x3d6f
.set cs564, 0x3d6f
.set cs565, 0x3d70
.set cs566, 0x3d70
.set cs567, 0x3d70
.set cs568, 0x3d70
.set cs569, 0x3d71
.set cs570, 0x3d71
.set cs571, 0x3d71
.set cs572, 0x3d71
.set cs573, 0x3d71
.set cs574, 0x3d71
.set cs575, 0x3d71
.set cs576, 0x3d2b
.set cs577, 0xbd2b
.altmacro
.macro E8 a,b,c,d,e,f,g,h
.short cs\a,cs\b,cs\c,cs\d,cs\e,cs\f,cs\g,cs\h
.endm
.p2align 8
T2:
.set d,0
.rept 576
E8 %(576+(d%2)),576,%(d),%((d+144)%576),%((2*d)%576),%((2*d+144)%576),%((3*d)%576),%((3*d+144)%576)
.set d,d+1
.endr
.set kb,1
.rept 71
.set d,0
.rept 576
.set x,(4*kb*d)%576
E8 %(x),%((x+144)%576),%((x+d)%576),%((x+d+144)%576),%((x+2*d)%576),%((x+2*d+144)%576),%((x+3*d)%576),%((x+3*d+144)%576)
.set d,d+1
.endr
.set kb,kb+1
.endr
.noaltmacro
```
